```python
import torch

def _softmax(x, axis=-1):
    return torch.softmax(x, dim=axis)
def _gelu(x):
    return torch.nn.functional.gelu(x, approximate="tanh")
def _silu(x):
    return torch.nn.functional.silu(x)
def _sigmoid(x):
    return torch.sigmoid(x)
def _layernorm(x, axis=-1, eps=1e-5):
    m = x.mean(dim=axis, keepdim=True)
    v = x.var(dim=axis, keepdim=True, unbiased=False)
    return (x - m) / torch.sqrt(v + eps)
def _scatter_add(tgt, idx, src, axis=0):
    return tgt.clone().index_add_(axis, idx, src)
def _segment_sum(src, seg, n):
    out = torch.zeros((n,) + src.shape[1:], dtype=src.dtype)
    return out.index_add_(0, seg, src)
def _pad(x, pw):
    flat = tuple(v for pair in reversed(pw) for v in pair)
    return torch.nn.functional.pad(x, flat)

kernel_name = 'standalone__mha_softmax__near_ridge'

def setup_inputs():

    _w = (lambda a: (lambda t: t.to(torch.bfloat16) if t.is_floating_point() else t)(torch.as_tensor(a)))
    B, H, Sq, Sk, D = 8, 16, 624, 1024, 256
    return {
        "q": _w((lambda *s: torch.randn(*s, dtype=torch.bfloat16) * 0.8)(B, H, Sq, D)),
        "k": _w((lambda *s: torch.randn(*s, dtype=torch.bfloat16) * 0.8)(B, H, Sk, D)),
        "v": _w((lambda *s: torch.randn(*s, dtype=torch.bfloat16) * 0.05)(B, H, Sk, D)),
    }

def reference(q, k, v):
    scale = q.shape[-1] ** -0.5
    scores = torch.einsum("bhqd,bhkd->bhqk", q, k) * scale
    p = _softmax(scores, axis=-1)
    return torch.einsum("bhqk,bhkd->bhqd", p, v)
```

```asm
; @launch grid=(256,1,1) block=(256,1,1) lds=163840
.amdgcn_target "amdgcn-amd-amdhsa--gfx950"
.text
.globl standalone__mha_softmax__near_ridge_kernel
.p2align 8
.type standalone__mha_softmax__near_ridge_kernel,@function
standalone__mha_softmax__near_ridge_kernel:
    s_cmp_ge_u32 s2, 256
    s_cbranch_scc1 L_end
    s_load_dwordx4 s[36:39], s[0:1], 0
    s_load_dwordx4 s[40:43], s[0:1], 16
    s_getpc_b64 s[62:63]
L_pc0:
    v_lshlrev_b32 v26, 7, v0
    global_load_dword v27, v26, s[62:63]
    s_and_b32 s44, s2, 7
    s_lshr_b32 s45, s2, 4
    s_lshl_b32 s45, s45, 3
    s_add_u32 s44, s44, s45
    s_bfe_u32 s45, s2, 0x10003
    v_lshrrev_b32 v16, 6, v0
    v_and_b32 v17, 63, v0
    v_lshrrev_b32 v20, 3, v17
    v_readfirstlane_b32 s31, v16
    v_and_b32 v21, 6, v20
    v_and_b32 v22, 7, v17
    v_xor_b32 v21, v21, v22
    v_lshlrev_b32 v21, 4, v21
    v_lshl_add_u32 v21, v20, 9, v21
    v_lshl_add_u32 v4, v16, 12, v21
    v_and_b32 v18, 15, v17
    v_lshrrev_b32 v19, 4, v17
    s_mul_i32 s35, s45, 163840
    s_mul_i32 s47, s44, 319488
    s_lshl_b32 s48, s44, 19
    s_lshl_b32 s25, s31, 12
    s_add_u32 s26, s25, 16384
    s_add_u32 s27, s25, 32768
    s_lshl_b32 s34, s31, 14
    s_waitcnt lgkmcnt(0)
    s_add_u32 s8, s38, s48
    s_addc_u32 s9, s39, 0
    s_and_b32 s9, s9, 0xffff
    s_mov_b32 s10, 524288
    s_mov_b32 s11, 0x00020000
    s_mul_i32 s49, s31, 36864
    s_add_u32 s49, s49, s35
    s_mov_b32 s28, 0
    s_add_u32 m0, s25, 0
    s_nop 0
    buffer_load_dwordx4 v4, s[8:11], s28 offen offset:0 nt lds
    s_add_u32 m0, s25, 896
    s_nop 0
    buffer_load_dwordx4 v4, s[8:11], s28 offen offset:128 nt lds
    s_add_u32 m0, s25, 1792
    s_nop 0
    buffer_load_dwordx4 v4, s[8:11], s28 offen offset:256 nt lds
    s_add_u32 m0, s25, 2688
    s_nop 0
    buffer_load_dwordx4 v4, s[8:11], s28 offen offset:384 nt lds
    s_add_u32 s4, s36, s47
    s_addc_u32 s5, s37, 0
    s_and_b32 s5, s5, 0xffff
    s_mov_b32 s6, 319488
    s_mov_b32 s7, 0x00020000
    s_add_u32 s12, s40, s48
    s_addc_u32 s13, s41, 0
    s_and_b32 s13, s13, 0xffff
    s_mov_b32 s14, 524288
    s_mov_b32 s15, 0x00020000
    s_add_u32 s33, s49, 24576
    s_add_u32 m0, s34, 98304
    s_nop 0
    buffer_load_dwordx4 v4, s[4:7], s33 offen offset:0 nt lds
    s_add_u32 m0, s34, 99200
    s_nop 0
    buffer_load_dwordx4 v4, s[4:7], s33 offen offset:128 nt lds
    s_add_u32 m0, s34, 100096
    s_nop 0
    buffer_load_dwordx4 v4, s[4:7], s33 offen offset:256 nt lds
    s_add_u32 m0, s34, 100992
    s_nop 0
    buffer_load_dwordx4 v4, s[4:7], s33 offen offset:384 nt lds
    s_add_u32 s33, s49, 28672
    s_add_u32 m0, s34, 102400
    s_nop 0
    buffer_load_dwordx4 v4, s[4:7], s33 offen offset:0 nt lds
    s_add_u32 m0, s34, 103296
    s_nop 0
    buffer_load_dwordx4 v4, s[4:7], s33 offen offset:128 nt lds
    s_add_u32 m0, s34, 104192
    s_nop 0
    buffer_load_dwordx4 v4, s[4:7], s33 offen offset:256 nt lds
    s_add_u32 m0, s34, 105088
    s_nop 0
    buffer_load_dwordx4 v4, s[4:7], s33 offen offset:384 nt lds
    s_add_u32 s33, s49, 32768
    s_add_u32 m0, s34, 106496
    s_nop 0
    buffer_load_dwordx4 v4, s[4:7], s33 offen offset:0 nt lds
    s_add_u32 m0, s34, 107392
    s_nop 0
    buffer_load_dwordx4 v4, s[4:7], s33 offen offset:128 nt lds
    s_add_u32 m0, s34, 108288
    s_nop 0
    buffer_load_dwordx4 v4, s[4:7], s33 offen offset:256 nt lds
    s_add_u32 m0, s34, 109184
    s_nop 0
    buffer_load_dwordx4 v4, s[4:7], s33 offen offset:384 nt lds
    s_add_u32 s33, s49, 36864
    s_add_u32 m0, s34, 110592
    s_nop 0
    buffer_load_dwordx4 v4, s[4:7], s33 offen offset:0 nt lds
    s_add_u32 m0, s34, 111488
    s_nop 0
    buffer_load_dwordx4 v4, s[4:7], s33 offen offset:128 nt lds
    s_add_u32 m0, s34, 112384
    s_nop 0
    buffer_load_dwordx4 v4, s[4:7], s33 offen offset:256 nt lds
    s_add_u32 m0, s34, 113280
    s_nop 0
    buffer_load_dwordx4 v4, s[4:7], s33 offen offset:384 nt lds
    s_add_u32 s16, s42, s47
    s_addc_u32 s17, s43, 0
    s_and_b32 s17, s17, 0xffff
    s_mov_b32 s18, 319488
    s_mov_b32 s19, 0x00020000
    s_mov_b32 s20, 0x3db8aa3b
    s_mov_b32 s21, 0x49800000
    s_mov_b32 s52, 0xc2200000
    s_mov_b32 s53, 0xffff0000
    s_mov_b64 s[50:51], 0
    s_lshl_b32 s54, s45, 2
    s_add_u32 s54, s54, s31
    s_cmp_eq_u32 s54, 7
    s_cselect_b64 s[54:55], 0, -1
    s_mov_b32 s23, 49152
    s_mov_b32 s24, 32768
    v_lshrrev_b32 v20, 3, v18
    v_lshlrev_b32 v20, 12, v20
    v_and_b32 v21, 7, v18
    v_lshl_add_u32 v20, v21, 7, v20
    v_and_b32 v21, 6, v18
    v_xor_b32 v21, v21, v19
    v_lshl_add_u32 v0, v21, 4, v20
    v_xor_b32 v1, 64, v0
    v_lshrrev_b32 v20, 5, v17
    v_lshlrev_b32 v20, 12, v20
    v_bfe_u32 v21, v17, 2, 3
    v_lshl_add_u32 v20, v21, 7, v20
    v_and_b32 v21, 6, v21
    v_bfe_u32 v22, v17, 1, 1
    v_xor_b32 v21, v21, v22
    v_lshl_add_u32 v20, v21, 4, v20
    v_and_b32 v21, 1, v17
    v_lshl_add_u32 v20, v21, 3, v20
    v_add_u32 v2, 49152, v20
    v_lshlrev_b32 v20, 14, v16
    v_lshl_add_u32 v20, v17, 4, v20
    v_add_u32 v3, 98304, v20
    v_add_u32 v22, s34, v0
    v_add_u32 v22, 98304, v22
    v_xor_b32 v23, 64, v22
    v_lshrrev_b32 v24, 3, v18
    v_mul_u32_u24 v24, 45056, v24
    v_add3_u32 v24, v24, v0, s26
    v_xor_b32 v25, 64, v24
    v_accvgpr_write_b32 a0, 0
    v_accvgpr_write_b32 a1, 0
    v_accvgpr_write_b32 a2, 0
    v_accvgpr_write_b32 a3, 0
    v_accvgpr_write_b32 a4, 0
    v_accvgpr_write_b32 a5, 0
    v_accvgpr_write_b32 a6, 0
    v_accvgpr_write_b32 a7, 0
    v_accvgpr_write_b32 a8, 0
    v_accvgpr_write_b32 a9, 0
    v_accvgpr_write_b32 a10, 0
    v_accvgpr_write_b32 a11, 0
    v_accvgpr_write_b32 a12, 0
    v_accvgpr_write_b32 a13, 0
    v_accvgpr_write_b32 a14, 0
    v_accvgpr_write_b32 a15, 0
    v_accvgpr_write_b32 a16, 0
    v_accvgpr_write_b32 a17, 0
    v_accvgpr_write_b32 a18, 0
    v_accvgpr_write_b32 a19, 0
    v_accvgpr_write_b32 a20, 0
    v_accvgpr_write_b32 a21, 0
    v_accvgpr_write_b32 a22, 0
    v_accvgpr_write_b32 a23, 0
    v_accvgpr_write_b32 a24, 0
    v_accvgpr_write_b32 a25, 0
    v_accvgpr_write_b32 a26, 0
    v_accvgpr_write_b32 a27, 0
    v_accvgpr_write_b32 a28, 0
    v_accvgpr_write_b32 a29, 0
    v_accvgpr_write_b32 a30, 0
    v_accvgpr_write_b32 a31, 0
    v_accvgpr_write_b32 a32, 0
    v_accvgpr_write_b32 a33, 0
    v_accvgpr_write_b32 a34, 0
    v_accvgpr_write_b32 a35, 0
    v_accvgpr_write_b32 a36, 0
    v_accvgpr_write_b32 a37, 0
    v_accvgpr_write_b32 a38, 0
    v_accvgpr_write_b32 a39, 0
    v_accvgpr_write_b32 a40, 0
    v_accvgpr_write_b32 a41, 0
    v_accvgpr_write_b32 a42, 0
    v_accvgpr_write_b32 a43, 0
    v_accvgpr_write_b32 a44, 0
    v_accvgpr_write_b32 a45, 0
    v_accvgpr_write_b32 a46, 0
    v_accvgpr_write_b32 a47, 0
    v_accvgpr_write_b32 a48, 0
    v_accvgpr_write_b32 a49, 0
    v_accvgpr_write_b32 a50, 0
    v_accvgpr_write_b32 a51, 0
    v_accvgpr_write_b32 a52, 0
    v_accvgpr_write_b32 a53, 0
    v_accvgpr_write_b32 a54, 0
    v_accvgpr_write_b32 a55, 0
    v_accvgpr_write_b32 a56, 0
    v_accvgpr_write_b32 a57, 0
    v_accvgpr_write_b32 a58, 0
    v_accvgpr_write_b32 a59, 0
    v_accvgpr_write_b32 a60, 0
    v_accvgpr_write_b32 a61, 0
    v_accvgpr_write_b32 a62, 0
    v_accvgpr_write_b32 a63, 0
    v_accvgpr_write_b32 a64, 0
    v_accvgpr_write_b32 a65, 0
    v_accvgpr_write_b32 a66, 0
    v_accvgpr_write_b32 a67, 0
    v_accvgpr_write_b32 a68, 0
    v_accvgpr_write_b32 a69, 0
    v_accvgpr_write_b32 a70, 0
    v_accvgpr_write_b32 a71, 0
    v_accvgpr_write_b32 a72, 0
    v_accvgpr_write_b32 a73, 0
    v_accvgpr_write_b32 a74, 0
    v_accvgpr_write_b32 a75, 0
    v_accvgpr_write_b32 a76, 0
    v_accvgpr_write_b32 a77, 0
    v_accvgpr_write_b32 a78, 0
    v_accvgpr_write_b32 a79, 0
    v_accvgpr_write_b32 a80, 0
    v_accvgpr_write_b32 a81, 0
    v_accvgpr_write_b32 a82, 0
    v_accvgpr_write_b32 a83, 0
    v_accvgpr_write_b32 a84, 0
    v_accvgpr_write_b32 a85, 0
    v_accvgpr_write_b32 a86, 0
    v_accvgpr_write_b32 a87, 0
    v_accvgpr_write_b32 a88, 0
    v_accvgpr_write_b32 a89, 0
    v_accvgpr_write_b32 a90, 0
    v_accvgpr_write_b32 a91, 0
    v_accvgpr_write_b32 a92, 0
    v_accvgpr_write_b32 a93, 0
    v_accvgpr_write_b32 a94, 0
    v_accvgpr_write_b32 a95, 0
    v_accvgpr_write_b32 a96, 0
    v_accvgpr_write_b32 a97, 0
    v_accvgpr_write_b32 a98, 0
    v_accvgpr_write_b32 a99, 0
    v_accvgpr_write_b32 a100, 0
    v_accvgpr_write_b32 a101, 0
    v_accvgpr_write_b32 a102, 0
    v_accvgpr_write_b32 a103, 0
    v_accvgpr_write_b32 a104, 0
    v_accvgpr_write_b32 a105, 0
    v_accvgpr_write_b32 a106, 0
    v_accvgpr_write_b32 a107, 0
    v_accvgpr_write_b32 a108, 0
    v_accvgpr_write_b32 a109, 0
    v_accvgpr_write_b32 a110, 0
    v_accvgpr_write_b32 a111, 0
    v_accvgpr_write_b32 a112, 0
    v_accvgpr_write_b32 a113, 0
    v_accvgpr_write_b32 a114, 0
    v_accvgpr_write_b32 a115, 0
    v_accvgpr_write_b32 a116, 0
    v_accvgpr_write_b32 a117, 0
    v_accvgpr_write_b32 a118, 0
    v_accvgpr_write_b32 a119, 0
    v_accvgpr_write_b32 a120, 0
    v_accvgpr_write_b32 a121, 0
    v_accvgpr_write_b32 a122, 0
    v_accvgpr_write_b32 a123, 0
    v_accvgpr_write_b32 a124, 0
    v_accvgpr_write_b32 a125, 0
    v_accvgpr_write_b32 a126, 0
    v_accvgpr_write_b32 a127, 0
    v_accvgpr_write_b32 a128, 0
    v_accvgpr_write_b32 a129, 0
    v_accvgpr_write_b32 a130, 0
    v_accvgpr_write_b32 a131, 0
    v_accvgpr_write_b32 a132, 0
    v_accvgpr_write_b32 a133, 0
    v_accvgpr_write_b32 a134, 0
    v_accvgpr_write_b32 a135, 0
    v_accvgpr_write_b32 a136, 0
    v_accvgpr_write_b32 a137, 0
    v_accvgpr_write_b32 a138, 0
    v_accvgpr_write_b32 a139, 0
    v_accvgpr_write_b32 a140, 0
    v_accvgpr_write_b32 a141, 0
    v_accvgpr_write_b32 a142, 0
    v_accvgpr_write_b32 a143, 0
    v_accvgpr_write_b32 a144, 0
    v_accvgpr_write_b32 a145, 0
    v_accvgpr_write_b32 a146, 0
    v_accvgpr_write_b32 a147, 0
    v_accvgpr_write_b32 a148, 0
    v_accvgpr_write_b32 a149, 0
    v_accvgpr_write_b32 a150, 0
    v_accvgpr_write_b32 a151, 0
    v_accvgpr_write_b32 a152, 0
    v_accvgpr_write_b32 a153, 0
    v_accvgpr_write_b32 a154, 0
    v_accvgpr_write_b32 a155, 0
    v_accvgpr_write_b32 a156, 0
    v_accvgpr_write_b32 a157, 0
    v_accvgpr_write_b32 a158, 0
    v_accvgpr_write_b32 a159, 0
    v_accvgpr_write_b32 a160, 0
    v_accvgpr_write_b32 a161, 0
    v_accvgpr_write_b32 a162, 0
    v_accvgpr_write_b32 a163, 0
    v_accvgpr_write_b32 a164, 0
    v_accvgpr_write_b32 a165, 0
    v_accvgpr_write_b32 a166, 0
    v_accvgpr_write_b32 a167, 0
    v_accvgpr_write_b32 a168, 0
    v_accvgpr_write_b32 a169, 0
    v_accvgpr_write_b32 a170, 0
    v_accvgpr_write_b32 a171, 0
    v_accvgpr_write_b32 a172, 0
    v_accvgpr_write_b32 a173, 0
    v_accvgpr_write_b32 a174, 0
    v_accvgpr_write_b32 a175, 0
    v_accvgpr_write_b32 a176, 0
    v_accvgpr_write_b32 a177, 0
    v_accvgpr_write_b32 a178, 0
    v_accvgpr_write_b32 a179, 0
    v_accvgpr_write_b32 a180, 0
    v_accvgpr_write_b32 a181, 0
    v_accvgpr_write_b32 a182, 0
    v_accvgpr_write_b32 a183, 0
    v_accvgpr_write_b32 a184, 0
    v_accvgpr_write_b32 a185, 0
    v_accvgpr_write_b32 a186, 0
    v_accvgpr_write_b32 a187, 0
    v_accvgpr_write_b32 a188, 0
    v_accvgpr_write_b32 a189, 0
    v_accvgpr_write_b32 a190, 0
    v_accvgpr_write_b32 a191, 0
    v_accvgpr_write_b32 a192, 0
    v_accvgpr_write_b32 a193, 0
    v_accvgpr_write_b32 a194, 0
    v_accvgpr_write_b32 a195, 0
    v_accvgpr_write_b32 a196, 0
    v_accvgpr_write_b32 a197, 0
    v_accvgpr_write_b32 a198, 0
    v_accvgpr_write_b32 a199, 0
    v_accvgpr_write_b32 a200, 0
    v_accvgpr_write_b32 a201, 0
    v_accvgpr_write_b32 a202, 0
    v_accvgpr_write_b32 a203, 0
    v_accvgpr_write_b32 a204, 0
    v_accvgpr_write_b32 a205, 0
    v_accvgpr_write_b32 a206, 0
    v_accvgpr_write_b32 a207, 0
    v_accvgpr_write_b32 a208, 0
    v_accvgpr_write_b32 a209, 0
    v_accvgpr_write_b32 a210, 0
    v_accvgpr_write_b32 a211, 0
    v_accvgpr_write_b32 a212, 0
    v_accvgpr_write_b32 a213, 0
    v_accvgpr_write_b32 a214, 0
    v_accvgpr_write_b32 a215, 0
    v_accvgpr_write_b32 a216, 0
    v_accvgpr_write_b32 a217, 0
    v_accvgpr_write_b32 a218, 0
    v_accvgpr_write_b32 a219, 0
    v_accvgpr_write_b32 a220, 0
    v_accvgpr_write_b32 a221, 0
    v_accvgpr_write_b32 a222, 0
    v_accvgpr_write_b32 a223, 0
    v_accvgpr_write_b32 a224, 0
    v_accvgpr_write_b32 a225, 0
    v_accvgpr_write_b32 a226, 0
    v_accvgpr_write_b32 a227, 0
    v_accvgpr_write_b32 a228, 0
    v_accvgpr_write_b32 a229, 0
    v_accvgpr_write_b32 a230, 0
    v_accvgpr_write_b32 a231, 0
    v_accvgpr_write_b32 a232, 0
    v_accvgpr_write_b32 a233, 0
    v_accvgpr_write_b32 a234, 0
    v_accvgpr_write_b32 a235, 0
    v_accvgpr_write_b32 a236, 0
    v_accvgpr_write_b32 a237, 0
    v_accvgpr_write_b32 a238, 0
    v_accvgpr_write_b32 a239, 0
    v_accvgpr_write_b32 a240, 0
    v_accvgpr_write_b32 a241, 0
    v_accvgpr_write_b32 a242, 0
    v_accvgpr_write_b32 a243, 0
    v_accvgpr_write_b32 a244, 0
    v_accvgpr_write_b32 a245, 0
    v_accvgpr_write_b32 a246, 0
    v_accvgpr_write_b32 a247, 0
    v_accvgpr_write_b32 a248, 0
    v_accvgpr_write_b32 a249, 0
    v_accvgpr_write_b32 a250, 0
    v_accvgpr_write_b32 a251, 0
    v_accvgpr_write_b32 a252, 0
    v_accvgpr_write_b32 a253, 0
    v_accvgpr_write_b32 a254, 0
    v_accvgpr_write_b32 a255, 0
    v_mov_b32 v11, 0
    v_mov_b32 v12, 0
    v_mov_b32 v13, 0
    v_mov_b32 v14, 0
    v_mov_b32 v15, 0
    s_waitcnt vmcnt(16)
    s_barrier
    ds_read_b128 v[192:195], v0 offset:0
    ds_read_b128 v[196:199], v1 offset:0
    ds_read_b128 v[200:203], v0 offset:1024
    ds_read_b128 v[204:207], v1 offset:1024
    ds_read_b128 v[208:211], v0 offset:2048
    ds_read_b128 v[212:215], v1 offset:2048
    ds_read_b128 v[216:219], v0 offset:3072
    ds_read_b128 v[220:223], v1 offset:3072
    ds_read_b128 v[224:227], v0 offset:8192
    ds_read_b128 v[228:231], v1 offset:8192
    ds_read_b128 v[232:235], v0 offset:9216
    ds_read_b128 v[236:239], v1 offset:9216
    ds_read_b128 v[240:243], v0 offset:10240
    ds_read_b128 v[244:247], v1 offset:10240
    ds_read_b128 v[248:251], v0 offset:11264
    ds_read_b128 v[252:255], v1 offset:11264
    s_waitcnt vmcnt(8)
    ds_read_b128 v[168:171], v22 offset:0
    ds_read_b128 v[172:175], v23 offset:0
    ds_read_b128 v[176:179], v22 offset:1024
    ds_read_b128 v[16:19], v23 offset:1024
    ds_read_b128 v[28:31], v22 offset:2048
    ds_read_b128 v[32:35], v23 offset:2048
    ds_read_b128 v[44:47], v22 offset:3072
    ds_read_b128 v[84:87], v23 offset:3072
    s_waitcnt lgkmcnt(0)
    s_add_u32 s33, s49, 0
    s_add_u32 m0, s27, 0
    s_nop 0
    buffer_load_dwordx4 v4, s[4:7], s33 offen offset:0 nt lds
    v_lshlrev_b32 v56, 16, v168
    v_and_b32 v57, s53, v168
    v_lshlrev_b32 v58, 16, v169
    v_and_b32 v59, s53, v169
    v_lshlrev_b32 v60, 16, v170
    v_and_b32 v61, s53, v170
    v_lshlrev_b32 v62, 16, v171
    v_and_b32 v63, s53, v171
    v_pk_mul_f32 v[56:57], v[56:57], s[20:21] op_sel:[0,0] op_sel_hi:[1,0]
    v_pk_mul_f32 v[58:59], v[58:59], s[20:21] op_sel:[0,0] op_sel_hi:[1,0]
    v_pk_mul_f32 v[60:61], v[60:61], s[20:21] op_sel:[0,0] op_sel_hi:[1,0]
    v_pk_mul_f32 v[62:63], v[62:63], s[20:21] op_sel:[0,0] op_sel_hi:[1,0]
    v_cvt_pk_bf16_f32 v168, v56, v57
    v_cvt_pk_bf16_f32 v169, v58, v59
    v_cvt_pk_bf16_f32 v170, v60, v61
    v_cvt_pk_bf16_f32 v171, v62, v63
    v_lshlrev_b32 v64, 16, v172
    v_and_b32 v65, s53, v172
    v_mfma_f32_16x16x32_bf16 v[48:51], v[192:195], v[168:171], 0
    v_lshlrev_b32 v66, 16, v173
    v_and_b32 v67, s53, v173
    v_mfma_f32_16x16x32_bf16 v[88:91], v[224:227], v[168:171], 0
    s_add_u32 m0, s27, 896
    s_nop 0
    buffer_load_dwordx4 v4, s[4:7], s33 offen offset:128 nt lds
    v_lshlrev_b32 v68, 16, v174
    v_and_b32 v69, s53, v174
    v_lshlrev_b32 v70, 16, v175
    v_and_b32 v71, s53, v175
    v_pk_mul_f32 v[64:65], v[64:65], s[20:21] op_sel:[0,0] op_sel_hi:[1,0]
    v_pk_mul_f32 v[66:67], v[66:67], s[20:21] op_sel:[0,0] op_sel_hi:[1,0]
    v_pk_mul_f32 v[68:69], v[68:69], s[20:21] op_sel:[0,0] op_sel_hi:[1,0]
    v_pk_mul_f32 v[70:71], v[70:71], s[20:21] op_sel:[0,0] op_sel_hi:[1,0]
    v_cvt_pk_bf16_f32 v172, v64, v65
    v_cvt_pk_bf16_f32 v173, v66, v67
    v_cvt_pk_bf16_f32 v174, v68, v69
    v_cvt_pk_bf16_f32 v175, v70, v71
    v_lshlrev_b32 v56, 16, v176
    v_and_b32 v57, s53, v176
    v_mfma_f32_16x16x32_bf16 v[48:51], v[196:199], v[172:175], v[48:51]
    v_lshlrev_b32 v58, 16, v177
    v_and_b32 v59, s53, v177
    v_mfma_f32_16x16x32_bf16 v[88:91], v[228:231], v[172:175], v[88:91]
    v_lshlrev_b32 v60, 16, v178
    v_and_b32 v61, s53, v178
    v_lshlrev_b32 v62, 16, v179
    v_and_b32 v63, s53, v179
    s_add_u32 m0, s27, 1792
    s_nop 0
    buffer_load_dwordx4 v4, s[4:7], s33 offen offset:256 nt lds
    v_pk_mul_f32 v[56:57], v[56:57], s[20:21] op_sel:[0,0] op_sel_hi:[1,0]
    v_pk_mul_f32 v[58:59], v[58:59], s[20:21] op_sel:[0,0] op_sel_hi:[1,0]
    v_pk_mul_f32 v[60:61], v[60:61], s[20:21] op_sel:[0,0] op_sel_hi:[1,0]
    v_pk_mul_f32 v[62:63], v[62:63], s[20:21] op_sel:[0,0] op_sel_hi:[1,0]
    v_cvt_pk_bf16_f32 v176, v56, v57
    v_cvt_pk_bf16_f32 v177, v58, v59
    v_cvt_pk_bf16_f32 v178, v60, v61
    v_cvt_pk_bf16_f32 v179, v62, v63
    v_lshlrev_b32 v64, 16, v16
    v_and_b32 v65, s53, v16
    v_mfma_f32_16x16x32_bf16 v[48:51], v[200:203], v[176:179], v[48:51]
    v_lshlrev_b32 v66, 16, v17
    v_and_b32 v67, s53, v17
    v_mfma_f32_16x16x32_bf16 v[88:91], v[232:235], v[176:179], v[88:91]
    v_lshlrev_b32 v68, 16, v18
    v_and_b32 v69, s53, v18
    v_lshlrev_b32 v70, 16, v19
    v_and_b32 v71, s53, v19
    v_pk_mul_f32 v[64:65], v[64:65], s[20:21] op_sel:[0,0] op_sel_hi:[1,0]
    v_pk_mul_f32 v[66:67], v[66:67], s[20:21] op_sel:[0,0] op_sel_hi:[1,0]
    v_pk_mul_f32 v[68:69], v[68:69], s[20:21] op_sel:[0,0] op_sel_hi:[1,0]
    v_pk_mul_f32 v[70:71], v[70:71], s[20:21] op_sel:[0,0] op_sel_hi:[1,0]
    s_add_u32 m0, s27, 2688
    s_nop 0
    buffer_load_dwordx4 v4, s[4:7], s33 offen offset:384 nt lds
    v_cvt_pk_bf16_f32 v16, v64, v65
    v_cvt_pk_bf16_f32 v17, v66, v67
    v_cvt_pk_bf16_f32 v18, v68, v69
    v_cvt_pk_bf16_f32 v19, v70, v71
    v_lshlrev_b32 v56, 16, v28
    v_and_b32 v57, s53, v28
    v_mfma_f32_16x16x32_bf16 v[48:51], v[204:207], v[16:19], v[48:51]
    ds_write_b128 v3, v[16:19] offset:0
    v_lshlrev_b32 v58, 16, v29
    v_and_b32 v59, s53, v29
    v_mfma_f32_16x16x32_bf16 v[88:91], v[236:239], v[16:19], v[88:91]
    v_lshlrev_b32 v60, 16, v30
    v_and_b32 v61, s53, v30
    v_lshlrev_b32 v62, 16, v31
    v_and_b32 v63, s53, v31
    v_pk_mul_f32 v[56:57], v[56:57], s[20:21] op_sel:[0,0] op_sel_hi:[1,0]
    v_pk_mul_f32 v[58:59], v[58:59], s[20:21] op_sel:[0,0] op_sel_hi:[1,0]
    v_pk_mul_f32 v[60:61], v[60:61], s[20:21] op_sel:[0,0] op_sel_hi:[1,0]
    v_pk_mul_f32 v[62:63], v[62:63], s[20:21] op_sel:[0,0] op_sel_hi:[1,0]
    v_cvt_pk_bf16_f32 v28, v56, v57
    v_cvt_pk_bf16_f32 v29, v58, v59
    v_cvt_pk_bf16_f32 v30, v60, v61
    s_add_u32 s33, s49, 4096
    s_add_u32 m0, s27, 49152
    s_nop 0
    buffer_load_dwordx4 v4, s[4:7], s33 offen offset:0 nt lds
    v_cvt_pk_bf16_f32 v31, v62, v63
    v_lshlrev_b32 v64, 16, v32
    v_and_b32 v65, s53, v32
    v_mfma_f32_16x16x32_bf16 v[48:51], v[208:211], v[28:31], v[48:51]
    ds_write_b128 v3, v[28:31] offset:1024
    v_lshlrev_b32 v66, 16, v33
    v_and_b32 v67, s53, v33
    v_mfma_f32_16x16x32_bf16 v[88:91], v[240:243], v[28:31], v[88:91]
    v_lshlrev_b32 v68, 16, v34
    v_and_b32 v69, s53, v34
    v_lshlrev_b32 v70, 16, v35
    v_and_b32 v71, s53, v35
    v_pk_mul_f32 v[64:65], v[64:65], s[20:21] op_sel:[0,0] op_sel_hi:[1,0]
    v_pk_mul_f32 v[66:67], v[66:67], s[20:21] op_sel:[0,0] op_sel_hi:[1,0]
    v_pk_mul_f32 v[68:69], v[68:69], s[20:21] op_sel:[0,0] op_sel_hi:[1,0]
    v_pk_mul_f32 v[70:71], v[70:71], s[20:21] op_sel:[0,0] op_sel_hi:[1,0]
    v_cvt_pk_bf16_f32 v32, v64, v65
    v_cvt_pk_bf16_f32 v33, v66, v67
    v_cvt_pk_bf16_f32 v34, v68, v69
    v_cvt_pk_bf16_f32 v35, v70, v71
    v_lshlrev_b32 v56, 16, v44
    v_and_b32 v57, s53, v44
    s_add_u32 m0, s27, 50048
    s_nop 0
    buffer_load_dwordx4 v4, s[4:7], s33 offen offset:128 nt lds
    v_mfma_f32_16x16x32_bf16 v[48:51], v[212:215], v[32:35], v[48:51]
    ds_write_b128 v3, v[32:35] offset:2048
    v_lshlrev_b32 v58, 16, v45
    v_and_b32 v59, s53, v45
    v_mfma_f32_16x16x32_bf16 v[88:91], v[244:247], v[32:35], v[88:91]
    v_lshlrev_b32 v60, 16, v46
    v_and_b32 v61, s53, v46
    v_lshlrev_b32 v62, 16, v47
    v_and_b32 v63, s53, v47
    v_pk_mul_f32 v[56:57], v[56:57], s[20:21] op_sel:[0,0] op_sel_hi:[1,0]
    v_pk_mul_f32 v[58:59], v[58:59], s[20:21] op_sel:[0,0] op_sel_hi:[1,0]
    v_pk_mul_f32 v[60:61], v[60:61], s[20:21] op_sel:[0,0] op_sel_hi:[1,0]
    v_pk_mul_f32 v[62:63], v[62:63], s[20:21] op_sel:[0,0] op_sel_hi:[1,0]
    v_cvt_pk_bf16_f32 v44, v56, v57
    v_cvt_pk_bf16_f32 v45, v58, v59
    v_cvt_pk_bf16_f32 v46, v60, v61
    v_cvt_pk_bf16_f32 v47, v62, v63
    v_lshlrev_b32 v64, 16, v84
    v_and_b32 v65, s53, v84
    v_mfma_f32_16x16x32_bf16 v[48:51], v[216:219], v[44:47], v[48:51]
    ds_write_b128 v3, v[44:47] offset:3072
    v_lshlrev_b32 v66, 16, v85
    s_add_u32 m0, s27, 50944
    s_nop 0
    buffer_load_dwordx4 v4, s[4:7], s33 offen offset:256 nt lds
    v_and_b32 v67, s53, v85
    v_mfma_f32_16x16x32_bf16 v[88:91], v[248:251], v[44:47], v[88:91]
    v_lshlrev_b32 v68, 16, v86
    v_and_b32 v69, s53, v86
    v_lshlrev_b32 v70, 16, v87
    v_and_b32 v71, s53, v87
    v_pk_mul_f32 v[64:65], v[64:65], s[20:21] op_sel:[0,0] op_sel_hi:[1,0]
    v_pk_mul_f32 v[66:67], v[66:67], s[20:21] op_sel:[0,0] op_sel_hi:[1,0]
    v_pk_mul_f32 v[68:69], v[68:69], s[20:21] op_sel:[0,0] op_sel_hi:[1,0]
    v_pk_mul_f32 v[70:71], v[70:71], s[20:21] op_sel:[0,0] op_sel_hi:[1,0]
    v_cvt_pk_bf16_f32 v84, v64, v65
    v_cvt_pk_bf16_f32 v85, v66, v67
    v_cvt_pk_bf16_f32 v86, v68, v69
    v_cvt_pk_bf16_f32 v87, v70, v71
    s_nop 1
    v_mfma_f32_16x16x32_bf16 v[48:51], v[220:223], v[84:87], v[48:51]
    ds_write_b128 v3, v[84:87] offset:4096
    v_mfma_f32_16x16x32_bf16 v[88:91], v[252:255], v[84:87], v[88:91]
    s_nop 7
    v_max3_f32 v72, v48, v49, v50
    v_max3_f32 v72, v72, v51, v88
    v_max3_f32 v72, v72, v89, v90
    s_add_u32 m0, s27, 51840
    s_nop 0
    buffer_load_dwordx4 v4, s[4:7], s33 offen offset:384 nt lds
    v_max_f32 v72, v72, v91
    v_mov_b32 v73, v72
    v_mov_b32 v74, v72
    s_nop 1
    v_permlane32_swap_b32 v73, v74
    s_nop 1
    v_max_f32 v72, v73, v74
    v_mov_b32 v73, v72
    v_mov_b32 v74, v72
    s_nop 1
    v_permlane16_swap_b32 v73, v74
    s_nop 1
    v_max_f32 v72, v73, v74
    v_sub_f32 v6, 0, v72
    v_sub_f32 v7, 0, v72
    v_sub_f32 v8, 0, v72
    v_sub_f32 v9, 0, v72
    v_add_f32 v48, v48, v6
    v_exp_f32 v48, v48
    v_add_f32 v49, v49, v6
    v_exp_f32 v49, v49
    v_add_f32 v50, v50, v6
    v_exp_f32 v50, v50
    v_add_f32 v51, v51, v6
    v_exp_f32 v51, v51
    v_add_f32 v5, v48, v49
    v_cvt_pk_bf16_f32 v48, v48, v49
    v_cvt_pk_bf16_f32 v49, v50, v51
    v_add_f32 v50, v50, v51
    v_add_f32 v50, v50, v5
    v_add_f32 v88, v88, v6
    v_exp_f32 v88, v88
    v_add_f32 v89, v89, v6
    v_exp_f32 v89, v89
    v_add_f32 v90, v90, v6
    v_exp_f32 v90, v90
    v_add_f32 v91, v91, v6
    v_exp_f32 v91, v91
    v_add_f32 v51, v50, v88
    v_cvt_pk_bf16_f32 v50, v88, v89
    v_add_f32 v88, v51, v89
    v_add_f32 v88, v88, v90
    v_cvt_pk_bf16_f32 v51, v90, v91
    v_add_f32 v88, v88, v91
    s_waitcnt vmcnt(8)
    ds_read_b128 v[180:183], v22 offset:8192
    ds_read_b128 v[184:187], v23 offset:8192
    ds_read_b128 v[188:191], v22 offset:9216
    ds_read_b128 v[16:19], v23 offset:9216
    ds_read_b128 v[28:31], v22 offset:10240
    ds_read_b128 v[32:35], v23 offset:10240
    ds_read_b128 v[44:47], v22 offset:11264
    ds_read_b128 v[84:87], v23 offset:11264
    s_waitcnt lgkmcnt(0)
    s_add_u32 s33, s49, 8192
    s_add_u32 m0, s26, 0
    s_nop 0
    buffer_load_dwordx4 v4, s[4:7], s33 offen offset:0 nt lds
    v_lshlrev_b32 v56, 16, v180
    v_and_b32 v57, s53, v180
    v_lshlrev_b32 v58, 16, v181
    v_and_b32 v59, s53, v181
    v_lshlrev_b32 v60, 16, v182
    v_and_b32 v61, s53, v182
    v_lshlrev_b32 v62, 16, v183
    v_and_b32 v63, s53, v183
    v_pk_mul_f32 v[56:57], v[56:57], s[20:21] op_sel:[0,0] op_sel_hi:[1,0]
    v_pk_mul_f32 v[58:59], v[58:59], s[20:21] op_sel:[0,0] op_sel_hi:[1,0]
    v_pk_mul_f32 v[60:61], v[60:61], s[20:21] op_sel:[0,0] op_sel_hi:[1,0]
    v_pk_mul_f32 v[62:63], v[62:63], s[20:21] op_sel:[0,0] op_sel_hi:[1,0]
    v_cvt_pk_bf16_f32 v180, v56, v57
    v_cvt_pk_bf16_f32 v181, v58, v59
    v_cvt_pk_bf16_f32 v182, v60, v61
    v_cvt_pk_bf16_f32 v183, v62, v63
    v_lshlrev_b32 v64, 16, v184
    v_and_b32 v65, s53, v184
    v_mfma_f32_16x16x32_bf16 v[52:55], v[192:195], v[180:183], v[6:9]
    v_lshlrev_b32 v66, 16, v185
    v_and_b32 v67, s53, v185
    s_add_u32 m0, s26, 896
    s_nop 0
    buffer_load_dwordx4 v4, s[4:7], s33 offen offset:128 nt lds
    v_mfma_f32_16x16x32_bf16 v[92:95], v[224:227], v[180:183], v[6:9]
    v_lshlrev_b32 v68, 16, v186
    v_and_b32 v69, s53, v186
    v_lshlrev_b32 v70, 16, v187
    v_and_b32 v71, s53, v187
    v_pk_mul_f32 v[64:65], v[64:65], s[20:21] op_sel:[0,0] op_sel_hi:[1,0]
    v_pk_mul_f32 v[66:67], v[66:67], s[20:21] op_sel:[0,0] op_sel_hi:[1,0]
    v_pk_mul_f32 v[68:69], v[68:69], s[20:21] op_sel:[0,0] op_sel_hi:[1,0]
    v_pk_mul_f32 v[70:71], v[70:71], s[20:21] op_sel:[0,0] op_sel_hi:[1,0]
    v_cvt_pk_bf16_f32 v184, v64, v65
    v_cvt_pk_bf16_f32 v185, v66, v67
    v_cvt_pk_bf16_f32 v186, v68, v69
    v_cvt_pk_bf16_f32 v187, v70, v71
    v_lshlrev_b32 v56, 16, v188
    v_and_b32 v57, s53, v188
    v_mfma_f32_16x16x32_bf16 v[52:55], v[196:199], v[184:187], v[52:55]
    v_lshlrev_b32 v58, 16, v189
    v_and_b32 v59, s53, v189
    v_mfma_f32_16x16x32_bf16 v[92:95], v[228:231], v[184:187], v[92:95]
    v_lshlrev_b32 v60, 16, v190
    v_and_b32 v61, s53, v190
    s_add_u32 m0, s26, 1792
    s_nop 0
    buffer_load_dwordx4 v4, s[4:7], s33 offen offset:256 nt lds
    v_lshlrev_b32 v62, 16, v191
    v_and_b32 v63, s53, v191
    v_pk_mul_f32 v[56:57], v[56:57], s[20:21] op_sel:[0,0] op_sel_hi:[1,0]
    v_pk_mul_f32 v[58:59], v[58:59], s[20:21] op_sel:[0,0] op_sel_hi:[1,0]
    v_pk_mul_f32 v[60:61], v[60:61], s[20:21] op_sel:[0,0] op_sel_hi:[1,0]
    v_pk_mul_f32 v[62:63], v[62:63], s[20:21] op_sel:[0,0] op_sel_hi:[1,0]
    v_cvt_pk_bf16_f32 v188, v56, v57
    v_cvt_pk_bf16_f32 v189, v58, v59
    v_cvt_pk_bf16_f32 v190, v60, v61
    v_cvt_pk_bf16_f32 v191, v62, v63
    v_lshlrev_b32 v64, 16, v16
    v_and_b32 v65, s53, v16
    v_mfma_f32_16x16x32_bf16 v[52:55], v[200:203], v[188:191], v[52:55]
    v_lshlrev_b32 v66, 16, v17
    v_and_b32 v67, s53, v17
    v_mfma_f32_16x16x32_bf16 v[92:95], v[232:235], v[188:191], v[92:95]
    v_lshlrev_b32 v68, 16, v18
    v_and_b32 v69, s53, v18
    v_lshlrev_b32 v70, 16, v19
    v_and_b32 v71, s53, v19
    v_pk_mul_f32 v[64:65], v[64:65], s[20:21] op_sel:[0,0] op_sel_hi:[1,0]
    s_add_u32 m0, s26, 2688
    s_nop 0
    buffer_load_dwordx4 v4, s[4:7], s33 offen offset:384 nt lds
    v_pk_mul_f32 v[66:67], v[66:67], s[20:21] op_sel:[0,0] op_sel_hi:[1,0]
    v_pk_mul_f32 v[68:69], v[68:69], s[20:21] op_sel:[0,0] op_sel_hi:[1,0]
    v_pk_mul_f32 v[70:71], v[70:71], s[20:21] op_sel:[0,0] op_sel_hi:[1,0]
    v_cvt_pk_bf16_f32 v16, v64, v65
    v_cvt_pk_bf16_f32 v17, v66, v67
    v_cvt_pk_bf16_f32 v18, v68, v69
    v_cvt_pk_bf16_f32 v19, v70, v71
    v_lshlrev_b32 v56, 16, v28
    v_and_b32 v57, s53, v28
    v_mfma_f32_16x16x32_bf16 v[52:55], v[204:207], v[16:19], v[52:55]
    ds_write_b128 v3, v[16:19] offset:8192
    v_lshlrev_b32 v58, 16, v29
    v_and_b32 v59, s53, v29
    v_mfma_f32_16x16x32_bf16 v[92:95], v[236:239], v[16:19], v[92:95]
    v_lshlrev_b32 v60, 16, v30
    v_and_b32 v61, s53, v30
    v_lshlrev_b32 v62, 16, v31
    v_and_b32 v63, s53, v31
    v_pk_mul_f32 v[56:57], v[56:57], s[20:21] op_sel:[0,0] op_sel_hi:[1,0]
    v_pk_mul_f32 v[58:59], v[58:59], s[20:21] op_sel:[0,0] op_sel_hi:[1,0]
    v_pk_mul_f32 v[60:61], v[60:61], s[20:21] op_sel:[0,0] op_sel_hi:[1,0]
    s_add_u32 s33, s49, 12288
    s_add_u32 m0, s26, 49152
    s_nop 0
    buffer_load_dwordx4 v4, s[4:7], s33 offen offset:0 nt lds
    v_pk_mul_f32 v[62:63], v[62:63], s[20:21] op_sel:[0,0] op_sel_hi:[1,0]
    v_cvt_pk_bf16_f32 v28, v56, v57
    v_cvt_pk_bf16_f32 v29, v58, v59
    v_cvt_pk_bf16_f32 v30, v60, v61
    v_cvt_pk_bf16_f32 v31, v62, v63
    v_lshlrev_b32 v64, 16, v32
    v_and_b32 v65, s53, v32
    v_mfma_f32_16x16x32_bf16 v[52:55], v[208:211], v[28:31], v[52:55]
    ds_write_b128 v3, v[28:31] offset:9216
    v_lshlrev_b32 v66, 16, v33
    v_and_b32 v67, s53, v33
    v_mfma_f32_16x16x32_bf16 v[92:95], v[240:243], v[28:31], v[92:95]
    v_lshlrev_b32 v68, 16, v34
    v_and_b32 v69, s53, v34
    v_lshlrev_b32 v70, 16, v35
    v_and_b32 v71, s53, v35
    v_pk_mul_f32 v[64:65], v[64:65], s[20:21] op_sel:[0,0] op_sel_hi:[1,0]
    v_pk_mul_f32 v[66:67], v[66:67], s[20:21] op_sel:[0,0] op_sel_hi:[1,0]
    v_pk_mul_f32 v[68:69], v[68:69], s[20:21] op_sel:[0,0] op_sel_hi:[1,0]
    v_pk_mul_f32 v[70:71], v[70:71], s[20:21] op_sel:[0,0] op_sel_hi:[1,0]
    v_cvt_pk_bf16_f32 v32, v64, v65
    s_add_u32 m0, s26, 50048
    s_nop 0
    buffer_load_dwordx4 v4, s[4:7], s33 offen offset:128 nt lds
    v_cvt_pk_bf16_f32 v33, v66, v67
    v_cvt_pk_bf16_f32 v34, v68, v69
    v_cvt_pk_bf16_f32 v35, v70, v71
    v_lshlrev_b32 v56, 16, v44
    v_and_b32 v57, s53, v44
    v_mfma_f32_16x16x32_bf16 v[52:55], v[212:215], v[32:35], v[52:55]
    ds_write_b128 v3, v[32:35] offset:10240
    v_lshlrev_b32 v58, 16, v45
    v_and_b32 v59, s53, v45
    v_mfma_f32_16x16x32_bf16 v[92:95], v[244:247], v[32:35], v[92:95]
    v_lshlrev_b32 v60, 16, v46
    v_and_b32 v61, s53, v46
    v_lshlrev_b32 v62, 16, v47
    v_and_b32 v63, s53, v47
    v_pk_mul_f32 v[56:57], v[56:57], s[20:21] op_sel:[0,0] op_sel_hi:[1,0]
    v_pk_mul_f32 v[58:59], v[58:59], s[20:21] op_sel:[0,0] op_sel_hi:[1,0]
    v_pk_mul_f32 v[60:61], v[60:61], s[20:21] op_sel:[0,0] op_sel_hi:[1,0]
    v_pk_mul_f32 v[62:63], v[62:63], s[20:21] op_sel:[0,0] op_sel_hi:[1,0]
    v_cvt_pk_bf16_f32 v44, v56, v57
    v_cvt_pk_bf16_f32 v45, v58, v59
    v_cvt_pk_bf16_f32 v46, v60, v61
    s_add_u32 m0, s26, 50944
    s_nop 0
    buffer_load_dwordx4 v4, s[4:7], s33 offen offset:256 nt lds
    v_cvt_pk_bf16_f32 v47, v62, v63
    v_lshlrev_b32 v64, 16, v84
    v_and_b32 v65, s53, v84
    v_mfma_f32_16x16x32_bf16 v[52:55], v[216:219], v[44:47], v[52:55]
    ds_write_b128 v3, v[44:47] offset:11264
    v_lshlrev_b32 v66, 16, v85
    v_and_b32 v67, s53, v85
    v_mfma_f32_16x16x32_bf16 v[92:95], v[248:251], v[44:47], v[92:95]
    v_lshlrev_b32 v68, 16, v86
    v_and_b32 v69, s53, v86
    v_lshlrev_b32 v70, 16, v87
    v_and_b32 v71, s53, v87
    v_pk_mul_f32 v[64:65], v[64:65], s[20:21] op_sel:[0,0] op_sel_hi:[1,0]
    v_pk_mul_f32 v[66:67], v[66:67], s[20:21] op_sel:[0,0] op_sel_hi:[1,0]
    v_pk_mul_f32 v[68:69], v[68:69], s[20:21] op_sel:[0,0] op_sel_hi:[1,0]
    v_pk_mul_f32 v[70:71], v[70:71], s[20:21] op_sel:[0,0] op_sel_hi:[1,0]
    v_cvt_pk_bf16_f32 v84, v64, v65
    v_cvt_pk_bf16_f32 v85, v66, v67
    v_cvt_pk_bf16_f32 v86, v68, v69
    v_cvt_pk_bf16_f32 v87, v70, v71
    s_nop 1
    s_add_u32 m0, s26, 51840
    s_nop 0
    buffer_load_dwordx4 v4, s[4:7], s33 offen offset:384 nt lds
    v_mfma_f32_16x16x32_bf16 v[52:55], v[220:223], v[84:87], v[52:55]
    ds_write_b128 v3, v[84:87] offset:12288
    v_mfma_f32_16x16x32_bf16 v[92:95], v[252:255], v[84:87], v[92:95]
    s_nop 7
    v_max3_f32 v72, v52, v53, v54
    v_max3_f32 v72, v72, v55, v92
    v_max3_f32 v72, v72, v93, v94
    v_max_f32 v72, v72, v95
    v_exp_f32 v52, v52
    v_exp_f32 v53, v53
    v_exp_f32 v54, v54
    v_exp_f32 v55, v55
    v_add_f32 v5, v52, v53
    v_cvt_pk_bf16_f32 v52, v52, v53
    v_cvt_pk_bf16_f32 v53, v54, v55
    v_add_f32 v54, v54, v55
    v_add_f32 v54, v54, v5
    v_exp_f32 v92, v92
    v_exp_f32 v93, v93
    v_exp_f32 v94, v94
    v_exp_f32 v95, v95
    v_add_f32 v55, v54, v92
    v_cvt_pk_bf16_f32 v54, v92, v93
    v_add_f32 v92, v55, v93
    v_add_f32 v92, v92, v94
    v_cvt_pk_bf16_f32 v55, v94, v95
    v_add_f32 v92, v92, v95
    v_mov_b32 v73, v72
    v_mov_b32 v74, v72
    s_nop 1
    v_permlane32_swap_b32 v73, v74
    s_nop 1
    v_max_f32 v72, v73, v74
    v_mov_b32 v73, v72
    v_mov_b32 v74, v72
    s_nop 1
    v_permlane16_swap_b32 v73, v74
    s_nop 1
    v_max_f32 v72, v73, v74
    v_cmp_nle_f32 vcc, s52, v72
    s_and_b64 vcc, vcc, s[54:55]
    s_or_b64 s[50:51], s[50:51], vcc
    s_waitcnt vmcnt(8)
    ds_read_b128 v[96:99], v24 offset:16384
    ds_read_b128 v[100:103], v25 offset:16384
    ds_read_b128 v[104:107], v24 offset:17408
    ds_read_b128 v[108:111], v25 offset:17408
    ds_read_b128 v[112:115], v24 offset:18432
    ds_read_b128 v[116:119], v25 offset:18432
    ds_read_b128 v[120:123], v24 offset:19456
    ds_read_b128 v[124:127], v25 offset:19456
    s_waitcnt lgkmcnt(0)
    s_add_u32 s33, s49, 16384
    s_add_u32 m0, s27, 0
    s_nop 0
    buffer_load_dwordx4 v4, s[4:7], s33 offen offset:0 nt lds
    v_lshlrev_b32 v56, 16, v96
    v_and_b32 v57, s53, v96
    v_lshlrev_b32 v58, 16, v97
    v_and_b32 v59, s53, v97
    v_lshlrev_b32 v60, 16, v98
    v_and_b32 v61, s53, v98
    v_lshlrev_b32 v62, 16, v99
    v_and_b32 v63, s53, v99
    v_pk_mul_f32 v[56:57], v[56:57], s[20:21] op_sel:[0,0] op_sel_hi:[1,0]
    v_pk_mul_f32 v[58:59], v[58:59], s[20:21] op_sel:[0,0] op_sel_hi:[1,0]
    v_pk_mul_f32 v[60:61], v[60:61], s[20:21] op_sel:[0,0] op_sel_hi:[1,0]
    v_pk_mul_f32 v[62:63], v[62:63], s[20:21] op_sel:[0,0] op_sel_hi:[1,0]
    v_cvt_pk_bf16_f32 v96, v56, v57
    v_cvt_pk_bf16_f32 v97, v58, v59
    v_cvt_pk_bf16_f32 v98, v60, v61
    v_cvt_pk_bf16_f32 v99, v62, v63
    v_lshlrev_b32 v64, 16, v100
    v_and_b32 v65, s53, v100
    v_mfma_f32_16x16x32_bf16 v[36:39], v[192:195], v[96:99], v[6:9]
    s_add_u32 m0, s27, 896
    s_nop 0
    buffer_load_dwordx4 v4, s[4:7], s33 offen offset:128 nt lds
    v_lshlrev_b32 v66, 16, v101
    v_and_b32 v67, s53, v101
    v_mfma_f32_16x16x32_bf16 v[76:79], v[224:227], v[96:99], v[6:9]
    v_lshlrev_b32 v68, 16, v102
    v_and_b32 v69, s53, v102
    v_lshlrev_b32 v70, 16, v103
    v_and_b32 v71, s53, v103
    v_pk_mul_f32 v[64:65], v[64:65], s[20:21] op_sel:[0,0] op_sel_hi:[1,0]
    v_pk_mul_f32 v[66:67], v[66:67], s[20:21] op_sel:[0,0] op_sel_hi:[1,0]
    v_pk_mul_f32 v[68:69], v[68:69], s[20:21] op_sel:[0,0] op_sel_hi:[1,0]
    v_pk_mul_f32 v[70:71], v[70:71], s[20:21] op_sel:[0,0] op_sel_hi:[1,0]
    v_cvt_pk_bf16_f32 v100, v64, v65
    v_cvt_pk_bf16_f32 v101, v66, v67
    v_cvt_pk_bf16_f32 v102, v68, v69
    v_cvt_pk_bf16_f32 v103, v70, v71
    v_lshlrev_b32 v56, 16, v104
    v_and_b32 v57, s53, v104
    v_mfma_f32_16x16x32_bf16 v[36:39], v[196:199], v[100:103], v[36:39]
    v_lshlrev_b32 v58, 16, v105
    s_add_u32 m0, s27, 1792
    s_nop 0
    buffer_load_dwordx4 v4, s[4:7], s33 offen offset:256 nt lds
    v_and_b32 v59, s53, v105
    v_mfma_f32_16x16x32_bf16 v[76:79], v[228:231], v[100:103], v[76:79]
    v_lshlrev_b32 v60, 16, v106
    v_and_b32 v61, s53, v106
    v_lshlrev_b32 v62, 16, v107
    v_and_b32 v63, s53, v107
    v_pk_mul_f32 v[56:57], v[56:57], s[20:21] op_sel:[0,0] op_sel_hi:[1,0]
    v_pk_mul_f32 v[58:59], v[58:59], s[20:21] op_sel:[0,0] op_sel_hi:[1,0]
    v_pk_mul_f32 v[60:61], v[60:61], s[20:21] op_sel:[0,0] op_sel_hi:[1,0]
    v_pk_mul_f32 v[62:63], v[62:63], s[20:21] op_sel:[0,0] op_sel_hi:[1,0]
    v_cvt_pk_bf16_f32 v104, v56, v57
    v_cvt_pk_bf16_f32 v105, v58, v59
    v_cvt_pk_bf16_f32 v106, v60, v61
    v_cvt_pk_bf16_f32 v107, v62, v63
    v_lshlrev_b32 v64, 16, v108
    v_and_b32 v65, s53, v108
    v_mfma_f32_16x16x32_bf16 v[36:39], v[200:203], v[104:107], v[36:39]
    v_lshlrev_b32 v66, 16, v109
    v_and_b32 v67, s53, v109
    s_add_u32 m0, s27, 2688
    s_nop 0
    buffer_load_dwordx4 v4, s[4:7], s33 offen offset:384 nt lds
    v_mfma_f32_16x16x32_bf16 v[76:79], v[232:235], v[104:107], v[76:79]
    v_lshlrev_b32 v68, 16, v110
    v_and_b32 v69, s53, v110
    v_lshlrev_b32 v70, 16, v111
    v_and_b32 v71, s53, v111
    v_pk_mul_f32 v[64:65], v[64:65], s[20:21] op_sel:[0,0] op_sel_hi:[1,0]
    v_pk_mul_f32 v[66:67], v[66:67], s[20:21] op_sel:[0,0] op_sel_hi:[1,0]
    v_pk_mul_f32 v[68:69], v[68:69], s[20:21] op_sel:[0,0] op_sel_hi:[1,0]
    v_pk_mul_f32 v[70:71], v[70:71], s[20:21] op_sel:[0,0] op_sel_hi:[1,0]
    v_cvt_pk_bf16_f32 v108, v64, v65
    v_cvt_pk_bf16_f32 v109, v66, v67
    v_cvt_pk_bf16_f32 v110, v68, v69
    v_cvt_pk_bf16_f32 v111, v70, v71
    v_lshlrev_b32 v56, 16, v112
    v_and_b32 v57, s53, v112
    v_mfma_f32_16x16x32_bf16 v[36:39], v[204:207], v[108:111], v[36:39]
    v_lshlrev_b32 v58, 16, v113
    v_and_b32 v59, s53, v113
    v_mfma_f32_16x16x32_bf16 v[76:79], v[236:239], v[108:111], v[76:79]
    s_add_u32 s33, s49, 20480
    s_add_u32 m0, s27, 49152
    s_nop 0
    buffer_load_dwordx4 v4, s[4:7], s33 offen offset:0 nt lds
    v_lshlrev_b32 v60, 16, v114
    v_and_b32 v61, s53, v114
    v_lshlrev_b32 v62, 16, v115
    v_and_b32 v63, s53, v115
    v_pk_mul_f32 v[56:57], v[56:57], s[20:21] op_sel:[0,0] op_sel_hi:[1,0]
    v_pk_mul_f32 v[58:59], v[58:59], s[20:21] op_sel:[0,0] op_sel_hi:[1,0]
    v_pk_mul_f32 v[60:61], v[60:61], s[20:21] op_sel:[0,0] op_sel_hi:[1,0]
    v_pk_mul_f32 v[62:63], v[62:63], s[20:21] op_sel:[0,0] op_sel_hi:[1,0]
    v_cvt_pk_bf16_f32 v112, v56, v57
    v_cvt_pk_bf16_f32 v113, v58, v59
    v_cvt_pk_bf16_f32 v114, v60, v61
    v_cvt_pk_bf16_f32 v115, v62, v63
    v_lshlrev_b32 v64, 16, v116
    v_and_b32 v65, s53, v116
    v_mfma_f32_16x16x32_bf16 v[36:39], v[208:211], v[112:115], v[36:39]
    v_lshlrev_b32 v66, 16, v117
    v_and_b32 v67, s53, v117
    v_mfma_f32_16x16x32_bf16 v[76:79], v[240:243], v[112:115], v[76:79]
    v_lshlrev_b32 v68, 16, v118
    s_add_u32 m0, s27, 50048
    s_nop 0
    buffer_load_dwordx4 v4, s[4:7], s33 offen offset:128 nt lds
    v_and_b32 v69, s53, v118
    v_lshlrev_b32 v70, 16, v119
    v_and_b32 v71, s53, v119
    v_pk_mul_f32 v[64:65], v[64:65], s[20:21] op_sel:[0,0] op_sel_hi:[1,0]
    v_pk_mul_f32 v[66:67], v[66:67], s[20:21] op_sel:[0,0] op_sel_hi:[1,0]
    v_pk_mul_f32 v[68:69], v[68:69], s[20:21] op_sel:[0,0] op_sel_hi:[1,0]
    v_pk_mul_f32 v[70:71], v[70:71], s[20:21] op_sel:[0,0] op_sel_hi:[1,0]
    v_cvt_pk_bf16_f32 v116, v64, v65
    v_cvt_pk_bf16_f32 v117, v66, v67
    v_cvt_pk_bf16_f32 v118, v68, v69
    v_cvt_pk_bf16_f32 v119, v70, v71
    v_lshlrev_b32 v56, 16, v120
    v_and_b32 v57, s53, v120
    v_mfma_f32_16x16x32_bf16 v[36:39], v[212:215], v[116:119], v[36:39]
    v_lshlrev_b32 v58, 16, v121
    v_and_b32 v59, s53, v121
    v_mfma_f32_16x16x32_bf16 v[76:79], v[244:247], v[116:119], v[76:79]
    v_lshlrev_b32 v60, 16, v122
    v_and_b32 v61, s53, v122
    s_add_u32 m0, s27, 50944
    s_nop 0
    buffer_load_dwordx4 v4, s[4:7], s33 offen offset:256 nt lds
    v_lshlrev_b32 v62, 16, v123
    v_and_b32 v63, s53, v123
    v_pk_mul_f32 v[56:57], v[56:57], s[20:21] op_sel:[0,0] op_sel_hi:[1,0]
    v_pk_mul_f32 v[58:59], v[58:59], s[20:21] op_sel:[0,0] op_sel_hi:[1,0]
    v_pk_mul_f32 v[60:61], v[60:61], s[20:21] op_sel:[0,0] op_sel_hi:[1,0]
    v_pk_mul_f32 v[62:63], v[62:63], s[20:21] op_sel:[0,0] op_sel_hi:[1,0]
    v_cvt_pk_bf16_f32 v120, v56, v57
    v_cvt_pk_bf16_f32 v121, v58, v59
    v_cvt_pk_bf16_f32 v122, v60, v61
    v_cvt_pk_bf16_f32 v123, v62, v63
    v_lshlrev_b32 v64, 16, v124
    v_and_b32 v65, s53, v124
    v_mfma_f32_16x16x32_bf16 v[36:39], v[216:219], v[120:123], v[36:39]
    v_lshlrev_b32 v66, 16, v125
    v_and_b32 v67, s53, v125
    v_mfma_f32_16x16x32_bf16 v[76:79], v[248:251], v[120:123], v[76:79]
    v_lshlrev_b32 v68, 16, v126
    v_and_b32 v69, s53, v126
    v_lshlrev_b32 v70, 16, v127
    s_add_u32 m0, s27, 51840
    s_nop 0
    buffer_load_dwordx4 v4, s[4:7], s33 offen offset:384 nt lds
    v_and_b32 v71, s53, v127
    v_pk_mul_f32 v[64:65], v[64:65], s[20:21] op_sel:[0,0] op_sel_hi:[1,0]
    v_pk_mul_f32 v[66:67], v[66:67], s[20:21] op_sel:[0,0] op_sel_hi:[1,0]
    v_pk_mul_f32 v[68:69], v[68:69], s[20:21] op_sel:[0,0] op_sel_hi:[1,0]
    v_pk_mul_f32 v[70:71], v[70:71], s[20:21] op_sel:[0,0] op_sel_hi:[1,0]
    v_cvt_pk_bf16_f32 v124, v64, v65
    v_cvt_pk_bf16_f32 v125, v66, v67
    v_cvt_pk_bf16_f32 v126, v68, v69
    v_cvt_pk_bf16_f32 v127, v70, v71
    s_nop 1
    v_mfma_f32_16x16x32_bf16 v[36:39], v[220:223], v[124:127], v[36:39]
    v_mfma_f32_16x16x32_bf16 v[76:79], v[252:255], v[124:127], v[76:79]
    s_nop 7
    v_max3_f32 v72, v36, v37, v38
    v_max3_f32 v72, v72, v39, v76
    v_max3_f32 v72, v72, v77, v78
    v_max_f32 v72, v72, v79
    v_exp_f32 v36, v36
    v_exp_f32 v37, v37
    v_exp_f32 v38, v38
    v_exp_f32 v39, v39
    v_add_f32 v5, v36, v37
    v_cvt_pk_bf16_f32 v36, v36, v37
    v_cvt_pk_bf16_f32 v37, v38, v39
    v_add_f32 v38, v38, v39
    v_add_f32 v38, v38, v5
    v_exp_f32 v76, v76
    v_exp_f32 v77, v77
    v_exp_f32 v78, v78
    v_exp_f32 v79, v79
    v_mov_b32 v73, v72
    v_mov_b32 v74, v72
    s_nop 1
    v_permlane32_swap_b32 v73, v74
    s_nop 1
    v_max_f32 v72, v73, v74
    v_mov_b32 v73, v72
    v_mov_b32 v74, v72
    s_nop 1
    v_permlane16_swap_b32 v73, v74
    s_nop 1
    v_max_f32 v72, v73, v74
    v_cmp_nle_f32 vcc, s52, v72
    s_or_b64 s[50:51], s[50:51], vcc
    s_waitcnt vmcnt(8)
    ds_read_b128 v[128:131], v24 offset:0
    ds_read_b128 v[132:135], v25 offset:0
    ds_read_b128 v[136:139], v24 offset:1024
    ds_read_b128 v[16:19], v25 offset:1024
    ds_read_b128 v[140:143], v24 offset:2048
    ds_read_b128 v[144:147], v25 offset:2048
    ds_read_b128 v[148:151], v24 offset:3072
    ds_read_b128 v[152:155], v25 offset:3072
    s_waitcnt lgkmcnt(0)
    s_mov_b32 s28, 0
    s_add_u32 m0, s25, 49152
    s_nop 0
    buffer_load_dwordx4 v4, s[12:15], s28 offen offset:0 nt lds
    v_lshlrev_b32 v56, 16, v128
    v_and_b32 v57, s53, v128
    v_lshlrev_b32 v58, 16, v129
    v_and_b32 v59, s53, v129
    v_lshlrev_b32 v60, 16, v130
    v_and_b32 v61, s53, v130
    v_lshlrev_b32 v62, 16, v131
    v_and_b32 v63, s53, v131
    v_pk_mul_f32 v[56:57], v[56:57], s[20:21] op_sel:[0,0] op_sel_hi:[1,0]
    v_pk_mul_f32 v[58:59], v[58:59], s[20:21] op_sel:[0,0] op_sel_hi:[1,0]
    v_pk_mul_f32 v[60:61], v[60:61], s[20:21] op_sel:[0,0] op_sel_hi:[1,0]
    v_pk_mul_f32 v[62:63], v[62:63], s[20:21] op_sel:[0,0] op_sel_hi:[1,0]
    v_cvt_pk_bf16_f32 v128, v56, v57
    v_cvt_pk_bf16_f32 v129, v58, v59
    v_cvt_pk_bf16_f32 v130, v60, v61
    v_cvt_pk_bf16_f32 v131, v62, v63
    v_lshlrev_b32 v64, 16, v132
    v_and_b32 v65, s53, v132
    v_mfma_f32_16x16x32_bf16 v[40:43], v[192:195], v[128:131], v[6:9]
    v_lshlrev_b32 v66, 16, v133
    s_add_u32 m0, s25, 50048
    s_nop 0
    buffer_load_dwordx4 v4, s[12:15], s28 offen offset:128 nt lds
    v_and_b32 v67, s53, v133
    v_mfma_f32_16x16x32_bf16 v[80:83], v[224:227], v[128:131], v[6:9]
    v_lshlrev_b32 v68, 16, v134
    v_and_b32 v69, s53, v134
    v_lshlrev_b32 v70, 16, v135
    v_and_b32 v71, s53, v135
    v_pk_mul_f32 v[64:65], v[64:65], s[20:21] op_sel:[0,0] op_sel_hi:[1,0]
    v_pk_mul_f32 v[66:67], v[66:67], s[20:21] op_sel:[0,0] op_sel_hi:[1,0]
    v_pk_mul_f32 v[68:69], v[68:69], s[20:21] op_sel:[0,0] op_sel_hi:[1,0]
    v_pk_mul_f32 v[70:71], v[70:71], s[20:21] op_sel:[0,0] op_sel_hi:[1,0]
    v_cvt_pk_bf16_f32 v132, v64, v65
    v_cvt_pk_bf16_f32 v133, v66, v67
    v_cvt_pk_bf16_f32 v134, v68, v69
    v_cvt_pk_bf16_f32 v135, v70, v71
    v_lshlrev_b32 v56, 16, v136
    v_and_b32 v57, s53, v136
    v_mfma_f32_16x16x32_bf16 v[40:43], v[196:199], v[132:135], v[40:43]
    v_lshlrev_b32 v58, 16, v137
    v_and_b32 v59, s53, v137
    v_mfma_f32_16x16x32_bf16 v[80:83], v[228:231], v[132:135], v[80:83]
    s_add_u32 m0, s25, 50944
    s_nop 0
    buffer_load_dwordx4 v4, s[12:15], s28 offen offset:256 nt lds
    v_lshlrev_b32 v60, 16, v138
    v_and_b32 v61, s53, v138
    v_lshlrev_b32 v62, 16, v139
    v_and_b32 v63, s53, v139
    v_pk_mul_f32 v[56:57], v[56:57], s[20:21] op_sel:[0,0] op_sel_hi:[1,0]
    v_pk_mul_f32 v[58:59], v[58:59], s[20:21] op_sel:[0,0] op_sel_hi:[1,0]
    v_pk_mul_f32 v[60:61], v[60:61], s[20:21] op_sel:[0,0] op_sel_hi:[1,0]
    v_pk_mul_f32 v[62:63], v[62:63], s[20:21] op_sel:[0,0] op_sel_hi:[1,0]
    v_cvt_pk_bf16_f32 v136, v56, v57
    v_cvt_pk_bf16_f32 v137, v58, v59
    v_cvt_pk_bf16_f32 v138, v60, v61
    v_cvt_pk_bf16_f32 v139, v62, v63
    v_lshlrev_b32 v64, 16, v16
    v_and_b32 v65, s53, v16
    v_mfma_f32_16x16x32_bf16 v[40:43], v[200:203], v[136:139], v[40:43]
    v_lshlrev_b32 v66, 16, v17
    v_and_b32 v67, s53, v17
    v_mfma_f32_16x16x32_bf16 v[80:83], v[232:235], v[136:139], v[80:83]
    v_lshlrev_b32 v68, 16, v18
    v_and_b32 v69, s53, v18
    s_add_u32 m0, s25, 51840
    s_nop 0
    buffer_load_dwordx4 v4, s[12:15], s28 offen offset:384 nt lds
    v_lshlrev_b32 v70, 16, v19
    v_and_b32 v71, s53, v19
    v_pk_mul_f32 v[64:65], v[64:65], s[20:21] op_sel:[0,0] op_sel_hi:[1,0]
    v_pk_mul_f32 v[66:67], v[66:67], s[20:21] op_sel:[0,0] op_sel_hi:[1,0]
    v_pk_mul_f32 v[68:69], v[68:69], s[20:21] op_sel:[0,0] op_sel_hi:[1,0]
    v_pk_mul_f32 v[70:71], v[70:71], s[20:21] op_sel:[0,0] op_sel_hi:[1,0]
    v_cvt_pk_bf16_f32 v16, v64, v65
    v_cvt_pk_bf16_f32 v17, v66, v67
    v_cvt_pk_bf16_f32 v18, v68, v69
    v_cvt_pk_bf16_f32 v19, v70, v71
    v_lshlrev_b32 v56, 16, v140
    v_and_b32 v57, s53, v140
    v_mfma_f32_16x16x32_bf16 v[40:43], v[204:207], v[16:19], v[40:43]
    ds_write_b128 v3, v[16:19] offset:15360
    v_lshlrev_b32 v58, 16, v141
    v_and_b32 v59, s53, v141
    v_mfma_f32_16x16x32_bf16 v[80:83], v[236:239], v[16:19], v[80:83]
    v_lshlrev_b32 v60, 16, v142
    v_and_b32 v61, s53, v142
    v_lshlrev_b32 v62, 16, v143
    s_mov_b32 s28, 16384
    s_add_u32 m0, s26, 0
    s_nop 0
    buffer_load_dwordx4 v4, s[8:11], s28 offen offset:0 nt lds
    v_and_b32 v63, s53, v143
    v_pk_mul_f32 v[56:57], v[56:57], s[20:21] op_sel:[0,0] op_sel_hi:[1,0]
    v_pk_mul_f32 v[58:59], v[58:59], s[20:21] op_sel:[0,0] op_sel_hi:[1,0]
    v_pk_mul_f32 v[60:61], v[60:61], s[20:21] op_sel:[0,0] op_sel_hi:[1,0]
    v_pk_mul_f32 v[62:63], v[62:63], s[20:21] op_sel:[0,0] op_sel_hi:[1,0]
    v_cvt_pk_bf16_f32 v140, v56, v57
    v_cvt_pk_bf16_f32 v141, v58, v59
    v_cvt_pk_bf16_f32 v142, v60, v61
    v_cvt_pk_bf16_f32 v143, v62, v63
    v_lshlrev_b32 v64, 16, v144
    v_and_b32 v65, s53, v144
    v_mfma_f32_16x16x32_bf16 v[40:43], v[208:211], v[140:143], v[40:43]
    v_lshlrev_b32 v66, 16, v145
    v_and_b32 v67, s53, v145
    v_mfma_f32_16x16x32_bf16 v[80:83], v[240:243], v[140:143], v[80:83]
    v_lshlrev_b32 v68, 16, v146
    v_and_b32 v69, s53, v146
    v_lshlrev_b32 v70, 16, v147
    v_and_b32 v71, s53, v147
    v_pk_mul_f32 v[64:65], v[64:65], s[20:21] op_sel:[0,0] op_sel_hi:[1,0]
    s_add_u32 m0, s26, 896
    s_nop 0
    buffer_load_dwordx4 v4, s[8:11], s28 offen offset:128 nt lds
    v_pk_mul_f32 v[66:67], v[66:67], s[20:21] op_sel:[0,0] op_sel_hi:[1,0]
    v_pk_mul_f32 v[68:69], v[68:69], s[20:21] op_sel:[0,0] op_sel_hi:[1,0]
    v_pk_mul_f32 v[70:71], v[70:71], s[20:21] op_sel:[0,0] op_sel_hi:[1,0]
    v_cvt_pk_bf16_f32 v144, v64, v65
    v_cvt_pk_bf16_f32 v145, v66, v67
    v_cvt_pk_bf16_f32 v146, v68, v69
    v_cvt_pk_bf16_f32 v147, v70, v71
    v_lshlrev_b32 v56, 16, v148
    v_and_b32 v57, s53, v148
    v_mfma_f32_16x16x32_bf16 v[40:43], v[212:215], v[144:147], v[40:43]
    v_lshlrev_b32 v58, 16, v149
    v_and_b32 v59, s53, v149
    v_mfma_f32_16x16x32_bf16 v[80:83], v[244:247], v[144:147], v[80:83]
    v_lshlrev_b32 v60, 16, v150
    v_and_b32 v61, s53, v150
    v_lshlrev_b32 v62, 16, v151
    v_and_b32 v63, s53, v151
    v_pk_mul_f32 v[56:57], v[56:57], s[20:21] op_sel:[0,0] op_sel_hi:[1,0]
    v_pk_mul_f32 v[58:59], v[58:59], s[20:21] op_sel:[0,0] op_sel_hi:[1,0]
    v_pk_mul_f32 v[60:61], v[60:61], s[20:21] op_sel:[0,0] op_sel_hi:[1,0]
    s_add_u32 m0, s26, 1792
    s_nop 0
    buffer_load_dwordx4 v4, s[8:11], s28 offen offset:256 nt lds
    v_pk_mul_f32 v[62:63], v[62:63], s[20:21] op_sel:[0,0] op_sel_hi:[1,0]
    v_cvt_pk_bf16_f32 v148, v56, v57
    v_cvt_pk_bf16_f32 v149, v58, v59
    v_cvt_pk_bf16_f32 v150, v60, v61
    v_cvt_pk_bf16_f32 v151, v62, v63
    v_lshlrev_b32 v64, 16, v152
    v_and_b32 v65, s53, v152
    v_mfma_f32_16x16x32_bf16 v[40:43], v[216:219], v[148:151], v[40:43]
    v_lshlrev_b32 v66, 16, v153
    v_and_b32 v67, s53, v153
    v_mfma_f32_16x16x32_bf16 v[80:83], v[248:251], v[148:151], v[80:83]
    v_lshlrev_b32 v68, 16, v154
    v_and_b32 v69, s53, v154
    v_lshlrev_b32 v70, 16, v155
    v_and_b32 v71, s53, v155
    v_pk_mul_f32 v[64:65], v[64:65], s[20:21] op_sel:[0,0] op_sel_hi:[1,0]
    v_pk_mul_f32 v[66:67], v[66:67], s[20:21] op_sel:[0,0] op_sel_hi:[1,0]
    v_pk_mul_f32 v[68:69], v[68:69], s[20:21] op_sel:[0,0] op_sel_hi:[1,0]
    v_pk_mul_f32 v[70:71], v[70:71], s[20:21] op_sel:[0,0] op_sel_hi:[1,0]
    v_cvt_pk_bf16_f32 v152, v64, v65
    s_add_u32 m0, s26, 2688
    s_nop 0
    buffer_load_dwordx4 v4, s[8:11], s28 offen offset:384 nt lds
    v_cvt_pk_bf16_f32 v153, v66, v67
    v_cvt_pk_bf16_f32 v154, v68, v69
    v_cvt_pk_bf16_f32 v155, v70, v71
    s_nop 1
    v_mfma_f32_16x16x32_bf16 v[40:43], v[220:223], v[152:155], v[40:43]
    v_mfma_f32_16x16x32_bf16 v[80:83], v[252:255], v[152:155], v[80:83]
    s_nop 7
    v_max3_f32 v72, v40, v41, v42
    v_max3_f32 v72, v72, v43, v80
    v_max3_f32 v72, v72, v81, v82
    v_max_f32 v72, v72, v83
    v_exp_f32 v40, v40
    v_exp_f32 v41, v41
    v_exp_f32 v42, v42
    v_exp_f32 v43, v43
    v_add_f32 v5, v40, v41
    v_cvt_pk_bf16_f32 v40, v40, v41
    v_cvt_pk_bf16_f32 v41, v42, v43
    v_add_f32 v42, v42, v43
    v_add_f32 v42, v42, v5
    v_exp_f32 v80, v80
    v_exp_f32 v81, v81
    v_exp_f32 v82, v82
    v_exp_f32 v83, v83
    v_mov_b32 v73, v72
    v_mov_b32 v74, v72
    s_nop 1
    v_permlane32_swap_b32 v73, v74
    s_nop 1
    v_max_f32 v72, v73, v74
    v_mov_b32 v73, v72
    v_mov_b32 v74, v72
    s_nop 1
    v_permlane16_swap_b32 v73, v74
    s_nop 1
    v_max_f32 v72, v73, v74
    v_cmp_nle_f32 vcc, s52, v72
    s_or_b64 s[50:51], s[50:51], vcc
    s_waitcnt vmcnt(8)
    ds_read_b128 v[156:159], v24 offset:16384
    ds_read_b128 v[160:163], v25 offset:16384
    ds_read_b128 v[164:167], v24 offset:17408
    ds_read_b128 v[16:19], v25 offset:17408
    ds_read_b128 v[28:31], v24 offset:18432
    ds_read_b128 v[32:35], v25 offset:18432
    ds_read_b128 v[20:23], v24 offset:19456
    ds_read_b128 v[72:75], v25 offset:19456
    s_waitcnt lgkmcnt(0)
    s_mov_b32 s28, 32768
    s_add_u32 m0, s27, 0
    s_nop 0
    buffer_load_dwordx4 v4, s[8:11], s28 offen offset:0 nt lds
    v_lshlrev_b32 v56, 16, v156
    v_and_b32 v57, s53, v156
    v_lshlrev_b32 v58, 16, v157
    v_and_b32 v59, s53, v157
    v_lshlrev_b32 v60, 16, v158
    v_and_b32 v61, s53, v158
    v_lshlrev_b32 v62, 16, v159
    v_and_b32 v63, s53, v159
    v_pk_mul_f32 v[56:57], v[56:57], s[20:21] op_sel:[0,0] op_sel_hi:[1,0]
    v_pk_mul_f32 v[58:59], v[58:59], s[20:21] op_sel:[0,0] op_sel_hi:[1,0]
    v_pk_mul_f32 v[60:61], v[60:61], s[20:21] op_sel:[0,0] op_sel_hi:[1,0]
    v_pk_mul_f32 v[62:63], v[62:63], s[20:21] op_sel:[0,0] op_sel_hi:[1,0]
    v_cvt_pk_bf16_f32 v156, v56, v57
    v_cvt_pk_bf16_f32 v157, v58, v59
    v_cvt_pk_bf16_f32 v158, v60, v61
    v_cvt_pk_bf16_f32 v159, v62, v63
    v_lshlrev_b32 v64, 16, v160
    v_and_b32 v65, s53, v160
    v_mfma_f32_16x16x32_bf16 v[44:47], v[192:195], v[156:159], v[6:9]
    v_mov_b64 v[192:193], 0
    v_mov_b64 v[194:195], 0
    v_lshlrev_b32 v66, 16, v161
    v_and_b32 v67, s53, v161
    v_mfma_f32_16x16x32_bf16 v[84:87], v[224:227], v[156:159], v[6:9]
    s_add_u32 m0, s27, 896
    s_nop 0
    buffer_load_dwordx4 v4, s[8:11], s28 offen offset:128 nt lds
    v_mov_b64 v[224:225], 0
    v_mov_b64 v[226:227], 0
    v_lshlrev_b32 v68, 16, v162
    v_and_b32 v69, s53, v162
    v_lshlrev_b32 v70, 16, v163
    v_and_b32 v71, s53, v163
    v_pk_mul_f32 v[64:65], v[64:65], s[20:21] op_sel:[0,0] op_sel_hi:[1,0]
    v_pk_mul_f32 v[66:67], v[66:67], s[20:21] op_sel:[0,0] op_sel_hi:[1,0]
    v_pk_mul_f32 v[68:69], v[68:69], s[20:21] op_sel:[0,0] op_sel_hi:[1,0]
    v_pk_mul_f32 v[70:71], v[70:71], s[20:21] op_sel:[0,0] op_sel_hi:[1,0]
    v_cvt_pk_bf16_f32 v160, v64, v65
    v_cvt_pk_bf16_f32 v161, v66, v67
    v_cvt_pk_bf16_f32 v162, v68, v69
    v_cvt_pk_bf16_f32 v163, v70, v71
    v_lshlrev_b32 v56, 16, v164
    v_and_b32 v57, s53, v164
    v_mfma_f32_16x16x32_bf16 v[44:47], v[196:199], v[160:163], v[44:47]
    v_mov_b64 v[196:197], 0
    v_mov_b64 v[198:199], 0
    v_lshlrev_b32 v58, 16, v165
    v_and_b32 v59, s53, v165
    v_mfma_f32_16x16x32_bf16 v[84:87], v[228:231], v[160:163], v[84:87]
    v_mov_b64 v[228:229], 0
    v_mov_b64 v[230:231], 0
    s_add_u32 m0, s27, 1792
    s_nop 0
    buffer_load_dwordx4 v4, s[8:11], s28 offen offset:256 nt lds
    v_lshlrev_b32 v60, 16, v166
    v_and_b32 v61, s53, v166
    v_lshlrev_b32 v62, 16, v167
    v_and_b32 v63, s53, v167
    v_pk_mul_f32 v[56:57], v[56:57], s[20:21] op_sel:[0,0] op_sel_hi:[1,0]
    v_pk_mul_f32 v[58:59], v[58:59], s[20:21] op_sel:[0,0] op_sel_hi:[1,0]
    v_pk_mul_f32 v[60:61], v[60:61], s[20:21] op_sel:[0,0] op_sel_hi:[1,0]
    v_pk_mul_f32 v[62:63], v[62:63], s[20:21] op_sel:[0,0] op_sel_hi:[1,0]
    v_cvt_pk_bf16_f32 v164, v56, v57
    v_cvt_pk_bf16_f32 v165, v58, v59
    v_cvt_pk_bf16_f32 v166, v60, v61
    v_cvt_pk_bf16_f32 v167, v62, v63
    v_lshlrev_b32 v64, 16, v16
    v_and_b32 v65, s53, v16
    v_mfma_f32_16x16x32_bf16 v[44:47], v[200:203], v[164:167], v[44:47]
    v_mov_b64 v[200:201], 0
    v_mov_b64 v[202:203], 0
    v_lshlrev_b32 v66, 16, v17
    v_and_b32 v67, s53, v17
    v_mfma_f32_16x16x32_bf16 v[84:87], v[232:235], v[164:167], v[84:87]
    v_mov_b64 v[232:233], 0
    v_mov_b64 v[234:235], 0
    v_lshlrev_b32 v68, 16, v18
    v_and_b32 v69, s53, v18
    s_add_u32 m0, s27, 2688
    s_nop 0
    buffer_load_dwordx4 v4, s[8:11], s28 offen offset:384 nt lds
    v_lshlrev_b32 v70, 16, v19
    v_and_b32 v71, s53, v19
    v_pk_mul_f32 v[64:65], v[64:65], s[20:21] op_sel:[0,0] op_sel_hi:[1,0]
    v_pk_mul_f32 v[66:67], v[66:67], s[20:21] op_sel:[0,0] op_sel_hi:[1,0]
    v_pk_mul_f32 v[68:69], v[68:69], s[20:21] op_sel:[0,0] op_sel_hi:[1,0]
    v_pk_mul_f32 v[70:71], v[70:71], s[20:21] op_sel:[0,0] op_sel_hi:[1,0]
    v_cvt_pk_bf16_f32 v16, v64, v65
    v_cvt_pk_bf16_f32 v17, v66, v67
    v_cvt_pk_bf16_f32 v18, v68, v69
    v_cvt_pk_bf16_f32 v19, v70, v71
    v_lshlrev_b32 v56, 16, v28
    v_and_b32 v57, s53, v28
    v_mfma_f32_16x16x32_bf16 v[44:47], v[204:207], v[16:19], v[44:47]
    ds_write_b128 v3, v[16:19] offset:5120
    v_mov_b64 v[204:205], 0
    v_mov_b64 v[206:207], 0
    v_lshlrev_b32 v58, 16, v29
    v_and_b32 v59, s53, v29
    v_mfma_f32_16x16x32_bf16 v[84:87], v[236:239], v[16:19], v[84:87]
    v_mov_b64 v[236:237], 0
    v_mov_b64 v[238:239], 0
    v_lshlrev_b32 v60, 16, v30
    v_and_b32 v61, s53, v30
    v_lshlrev_b32 v62, 16, v31
    s_mov_b32 s28, 16384
    s_add_u32 m0, s26, 49152
    s_nop 0
    buffer_load_dwordx4 v4, s[12:15], s28 offen offset:0 nt lds
    v_and_b32 v63, s53, v31
    v_pk_mul_f32 v[56:57], v[56:57], s[20:21] op_sel:[0,0] op_sel_hi:[1,0]
    v_pk_mul_f32 v[58:59], v[58:59], s[20:21] op_sel:[0,0] op_sel_hi:[1,0]
    v_pk_mul_f32 v[60:61], v[60:61], s[20:21] op_sel:[0,0] op_sel_hi:[1,0]
    v_pk_mul_f32 v[62:63], v[62:63], s[20:21] op_sel:[0,0] op_sel_hi:[1,0]
    v_cvt_pk_bf16_f32 v28, v56, v57
    v_cvt_pk_bf16_f32 v29, v58, v59
    v_cvt_pk_bf16_f32 v30, v60, v61
    v_cvt_pk_bf16_f32 v31, v62, v63
    v_lshlrev_b32 v64, 16, v32
    v_and_b32 v65, s53, v32
    v_mfma_f32_16x16x32_bf16 v[44:47], v[208:211], v[28:31], v[44:47]
    ds_write_b128 v3, v[28:31] offset:6144
    v_mov_b64 v[208:209], 0
    v_mov_b64 v[210:211], 0
    v_lshlrev_b32 v66, 16, v33
    v_and_b32 v67, s53, v33
    v_mfma_f32_16x16x32_bf16 v[84:87], v[240:243], v[28:31], v[84:87]
    v_mov_b64 v[240:241], 0
    v_mov_b64 v[242:243], 0
    v_lshlrev_b32 v68, 16, v34
    v_and_b32 v69, s53, v34
    v_lshlrev_b32 v70, 16, v35
    v_and_b32 v71, s53, v35
    s_add_u32 m0, s26, 50048
    s_nop 0
    buffer_load_dwordx4 v4, s[12:15], s28 offen offset:128 nt lds
    v_pk_mul_f32 v[64:65], v[64:65], s[20:21] op_sel:[0,0] op_sel_hi:[1,0]
    v_pk_mul_f32 v[66:67], v[66:67], s[20:21] op_sel:[0,0] op_sel_hi:[1,0]
    v_pk_mul_f32 v[68:69], v[68:69], s[20:21] op_sel:[0,0] op_sel_hi:[1,0]
    v_pk_mul_f32 v[70:71], v[70:71], s[20:21] op_sel:[0,0] op_sel_hi:[1,0]
    v_cvt_pk_bf16_f32 v32, v64, v65
    v_cvt_pk_bf16_f32 v33, v66, v67
    v_cvt_pk_bf16_f32 v34, v68, v69
    v_cvt_pk_bf16_f32 v35, v70, v71
    v_lshlrev_b32 v56, 16, v20
    v_and_b32 v57, s53, v20
    v_mfma_f32_16x16x32_bf16 v[44:47], v[212:215], v[32:35], v[44:47]
    ds_write_b128 v3, v[32:35] offset:7168
    v_mov_b64 v[212:213], 0
    v_mov_b64 v[214:215], 0
    v_lshlrev_b32 v58, 16, v21
    v_and_b32 v59, s53, v21
    v_mfma_f32_16x16x32_bf16 v[84:87], v[244:247], v[32:35], v[84:87]
    v_mov_b64 v[244:245], 0
    v_mov_b64 v[246:247], 0
    v_lshlrev_b32 v60, 16, v22
    v_and_b32 v61, s53, v22
    v_lshlrev_b32 v62, 16, v23
    v_and_b32 v63, s53, v23
    v_pk_mul_f32 v[56:57], v[56:57], s[20:21] op_sel:[0,0] op_sel_hi:[1,0]
    s_add_u32 m0, s26, 50944
    s_nop 0
    buffer_load_dwordx4 v4, s[12:15], s28 offen offset:256 nt lds
    v_pk_mul_f32 v[58:59], v[58:59], s[20:21] op_sel:[0,0] op_sel_hi:[1,0]
    v_pk_mul_f32 v[60:61], v[60:61], s[20:21] op_sel:[0,0] op_sel_hi:[1,0]
    v_pk_mul_f32 v[62:63], v[62:63], s[20:21] op_sel:[0,0] op_sel_hi:[1,0]
    v_cvt_pk_bf16_f32 v20, v56, v57
    v_cvt_pk_bf16_f32 v21, v58, v59
    v_cvt_pk_bf16_f32 v22, v60, v61
    v_cvt_pk_bf16_f32 v23, v62, v63
    v_lshlrev_b32 v64, 16, v72
    v_and_b32 v65, s53, v72
    v_mfma_f32_16x16x32_bf16 v[44:47], v[216:219], v[20:23], v[44:47]
    ds_write_b128 v3, v[20:23] offset:13312
    v_mov_b64 v[216:217], 0
    v_mov_b64 v[218:219], 0
    v_lshlrev_b32 v66, 16, v73
    v_and_b32 v67, s53, v73
    v_mfma_f32_16x16x32_bf16 v[84:87], v[248:251], v[20:23], v[84:87]
    v_mov_b64 v[248:249], 0
    v_mov_b64 v[250:251], 0
    v_lshlrev_b32 v68, 16, v74
    v_and_b32 v69, s53, v74
    v_lshlrev_b32 v70, 16, v75
    v_and_b32 v71, s53, v75
    v_pk_mul_f32 v[64:65], v[64:65], s[20:21] op_sel:[0,0] op_sel_hi:[1,0]
    v_pk_mul_f32 v[66:67], v[66:67], s[20:21] op_sel:[0,0] op_sel_hi:[1,0]
    s_add_u32 m0, s26, 51840
    s_nop 0
    buffer_load_dwordx4 v4, s[12:15], s28 offen offset:384 nt lds
    v_pk_mul_f32 v[68:69], v[68:69], s[20:21] op_sel:[0,0] op_sel_hi:[1,0]
    v_pk_mul_f32 v[70:71], v[70:71], s[20:21] op_sel:[0,0] op_sel_hi:[1,0]
    v_cvt_pk_bf16_f32 v72, v64, v65
    v_cvt_pk_bf16_f32 v73, v66, v67
    v_cvt_pk_bf16_f32 v74, v68, v69
    v_cvt_pk_bf16_f32 v75, v70, v71
    s_nop 1
    v_mfma_f32_16x16x32_bf16 v[44:47], v[220:223], v[72:75], v[44:47]
    ds_write_b128 v3, v[72:75] offset:14336
    v_mov_b64 v[220:221], 0
    v_mov_b64 v[222:223], 0
    v_mfma_f32_16x16x32_bf16 v[84:87], v[252:255], v[72:75], v[84:87]
    v_mov_b64 v[252:253], 0
    v_mov_b64 v[254:255], 0
    s_nop 7
    v_max3_f32 v72, v44, v45, v46
    v_max3_f32 v72, v72, v47, v84
    v_max3_f32 v72, v72, v85, v86
    v_max_f32 v72, v72, v87
    v_exp_f32 v44, v44
    v_exp_f32 v45, v45
    v_exp_f32 v46, v46
    v_exp_f32 v47, v47
    v_add_f32 v5, v44, v45
    v_cvt_pk_bf16_f32 v44, v44, v45
    v_cvt_pk_bf16_f32 v45, v46, v47
    v_add_f32 v46, v46, v47
    v_add_f32 v46, v46, v5
    v_exp_f32 v84, v84
    v_exp_f32 v85, v85
    v_exp_f32 v86, v86
    v_exp_f32 v87, v87
    v_add_f32 v47, v46, v84
    v_cvt_pk_bf16_f32 v46, v84, v85
    v_add_f32 v84, v47, v85
    v_add_f32 v84, v84, v86
    v_cvt_pk_bf16_f32 v47, v86, v87
    v_mov_b32 v73, v72
    v_mov_b32 v74, v72
    s_nop 1
    v_permlane32_swap_b32 v73, v74
    s_nop 1
    v_max_f32 v72, v73, v74
    v_mov_b32 v73, v72
    v_mov_b32 v74, v72
    s_nop 1
    v_permlane16_swap_b32 v73, v74
    s_nop 1
    v_max_f32 v72, v73, v74
    v_cmp_nle_f32 vcc, s52, v72
    s_or_b64 s[50:51], s[50:51], vcc
    s_cmp_eq_u64 s[50:51], 0
    s_cbranch_scc1 L_refok
    v_mov_b32 v92, 0x7f800000
L_refok:
    v_add_u32 v0, 16384, v0
    v_add_u32 v1, 16384, v1
    s_waitcnt vmcnt(8)
    s_barrier
    ds_read_b128 v[32:35], v0 offset:0
    ds_read_b128 v[16:19], v1 offset:0
    ds_read_b128 v[20:23], v0 offset:1024
    ds_read_b128 v[24:27], v0 offset:8192
    s_waitcnt lgkmcnt(0)
    s_mov_b32 s22, 15
.p2align 6
L_loop:
    v_mfma_f32_16x16x32_bf16 v[56:59], v[32:35], v[96:99], v[6:9]
    s_waitcnt lgkmcnt(2)
    ds_read_b128 v[28:31], v1 offset:8192
    v_add_f32 v84, v84, v87
    v_mfma_f32_16x16x32_bf16 v[56:59], v[16:19], v[100:103], v[56:59]
    s_waitcnt lgkmcnt(2)
    v_add_f32 v43, v42, v80
    v_cvt_pk_bf16_f32 v42, v80, v81
    v_mfma_f32_16x16x32_bf16 v[56:59], v[20:23], v[104:107], v[56:59]
    s_sub_u32 s29, s27, s26
    v_add_f32 v80, v43, v81
    v_add_f32 v80, v80, v82
    v_mfma_f32_16x16x32_bf16 v[60:63], v[20:23], v[136:139], v[6:9]
    s_sub_u32 s30, s26, s25
    v_add_f32 v80, v80, v83
    v_add_f32 v39, v38, v76
    v_mfma_f32_16x16x32_bf16 v[60:63], v[16:19], v[132:135], v[60:63]
    s_add_u32 m0, s25, 0
    v_cvt_pk_bf16_f32 v38, v76, v77
    v_add_f32 v76, v39, v77
    v_mfma_f32_16x16x32_bf16 v[60:63], v[32:35], v[128:131], v[60:63]
    v_add_f32 v76, v76, v78
    v_add_f32 v76, v76, v79
    v_mfma_f32_16x16x32_bf16 v[64:67], v[32:35], v[156:159], v[6:9]
    v_add_f32 v93, v92, v88
    v_add_f32 v93, v93, v84
    v_mfma_f32_16x16x32_bf16 v[64:67], v[16:19], v[160:163], v[64:67]
    v_add_f32 v93, v93, v80
    v_add_f32 v93, v93, v76
    v_mfma_f32_16x16x32_bf16 v[64:67], v[20:23], v[164:167], v[64:67]
    v_cmp_ngt_f32 vcc, s21, v93
    v_cvt_pk_bf16_f32 v43, v82, v83
    v_mfma_f32_16x16x32_bf16 v[68:71], v[20:23], v[176:179], v[6:9]
    v_cvt_pk_bf16_f32 v39, v78, v79
    v_mfma_f32_16x16x32_bf16 v[68:71], v[16:19], v[172:175], v[68:71]
    v_mfma_f32_16x16x32_bf16 v[68:71], v[32:35], v[168:171], v[68:71]
    s_cbranch_vccnz L_convA
L_fretA:
    v_mfma_f32_16x16x32_bf16 v[72:75], v[32:35], v[180:183], v[6:9]
    ds_read_b128 v[32:35], v0 offset:9216
    v_add_f32 v15, v15, v92
    v_mfma_f32_16x16x32_bf16 v[72:75], v[16:19], v[184:187], v[72:75]
    ds_read_b128 v[16:19], v1 offset:1024
    v_add_f32 v14, v14, v88
    v_mfma_f32_16x16x32_bf16 v[72:75], v[20:23], v[188:191], v[72:75]
    s_waitcnt lgkmcnt(3)
    ds_read_b128 v[20:23], v3 offset:15360
    v_add_f32 v13, v13, v84
    v_mfma_f32_16x16x32_bf16 v[92:95], v[24:27], v[180:183], v[6:9]
    s_waitcnt lgkmcnt(3)
    v_add_f32 v12, v12, v80
    v_add_f32 v11, v11, v76
    v_mfma_f32_16x16x32_bf16 v[92:95], v[28:31], v[184:187], v[92:95]
    s_waitcnt lgkmcnt(2)
    v_mfma_f32_16x16x32_bf16 v[92:95], v[32:35], v[188:191], v[92:95]
    buffer_load_dwordx4 v4, s[8:11], s23 offen offset:0 nt lds
    v_mfma_f32_16x16x32_bf16 v[88:91], v[32:35], v[176:179], v[6:9]
    s_add_u32 m0, s25, 896
    v_mfma_f32_16x16x32_bf16 v[88:91], v[28:31], v[172:175], v[88:91]
    v_mfma_f32_16x16x32_bf16 v[88:91], v[24:27], v[168:171], v[88:91]
    v_mfma_f32_16x16x32_bf16 v[84:87], v[24:27], v[156:159], v[6:9]
    v_mfma_f32_16x16x32_bf16 v[84:87], v[28:31], v[160:163], v[84:87]
    buffer_load_dwordx4 v4, s[8:11], s23 offen offset:128 nt lds
    v_mfma_f32_16x16x32_bf16 v[84:87], v[32:35], v[164:167], v[84:87]
    s_add_u32 m0, s25, 1792
    v_mfma_f32_16x16x32_bf16 v[80:83], v[32:35], v[136:139], v[6:9]
    v_mfma_f32_16x16x32_bf16 v[80:83], v[28:31], v[132:135], v[80:83]
    v_mfma_f32_16x16x32_bf16 v[80:83], v[24:27], v[128:131], v[80:83]
    v_mfma_f32_16x16x32_bf16 v[76:79], v[24:27], v[96:99], v[6:9]
    ds_read_b128 v[24:27], v3 offset:5120
    v_mfma_f32_16x16x32_bf16 v[76:79], v[28:31], v[100:103], v[76:79]
    ds_read_b128 v[28:31], v3 offset:0
    v_mfma_f32_16x16x32_bf16 v[76:79], v[32:35], v[104:107], v[76:79]
    ds_read_b128 v[32:35], v3 offset:8192
    s_waitcnt lgkmcnt(4)
    v_mfma_f32_16x16x32_bf16 v[56:59], v[16:19], v[108:111], v[56:59]
    buffer_load_dwordx4 v4, s[8:11], s23 offen offset:256 nt lds
    s_waitcnt lgkmcnt(3)
    v_mfma_f32_16x16x32_bf16 v[60:63], v[16:19], v[20:23], v[60:63]
    s_add_u32 m0, s25, 2688
    ds_read_b128 v[20:23], v1 offset:9216
    s_waitcnt lgkmcnt(3)
    v_mfma_f32_16x16x32_bf16 v[64:67], v[16:19], v[24:27], v[64:67]
    buffer_load_dwordx4 v4, s[8:11], s23 offen offset:384 nt lds
    s_waitcnt lgkmcnt(2)
    v_mfma_f32_16x16x32_bf16 v[68:71], v[16:19], v[28:31], v[68:71]
    s_add_u32 m0, s27, 49152
    s_waitcnt lgkmcnt(1)
    v_mfma_f32_16x16x32_bf16 v[72:75], v[16:19], v[32:35], v[72:75]
    ds_read_b128 v[16:19], v3 offset:15360
    s_waitcnt lgkmcnt(1)
    v_mfma_f32_16x16x32_bf16 v[92:95], v[20:23], v[32:35], v[92:95]
    ds_read_b128 v[32:35], v0 offset:2048
    v_mfma_f32_16x16x32_bf16 v[88:91], v[20:23], v[28:31], v[88:91]
    ds_read_b128 v[28:31], v3 offset:6144
    v_mfma_f32_16x16x32_bf16 v[84:87], v[20:23], v[24:27], v[84:87]
    ds_read_b128 v[24:27], v3 offset:1024
    s_waitcnt lgkmcnt(3)
    v_mfma_f32_16x16x32_bf16 v[80:83], v[20:23], v[16:19], v[80:83]
    ds_read_b128 v[16:19], v3 offset:9216
    v_mfma_f32_16x16x32_bf16 v[76:79], v[20:23], v[108:111], v[76:79]
    ds_read_b128 v[20:23], v0 offset:10240
    s_waitcnt lgkmcnt(4)
    v_mfma_f32_16x16x32_bf16 v[56:59], v[32:35], v[112:115], v[56:59]
    buffer_load_dwordx4 v4, s[12:15], s24 offen offset:0 nt lds
    v_mfma_f32_16x16x32_bf16 v[60:63], v[32:35], v[140:143], v[60:63]
    s_add_u32 m0, s27, 50048
    s_waitcnt lgkmcnt(3)
    v_mfma_f32_16x16x32_bf16 v[64:67], v[32:35], v[28:31], v[64:67]
    buffer_load_dwordx4 v4, s[12:15], s24 offen offset:128 nt lds
    s_waitcnt lgkmcnt(2)
    v_mfma_f32_16x16x32_bf16 v[68:71], v[32:35], v[24:27], v[68:71]
    s_add_u32 m0, s27, 50944
    s_waitcnt lgkmcnt(1)
    v_mfma_f32_16x16x32_bf16 v[72:75], v[32:35], v[16:19], v[72:75]
    ds_read_b128 v[32:35], v1 offset:2048
    s_waitcnt lgkmcnt(1)
    v_mfma_f32_16x16x32_bf16 v[92:95], v[20:23], v[16:19], v[92:95]
    ds_read_b128 v[16:19], v3 offset:7168
    v_mfma_f32_16x16x32_bf16 v[88:91], v[20:23], v[24:27], v[88:91]
    ds_read_b128 v[24:27], v3 offset:2048
    v_mfma_f32_16x16x32_bf16 v[84:87], v[20:23], v[28:31], v[84:87]
    ds_read_b128 v[28:31], v3 offset:10240
    v_mfma_f32_16x16x32_bf16 v[80:83], v[20:23], v[140:143], v[80:83]
    buffer_load_dwordx4 v4, s[12:15], s24 offen offset:256 nt lds
    v_mfma_f32_16x16x32_bf16 v[76:79], v[20:23], v[112:115], v[76:79]
    s_add_u32 m0, s27, 51840
    ds_read_b128 v[20:23], v1 offset:10240
    s_waitcnt lgkmcnt(4)
    v_mfma_f32_16x16x32_bf16 v[56:59], v[32:35], v[116:119], v[56:59]
    v_mfma_f32_16x16x32_bf16 v[60:63], v[32:35], v[144:147], v[60:63]
    s_waitcnt lgkmcnt(3)
    v_mfma_f32_16x16x32_bf16 v[64:67], v[32:35], v[16:19], v[64:67]
    buffer_load_dwordx4 v4, s[12:15], s24 offen offset:384 nt lds
    s_waitcnt lgkmcnt(2)
    v_mfma_f32_16x16x32_bf16 v[68:71], v[32:35], v[24:27], v[68:71]
    s_mov_b32 s28, s25
    s_waitcnt lgkmcnt(1)
    v_mfma_f32_16x16x32_bf16 v[72:75], v[32:35], v[28:31], v[72:75]
    s_mov_b32 s25, s26
    ds_read_b128 v[32:35], v0 offset:3072
    s_waitcnt lgkmcnt(1)
    v_mfma_f32_16x16x32_bf16 v[92:95], v[20:23], v[28:31], v[92:95]
    s_mov_b32 s26, s27
    ds_read_b128 v[28:31], v3 offset:13312
    s_mov_b32 s27, s28
    v_mfma_f32_16x16x32_bf16 v[88:91], v[20:23], v[24:27], v[88:91]
    s_add_u32 s23, s23, 16384
    ds_read_b128 v[24:27], v3 offset:3072
    s_add_u32 s24, s24, 16384
    v_mfma_f32_16x16x32_bf16 v[84:87], v[20:23], v[16:19], v[84:87]
    ds_read_b128 v[16:19], v3 offset:11264
    v_mfma_f32_16x16x32_bf16 v[80:83], v[20:23], v[144:147], v[80:83]
    v_mfma_f32_16x16x32_bf16 v[76:79], v[20:23], v[116:119], v[76:79]
    s_waitcnt lgkmcnt(3)
    ds_read_b128 v[20:23], v0 offset:11264
    v_add_u32 v0, s29, v0
    v_mfma_f32_16x16x32_bf16 v[56:59], v[32:35], v[120:123], v[56:59]
    v_mfma_f32_16x16x32_bf16 v[60:63], v[32:35], v[148:151], v[60:63]
    s_waitcnt lgkmcnt(3)
    v_mfma_f32_16x16x32_bf16 v[64:67], v[32:35], v[28:31], v[64:67]
    s_waitcnt lgkmcnt(2)
    v_mfma_f32_16x16x32_bf16 v[68:71], v[32:35], v[24:27], v[68:71]
    s_waitcnt lgkmcnt(1)
    v_mfma_f32_16x16x32_bf16 v[72:75], v[32:35], v[16:19], v[72:75]
    ds_read_b128 v[32:35], v1 offset:3072
    s_waitcnt lgkmcnt(1)
    v_mfma_f32_16x16x32_bf16 v[92:95], v[20:23], v[16:19], v[92:95]
    ds_read_b128 v[16:19], v3 offset:14336
    v_mfma_f32_16x16x32_bf16 v[88:91], v[20:23], v[24:27], v[88:91]
    ds_read_b128 v[24:27], v3 offset:4096
    v_mfma_f32_16x16x32_bf16 v[84:87], v[20:23], v[28:31], v[84:87]
    ds_read_b128 v[28:31], v3 offset:12288
    v_mfma_f32_16x16x32_bf16 v[80:83], v[20:23], v[148:151], v[80:83]
    v_mfma_f32_16x16x32_bf16 v[76:79], v[20:23], v[120:123], v[76:79]
    s_waitcnt lgkmcnt(3)
    ds_read_b128 v[20:23], v1 offset:11264
    v_add_u32 v1, s29, v1
    v_mfma_f32_16x16x32_bf16 v[56:59], v[32:35], v[124:127], v[56:59]
    v_mfma_f32_16x16x32_bf16 v[60:63], v[32:35], v[152:155], v[60:63]
    s_waitcnt lgkmcnt(3)
    v_mfma_f32_16x16x32_bf16 v[64:67], v[32:35], v[16:19], v[64:67]
    s_waitcnt lgkmcnt(2)
    v_mfma_f32_16x16x32_bf16 v[68:71], v[32:35], v[24:27], v[68:71]
    s_waitcnt lgkmcnt(1)
    v_mfma_f32_16x16x32_bf16 v[72:75], v[32:35], v[28:31], v[72:75]
    ds_read_b64_tr_b16 v[32:33], v2 offset:0
    s_waitcnt lgkmcnt(1)
    v_mfma_f32_16x16x32_bf16 v[92:95], v[20:23], v[28:31], v[92:95]
    ds_read_b64_tr_b16 v[34:35], v2 offset:8192
    v_mfma_f32_16x16x32_bf16 v[88:91], v[20:23], v[24:27], v[88:91]
    ds_read_b64_tr_b16 v[28:29], v2 offset:1024
    v_mfma_f32_16x16x32_bf16 v[84:87], v[20:23], v[16:19], v[84:87]
    ds_read_b64_tr_b16 v[30:31], v2 offset:9216
    v_mfma_f32_16x16x32_bf16 v[80:83], v[20:23], v[152:155], v[80:83]
    ds_read_b64_tr_b16 v[16:17], v2 offset:2048
    v_mfma_f32_16x16x32_bf16 v[76:79], v[20:23], v[124:127], v[76:79]
    ds_read_b64_tr_b16 v[18:19], v2 offset:10240
    s_waitcnt lgkmcnt(4)
    v_mfma_f32_16x16x32_bf16 a[0:3], v[36:39], v[32:35], a[0:3]
    ds_read_b64_tr_b16 v[20:21], v2 offset:3072
    v_mfma_f32_16x16x32_bf16 a[64:67], v[40:43], v[32:35], a[64:67]
    ds_read_b64_tr_b16 v[22:23], v2 offset:11264
    v_xor_b32 v2, 32, v2
    v_mfma_f32_16x16x32_bf16 a[128:131], v[44:47], v[32:35], a[128:131]
    ds_read_b64_tr_b16 v[24:25], v2 offset:0
    v_mfma_f32_16x16x32_bf16 a[192:195], v[48:51], v[32:35], a[192:195]
    ds_read_b64_tr_b16 v[26:27], v2 offset:8192
    v_mfma_f32_16x16x32_bf16 v[192:195], v[52:55], v[32:35], v[192:195]
    s_waitcnt lgkmcnt(6)
    v_exp_f32 v56, v56
    v_mfma_f32_16x16x32_bf16 a[16:19], v[36:39], v[28:31], a[16:19]
    v_exp_f32 v57, v57
    v_mfma_f32_16x16x32_bf16 a[80:83], v[40:43], v[28:31], a[80:83]
    v_exp_f32 v58, v58
    v_mfma_f32_16x16x32_bf16 a[144:147], v[44:47], v[28:31], a[144:147]
    v_exp_f32 v59, v59
    v_mfma_f32_16x16x32_bf16 a[208:211], v[48:51], v[28:31], a[208:211]
    v_exp_f32 v60, v60
    v_mfma_f32_16x16x32_bf16 v[208:211], v[52:55], v[28:31], v[208:211]
    s_waitcnt lgkmcnt(4)
    ds_read_b64_tr_b16 v[28:29], v2 offset:1024
    v_add_f32 v5, v56, v57
    v_mfma_f32_16x16x32_bf16 a[32:35], v[36:39], v[16:19], a[32:35]
    ds_read_b64_tr_b16 v[30:31], v2 offset:9216
    v_cvt_pk_bf16_f32 v56, v56, v57
    v_mfma_f32_16x16x32_bf16 a[96:99], v[40:43], v[16:19], a[96:99]
    ds_read_b64_tr_b16 v[32:33], v2 offset:2048
    v_cvt_pk_bf16_f32 v57, v58, v59
    v_mfma_f32_16x16x32_bf16 a[160:163], v[44:47], v[16:19], a[160:163]
    ds_read_b64_tr_b16 v[34:35], v2 offset:10240
    v_add_f32 v58, v58, v59
    v_mfma_f32_16x16x32_bf16 a[224:227], v[48:51], v[16:19], a[224:227]
    v_exp_f32 v61, v61
    v_mfma_f32_16x16x32_bf16 v[224:227], v[52:55], v[16:19], v[224:227]
    s_waitcnt lgkmcnt(6)
    ds_read_b64_tr_b16 v[16:17], v2 offset:3072
    v_add_f32 v58, v58, v5
    v_mfma_f32_16x16x32_bf16 a[48:51], v[36:39], v[20:23], a[48:51]
    ds_read_b64_tr_b16 v[18:19], v2 offset:11264
    v_xor_b32 v2, 64, v2
    v_mfma_f32_16x16x32_bf16 a[112:115], v[40:43], v[20:23], a[112:115]
    v_exp_f32 v62, v62
    v_mfma_f32_16x16x32_bf16 a[176:179], v[44:47], v[20:23], a[176:179]
    v_exp_f32 v63, v63
    v_mfma_f32_16x16x32_bf16 a[240:243], v[48:51], v[20:23], a[240:243]
    v_exp_f32 v64, v64
    v_mfma_f32_16x16x32_bf16 v[240:243], v[52:55], v[20:23], v[240:243]
    s_waitcnt lgkmcnt(6)
    ds_read_b64_tr_b16 v[20:21], v2 offset:0
    v_add_f32 v5, v60, v61
    v_mfma_f32_16x16x32_bf16 a[4:7], v[36:39], v[24:27], a[4:7]
    ds_read_b64_tr_b16 v[22:23], v2 offset:8192
    v_cvt_pk_bf16_f32 v60, v60, v61
    v_mfma_f32_16x16x32_bf16 a[68:71], v[40:43], v[24:27], a[68:71]
    v_exp_f32 v65, v65
    v_mfma_f32_16x16x32_bf16 a[132:135], v[44:47], v[24:27], a[132:135]
    v_exp_f32 v66, v66
    v_mfma_f32_16x16x32_bf16 a[196:199], v[48:51], v[24:27], a[196:199]
    v_exp_f32 v67, v67
    v_mfma_f32_16x16x32_bf16 v[196:199], v[52:55], v[24:27], v[196:199]
    s_waitcnt lgkmcnt(6)
    ds_read_b64_tr_b16 v[24:25], v2 offset:1024
    v_cvt_pk_bf16_f32 v61, v62, v63
    v_mfma_f32_16x16x32_bf16 a[20:23], v[36:39], v[28:31], a[20:23]
    ds_read_b64_tr_b16 v[26:27], v2 offset:9216
    v_add_f32 v62, v62, v63
    v_mfma_f32_16x16x32_bf16 a[84:87], v[40:43], v[28:31], a[84:87]
    v_exp_f32 v68, v68
    v_mfma_f32_16x16x32_bf16 a[148:151], v[44:47], v[28:31], a[148:151]
    v_exp_f32 v69, v69
    v_mfma_f32_16x16x32_bf16 a[212:215], v[48:51], v[28:31], a[212:215]
    v_exp_f32 v70, v70
    v_mfma_f32_16x16x32_bf16 v[212:215], v[52:55], v[28:31], v[212:215]
    s_waitcnt lgkmcnt(6)
    ds_read_b64_tr_b16 v[28:29], v2 offset:2048
    v_add_f32 v62, v62, v5
    v_mfma_f32_16x16x32_bf16 a[36:39], v[36:39], v[32:35], a[36:39]
    ds_read_b64_tr_b16 v[30:31], v2 offset:10240
    v_add_f32 v5, v64, v65
    v_mfma_f32_16x16x32_bf16 a[100:103], v[40:43], v[32:35], a[100:103]
    v_exp_f32 v71, v71
    v_mfma_f32_16x16x32_bf16 a[164:167], v[44:47], v[32:35], a[164:167]
    v_exp_f32 v72, v72
    v_mfma_f32_16x16x32_bf16 a[228:231], v[48:51], v[32:35], a[228:231]
    v_exp_f32 v73, v73
    v_mfma_f32_16x16x32_bf16 v[228:231], v[52:55], v[32:35], v[228:231]
    s_waitcnt lgkmcnt(6)
    ds_read_b64_tr_b16 v[32:33], v2 offset:3072
    v_cvt_pk_bf16_f32 v64, v64, v65
    v_mfma_f32_16x16x32_bf16 a[52:55], v[36:39], v[16:19], a[52:55]
    ds_read_b64_tr_b16 v[34:35], v2 offset:11264
    v_xor_b32 v2, 32, v2
    v_mfma_f32_16x16x32_bf16 a[116:119], v[40:43], v[16:19], a[116:119]
    v_exp_f32 v74, v74
    v_mfma_f32_16x16x32_bf16 a[180:183], v[44:47], v[16:19], a[180:183]
    v_exp_f32 v75, v75
    v_mfma_f32_16x16x32_bf16 a[244:247], v[48:51], v[16:19], a[244:247]
    v_exp_f32 v92, v92
    v_mfma_f32_16x16x32_bf16 v[244:247], v[52:55], v[16:19], v[244:247]
    s_waitcnt lgkmcnt(6)
    ds_read_b64_tr_b16 v[16:17], v2 offset:0
    v_cvt_pk_bf16_f32 v65, v66, v67
    v_mfma_f32_16x16x32_bf16 a[12:15], v[36:39], v[20:23], a[12:15]
    ds_read_b64_tr_b16 v[18:19], v2 offset:8192
    v_add_f32 v66, v66, v67
    v_mfma_f32_16x16x32_bf16 a[76:79], v[40:43], v[20:23], a[76:79]
    v_exp_f32 v93, v93
    v_mfma_f32_16x16x32_bf16 a[140:143], v[44:47], v[20:23], a[140:143]
    v_exp_f32 v94, v94
    v_mfma_f32_16x16x32_bf16 a[204:207], v[48:51], v[20:23], a[204:207]
    v_exp_f32 v95, v95
    v_mfma_f32_16x16x32_bf16 v[204:207], v[52:55], v[20:23], v[204:207]
    s_waitcnt lgkmcnt(6)
    ds_read_b64_tr_b16 v[20:21], v2 offset:1024
    v_add_f32 v66, v66, v5
    v_mfma_f32_16x16x32_bf16 a[28:31], v[36:39], v[24:27], a[28:31]
    ds_read_b64_tr_b16 v[22:23], v2 offset:9216
    v_add_f32 v5, v68, v69
    v_mfma_f32_16x16x32_bf16 a[92:95], v[40:43], v[24:27], a[92:95]
    v_exp_f32 v88, v88
    v_mfma_f32_16x16x32_bf16 a[156:159], v[44:47], v[24:27], a[156:159]
    v_exp_f32 v89, v89
    v_mfma_f32_16x16x32_bf16 a[220:223], v[48:51], v[24:27], a[220:223]
    v_exp_f32 v90, v90
    v_mfma_f32_16x16x32_bf16 v[220:223], v[52:55], v[24:27], v[220:223]
    s_waitcnt lgkmcnt(6)
    ds_read_b64_tr_b16 v[24:25], v2 offset:2048
    v_cvt_pk_bf16_f32 v68, v68, v69
    v_mfma_f32_16x16x32_bf16 a[44:47], v[36:39], v[28:31], a[44:47]
    ds_read_b64_tr_b16 v[26:27], v2 offset:10240
    v_cvt_pk_bf16_f32 v69, v70, v71
    v_mfma_f32_16x16x32_bf16 a[108:111], v[40:43], v[28:31], a[108:111]
    v_exp_f32 v91, v91
    v_mfma_f32_16x16x32_bf16 a[172:175], v[44:47], v[28:31], a[172:175]
    v_exp_f32 v84, v84
    v_mfma_f32_16x16x32_bf16 a[236:239], v[48:51], v[28:31], a[236:239]
    v_exp_f32 v85, v85
    v_mfma_f32_16x16x32_bf16 v[236:239], v[52:55], v[28:31], v[236:239]
    s_waitcnt lgkmcnt(6)
    ds_read_b64_tr_b16 v[28:29], v2 offset:3072
    v_add_f32 v70, v70, v71
    v_mfma_f32_16x16x32_bf16 a[60:63], v[36:39], v[32:35], a[60:63]
    ds_read_b64_tr_b16 v[30:31], v2 offset:11264
    v_xad_u32 v2, v2, 64, s30
    v_mfma_f32_16x16x32_bf16 a[124:127], v[40:43], v[32:35], a[124:127]
    v_exp_f32 v86, v86
    v_mfma_f32_16x16x32_bf16 a[188:191], v[44:47], v[32:35], a[188:191]
    v_exp_f32 v87, v87
    v_mfma_f32_16x16x32_bf16 a[252:255], v[48:51], v[32:35], a[252:255]
    v_exp_f32 v80, v80
    v_mfma_f32_16x16x32_bf16 v[252:255], v[52:55], v[32:35], v[252:255]
    s_waitcnt lgkmcnt(6)
    v_exp_f32 v81, v81
    v_mfma_f32_16x16x32_bf16 a[8:11], v[36:39], v[16:19], a[8:11]
    v_exp_f32 v82, v82
    v_mfma_f32_16x16x32_bf16 a[72:75], v[40:43], v[16:19], a[72:75]
    v_exp_f32 v83, v83
    v_mfma_f32_16x16x32_bf16 a[136:139], v[44:47], v[16:19], a[136:139]
    v_exp_f32 v76, v76
    v_mfma_f32_16x16x32_bf16 a[200:203], v[48:51], v[16:19], a[200:203]
    v_exp_f32 v77, v77
    v_mfma_f32_16x16x32_bf16 v[200:203], v[52:55], v[16:19], v[200:203]
    s_waitcnt vmcnt(8) lgkmcnt(0)
    s_barrier
    ds_read_b128 v[32:35], v0 offset:0
    v_mfma_f32_16x16x32_bf16 a[24:27], v[36:39], v[20:23], a[24:27]
    ds_read_b128 v[16:19], v1 offset:0
    v_add_f32 v70, v70, v5
    v_mfma_f32_16x16x32_bf16 a[88:91], v[40:43], v[20:23], a[88:91]
    v_exp_f32 v78, v78
    v_mfma_f32_16x16x32_bf16 a[152:155], v[44:47], v[20:23], a[152:155]
    v_exp_f32 v79, v79
    v_mfma_f32_16x16x32_bf16 a[216:219], v[48:51], v[20:23], a[216:219]
    v_add_f32 v5, v72, v73
    v_cvt_pk_bf16_f32 v72, v72, v73
    v_mfma_f32_16x16x32_bf16 v[216:219], v[52:55], v[20:23], v[216:219]
    ds_read_b128 v[20:23], v0 offset:1024
    v_cvt_pk_bf16_f32 v73, v74, v75
    v_mfma_f32_16x16x32_bf16 a[40:43], v[36:39], v[24:27], a[40:43]
    v_add_f32 v74, v74, v75
    v_add_f32 v74, v74, v5
    v_mfma_f32_16x16x32_bf16 a[104:107], v[40:43], v[24:27], a[104:107]
    v_add_f32 v75, v74, v92
    v_cvt_pk_bf16_f32 v74, v92, v93
    v_mfma_f32_16x16x32_bf16 a[168:171], v[44:47], v[24:27], a[168:171]
    v_add_f32 v92, v75, v93
    v_add_f32 v92, v92, v94
    v_mfma_f32_16x16x32_bf16 a[232:235], v[48:51], v[24:27], a[232:235]
    v_cvt_pk_bf16_f32 v75, v94, v95
    v_add_f32 v92, v92, v95
    v_mfma_f32_16x16x32_bf16 v[232:235], v[52:55], v[24:27], v[232:235]
    ds_read_b128 v[24:27], v0 offset:8192
    v_add_f32 v71, v70, v88
    v_mfma_f32_16x16x32_bf16 a[56:59], v[36:39], v[28:31], a[56:59]
    v_cvt_pk_bf16_f32 v70, v88, v89
    v_add_f32 v88, v71, v89
    v_mfma_f32_16x16x32_bf16 a[120:123], v[40:43], v[28:31], a[120:123]
    v_add_f32 v88, v88, v90
    v_cvt_pk_bf16_f32 v71, v90, v91
    v_mfma_f32_16x16x32_bf16 a[184:187], v[44:47], v[28:31], a[184:187]
    v_add_f32 v88, v88, v91
    v_add_f32 v67, v66, v84
    v_mfma_f32_16x16x32_bf16 a[248:251], v[48:51], v[28:31], a[248:251]
    v_cvt_pk_bf16_f32 v66, v84, v85
    v_add_f32 v84, v67, v85
    v_mfma_f32_16x16x32_bf16 v[248:251], v[52:55], v[28:31], v[248:251]
    s_waitcnt lgkmcnt(3)
    v_add_f32 v84, v84, v86
    v_cvt_pk_bf16_f32 v67, v86, v87
    v_mfma_f32_16x16x32_bf16 v[36:39], v[32:35], v[96:99], v[6:9]
    s_waitcnt lgkmcnt(2)
    ds_read_b128 v[28:31], v1 offset:8192
    v_add_f32 v84, v84, v87
    v_mfma_f32_16x16x32_bf16 v[36:39], v[16:19], v[100:103], v[36:39]
    s_waitcnt lgkmcnt(2)
    v_add_f32 v63, v62, v80
    v_cvt_pk_bf16_f32 v62, v80, v81
    v_mfma_f32_16x16x32_bf16 v[36:39], v[20:23], v[104:107], v[36:39]
    s_sub_u32 s29, s27, s26
    v_add_f32 v80, v63, v81
    v_add_f32 v80, v80, v82
    v_mfma_f32_16x16x32_bf16 v[40:43], v[20:23], v[136:139], v[6:9]
    s_sub_u32 s30, s26, s25
    v_add_f32 v80, v80, v83
    v_add_f32 v59, v58, v76
    v_mfma_f32_16x16x32_bf16 v[40:43], v[16:19], v[132:135], v[40:43]
    s_add_u32 m0, s25, 0
    v_cvt_pk_bf16_f32 v58, v76, v77
    v_add_f32 v76, v59, v77
    v_mfma_f32_16x16x32_bf16 v[40:43], v[32:35], v[128:131], v[40:43]
    v_add_f32 v76, v76, v78
    v_add_f32 v76, v76, v79
    v_mfma_f32_16x16x32_bf16 v[44:47], v[32:35], v[156:159], v[6:9]
    v_add_f32 v93, v92, v88
    v_add_f32 v93, v93, v84
    v_mfma_f32_16x16x32_bf16 v[44:47], v[16:19], v[160:163], v[44:47]
    v_add_f32 v93, v93, v80
    v_add_f32 v93, v93, v76
    v_mfma_f32_16x16x32_bf16 v[44:47], v[20:23], v[164:167], v[44:47]
    v_cmp_ngt_f32 vcc, s21, v93
    v_cvt_pk_bf16_f32 v63, v82, v83
    v_mfma_f32_16x16x32_bf16 v[48:51], v[20:23], v[176:179], v[6:9]
    v_cvt_pk_bf16_f32 v59, v78, v79
    v_mfma_f32_16x16x32_bf16 v[48:51], v[16:19], v[172:175], v[48:51]
    v_mfma_f32_16x16x32_bf16 v[48:51], v[32:35], v[168:171], v[48:51]
    s_cbranch_vccnz L_convB
L_fretB:
    v_mfma_f32_16x16x32_bf16 v[52:55], v[32:35], v[180:183], v[6:9]
    ds_read_b128 v[32:35], v0 offset:9216
    v_add_f32 v15, v15, v92
    v_mfma_f32_16x16x32_bf16 v[52:55], v[16:19], v[184:187], v[52:55]
    ds_read_b128 v[16:19], v1 offset:1024
    v_add_f32 v14, v14, v88
    v_mfma_f32_16x16x32_bf16 v[52:55], v[20:23], v[188:191], v[52:55]
    s_waitcnt lgkmcnt(3)
    ds_read_b128 v[20:23], v3 offset:15360
    v_add_f32 v13, v13, v84
    v_mfma_f32_16x16x32_bf16 v[92:95], v[24:27], v[180:183], v[6:9]
    s_waitcnt lgkmcnt(3)
    v_add_f32 v12, v12, v80
    v_add_f32 v11, v11, v76
    v_mfma_f32_16x16x32_bf16 v[92:95], v[28:31], v[184:187], v[92:95]
    s_waitcnt lgkmcnt(2)
    v_mfma_f32_16x16x32_bf16 v[92:95], v[32:35], v[188:191], v[92:95]
    buffer_load_dwordx4 v4, s[8:11], s23 offen offset:0 nt lds
    v_mfma_f32_16x16x32_bf16 v[88:91], v[32:35], v[176:179], v[6:9]
    s_add_u32 m0, s25, 896
    v_mfma_f32_16x16x32_bf16 v[88:91], v[28:31], v[172:175], v[88:91]
    v_mfma_f32_16x16x32_bf16 v[88:91], v[24:27], v[168:171], v[88:91]
    v_mfma_f32_16x16x32_bf16 v[84:87], v[24:27], v[156:159], v[6:9]
    v_mfma_f32_16x16x32_bf16 v[84:87], v[28:31], v[160:163], v[84:87]
    buffer_load_dwordx4 v4, s[8:11], s23 offen offset:128 nt lds
    v_mfma_f32_16x16x32_bf16 v[84:87], v[32:35], v[164:167], v[84:87]
    s_add_u32 m0, s25, 1792
    v_mfma_f32_16x16x32_bf16 v[80:83], v[32:35], v[136:139], v[6:9]
    v_mfma_f32_16x16x32_bf16 v[80:83], v[28:31], v[132:135], v[80:83]
    v_mfma_f32_16x16x32_bf16 v[80:83], v[24:27], v[128:131], v[80:83]
    v_mfma_f32_16x16x32_bf16 v[76:79], v[24:27], v[96:99], v[6:9]
    ds_read_b128 v[24:27], v3 offset:5120
    v_mfma_f32_16x16x32_bf16 v[76:79], v[28:31], v[100:103], v[76:79]
    ds_read_b128 v[28:31], v3 offset:0
    v_mfma_f32_16x16x32_bf16 v[76:79], v[32:35], v[104:107], v[76:79]
    ds_read_b128 v[32:35], v3 offset:8192
    s_waitcnt lgkmcnt(4)
    v_mfma_f32_16x16x32_bf16 v[36:39], v[16:19], v[108:111], v[36:39]
    buffer_load_dwordx4 v4, s[8:11], s23 offen offset:256 nt lds
    s_waitcnt lgkmcnt(3)
    v_mfma_f32_16x16x32_bf16 v[40:43], v[16:19], v[20:23], v[40:43]
    s_add_u32 m0, s25, 2688
    ds_read_b128 v[20:23], v1 offset:9216
    s_waitcnt lgkmcnt(3)
    v_mfma_f32_16x16x32_bf16 v[44:47], v[16:19], v[24:27], v[44:47]
    buffer_load_dwordx4 v4, s[8:11], s23 offen offset:384 nt lds
    s_waitcnt lgkmcnt(2)
    v_mfma_f32_16x16x32_bf16 v[48:51], v[16:19], v[28:31], v[48:51]
    s_add_u32 m0, s27, 49152
    s_waitcnt lgkmcnt(1)
    v_mfma_f32_16x16x32_bf16 v[52:55], v[16:19], v[32:35], v[52:55]
    ds_read_b128 v[16:19], v3 offset:15360
    s_waitcnt lgkmcnt(1)
    v_mfma_f32_16x16x32_bf16 v[92:95], v[20:23], v[32:35], v[92:95]
    ds_read_b128 v[32:35], v0 offset:2048
    v_mfma_f32_16x16x32_bf16 v[88:91], v[20:23], v[28:31], v[88:91]
    ds_read_b128 v[28:31], v3 offset:6144
    v_mfma_f32_16x16x32_bf16 v[84:87], v[20:23], v[24:27], v[84:87]
    ds_read_b128 v[24:27], v3 offset:1024
    s_waitcnt lgkmcnt(3)
    v_mfma_f32_16x16x32_bf16 v[80:83], v[20:23], v[16:19], v[80:83]
    ds_read_b128 v[16:19], v3 offset:9216
    v_mfma_f32_16x16x32_bf16 v[76:79], v[20:23], v[108:111], v[76:79]
    ds_read_b128 v[20:23], v0 offset:10240
    s_waitcnt lgkmcnt(4)
    v_mfma_f32_16x16x32_bf16 v[36:39], v[32:35], v[112:115], v[36:39]
    buffer_load_dwordx4 v4, s[12:15], s24 offen offset:0 nt lds
    v_mfma_f32_16x16x32_bf16 v[40:43], v[32:35], v[140:143], v[40:43]
    s_add_u32 m0, s27, 50048
    s_waitcnt lgkmcnt(3)
    v_mfma_f32_16x16x32_bf16 v[44:47], v[32:35], v[28:31], v[44:47]
    buffer_load_dwordx4 v4, s[12:15], s24 offen offset:128 nt lds
    s_waitcnt lgkmcnt(2)
    v_mfma_f32_16x16x32_bf16 v[48:51], v[32:35], v[24:27], v[48:51]
    s_add_u32 m0, s27, 50944
    s_waitcnt lgkmcnt(1)
    v_mfma_f32_16x16x32_bf16 v[52:55], v[32:35], v[16:19], v[52:55]
    ds_read_b128 v[32:35], v1 offset:2048
    s_waitcnt lgkmcnt(1)
    v_mfma_f32_16x16x32_bf16 v[92:95], v[20:23], v[16:19], v[92:95]
    ds_read_b128 v[16:19], v3 offset:7168
    v_mfma_f32_16x16x32_bf16 v[88:91], v[20:23], v[24:27], v[88:91]
    ds_read_b128 v[24:27], v3 offset:2048
    v_mfma_f32_16x16x32_bf16 v[84:87], v[20:23], v[28:31], v[84:87]
    ds_read_b128 v[28:31], v3 offset:10240
    v_mfma_f32_16x16x32_bf16 v[80:83], v[20:23], v[140:143], v[80:83]
    buffer_load_dwordx4 v4, s[12:15], s24 offen offset:256 nt lds
    v_mfma_f32_16x16x32_bf16 v[76:79], v[20:23], v[112:115], v[76:79]
    s_add_u32 m0, s27, 51840
    ds_read_b128 v[20:23], v1 offset:10240
    s_waitcnt lgkmcnt(4)
    v_mfma_f32_16x16x32_bf16 v[36:39], v[32:35], v[116:119], v[36:39]
    v_mfma_f32_16x16x32_bf16 v[40:43], v[32:35], v[144:147], v[40:43]
    s_waitcnt lgkmcnt(3)
    v_mfma_f32_16x16x32_bf16 v[44:47], v[32:35], v[16:19], v[44:47]
    buffer_load_dwordx4 v4, s[12:15], s24 offen offset:384 nt lds
    s_waitcnt lgkmcnt(2)
    v_mfma_f32_16x16x32_bf16 v[48:51], v[32:35], v[24:27], v[48:51]
    s_mov_b32 s28, s25
    s_waitcnt lgkmcnt(1)
    v_mfma_f32_16x16x32_bf16 v[52:55], v[32:35], v[28:31], v[52:55]
    s_mov_b32 s25, s26
    ds_read_b128 v[32:35], v0 offset:3072
    s_waitcnt lgkmcnt(1)
    v_mfma_f32_16x16x32_bf16 v[92:95], v[20:23], v[28:31], v[92:95]
    s_mov_b32 s26, s27
    ds_read_b128 v[28:31], v3 offset:13312
    s_mov_b32 s27, s28
    v_mfma_f32_16x16x32_bf16 v[88:91], v[20:23], v[24:27], v[88:91]
    s_add_u32 s23, s23, 16384
    ds_read_b128 v[24:27], v3 offset:3072
    s_add_u32 s24, s24, 16384
    v_mfma_f32_16x16x32_bf16 v[84:87], v[20:23], v[16:19], v[84:87]
    ds_read_b128 v[16:19], v3 offset:11264
    v_mfma_f32_16x16x32_bf16 v[80:83], v[20:23], v[144:147], v[80:83]
    v_mfma_f32_16x16x32_bf16 v[76:79], v[20:23], v[116:119], v[76:79]
    s_waitcnt lgkmcnt(3)
    ds_read_b128 v[20:23], v0 offset:11264
    v_add_u32 v0, s29, v0
    v_mfma_f32_16x16x32_bf16 v[36:39], v[32:35], v[120:123], v[36:39]
    v_mfma_f32_16x16x32_bf16 v[40:43], v[32:35], v[148:151], v[40:43]
    s_waitcnt lgkmcnt(3)
    v_mfma_f32_16x16x32_bf16 v[44:47], v[32:35], v[28:31], v[44:47]
    s_waitcnt lgkmcnt(2)
    v_mfma_f32_16x16x32_bf16 v[48:51], v[32:35], v[24:27], v[48:51]
    s_waitcnt lgkmcnt(1)
    v_mfma_f32_16x16x32_bf16 v[52:55], v[32:35], v[16:19], v[52:55]
    ds_read_b128 v[32:35], v1 offset:3072
    s_waitcnt lgkmcnt(1)
    v_mfma_f32_16x16x32_bf16 v[92:95], v[20:23], v[16:19], v[92:95]
    ds_read_b128 v[16:19], v3 offset:14336
    v_mfma_f32_16x16x32_bf16 v[88:91], v[20:23], v[24:27], v[88:91]
    ds_read_b128 v[24:27], v3 offset:4096
    v_mfma_f32_16x16x32_bf16 v[84:87], v[20:23], v[28:31], v[84:87]
    ds_read_b128 v[28:31], v3 offset:12288
    v_mfma_f32_16x16x32_bf16 v[80:83], v[20:23], v[148:151], v[80:83]
    v_mfma_f32_16x16x32_bf16 v[76:79], v[20:23], v[120:123], v[76:79]
    s_waitcnt lgkmcnt(3)
    ds_read_b128 v[20:23], v1 offset:11264
    v_add_u32 v1, s29, v1
    v_mfma_f32_16x16x32_bf16 v[36:39], v[32:35], v[124:127], v[36:39]
    v_mfma_f32_16x16x32_bf16 v[40:43], v[32:35], v[152:155], v[40:43]
    s_waitcnt lgkmcnt(3)
    v_mfma_f32_16x16x32_bf16 v[44:47], v[32:35], v[16:19], v[44:47]
    s_waitcnt lgkmcnt(2)
    v_mfma_f32_16x16x32_bf16 v[48:51], v[32:35], v[24:27], v[48:51]
    s_waitcnt lgkmcnt(1)
    v_mfma_f32_16x16x32_bf16 v[52:55], v[32:35], v[28:31], v[52:55]
    ds_read_b64_tr_b16 v[32:33], v2 offset:0
    s_waitcnt lgkmcnt(1)
    v_mfma_f32_16x16x32_bf16 v[92:95], v[20:23], v[28:31], v[92:95]
    ds_read_b64_tr_b16 v[34:35], v2 offset:8192
    v_mfma_f32_16x16x32_bf16 v[88:91], v[20:23], v[24:27], v[88:91]
    ds_read_b64_tr_b16 v[28:29], v2 offset:1024
    v_mfma_f32_16x16x32_bf16 v[84:87], v[20:23], v[16:19], v[84:87]
    ds_read_b64_tr_b16 v[30:31], v2 offset:9216
    v_mfma_f32_16x16x32_bf16 v[80:83], v[20:23], v[152:155], v[80:83]
    ds_read_b64_tr_b16 v[16:17], v2 offset:2048
    v_mfma_f32_16x16x32_bf16 v[76:79], v[20:23], v[124:127], v[76:79]
    ds_read_b64_tr_b16 v[18:19], v2 offset:10240
    s_waitcnt lgkmcnt(4)
    v_mfma_f32_16x16x32_bf16 a[0:3], v[56:59], v[32:35], a[0:3]
    ds_read_b64_tr_b16 v[20:21], v2 offset:3072
    v_mfma_f32_16x16x32_bf16 a[64:67], v[60:63], v[32:35], a[64:67]
    ds_read_b64_tr_b16 v[22:23], v2 offset:11264
    v_xor_b32 v2, 32, v2
    v_mfma_f32_16x16x32_bf16 a[128:131], v[64:67], v[32:35], a[128:131]
    ds_read_b64_tr_b16 v[24:25], v2 offset:0
    v_mfma_f32_16x16x32_bf16 a[192:195], v[68:71], v[32:35], a[192:195]
    ds_read_b64_tr_b16 v[26:27], v2 offset:8192
    v_mfma_f32_16x16x32_bf16 v[192:195], v[72:75], v[32:35], v[192:195]
    s_waitcnt lgkmcnt(6)
    v_exp_f32 v36, v36
    v_mfma_f32_16x16x32_bf16 a[16:19], v[56:59], v[28:31], a[16:19]
    v_exp_f32 v37, v37
    v_mfma_f32_16x16x32_bf16 a[80:83], v[60:63], v[28:31], a[80:83]
    v_exp_f32 v38, v38
    v_mfma_f32_16x16x32_bf16 a[144:147], v[64:67], v[28:31], a[144:147]
    v_exp_f32 v39, v39
    v_mfma_f32_16x16x32_bf16 a[208:211], v[68:71], v[28:31], a[208:211]
    v_exp_f32 v40, v40
    v_mfma_f32_16x16x32_bf16 v[208:211], v[72:75], v[28:31], v[208:211]
    s_waitcnt lgkmcnt(4)
    ds_read_b64_tr_b16 v[28:29], v2 offset:1024
    v_add_f32 v5, v36, v37
    v_mfma_f32_16x16x32_bf16 a[32:35], v[56:59], v[16:19], a[32:35]
    ds_read_b64_tr_b16 v[30:31], v2 offset:9216
    v_cvt_pk_bf16_f32 v36, v36, v37
    v_mfma_f32_16x16x32_bf16 a[96:99], v[60:63], v[16:19], a[96:99]
    ds_read_b64_tr_b16 v[32:33], v2 offset:2048
    v_cvt_pk_bf16_f32 v37, v38, v39
    v_mfma_f32_16x16x32_bf16 a[160:163], v[64:67], v[16:19], a[160:163]
    ds_read_b64_tr_b16 v[34:35], v2 offset:10240
    v_add_f32 v38, v38, v39
    v_mfma_f32_16x16x32_bf16 a[224:227], v[68:71], v[16:19], a[224:227]
    v_exp_f32 v41, v41
    v_mfma_f32_16x16x32_bf16 v[224:227], v[72:75], v[16:19], v[224:227]
    s_waitcnt lgkmcnt(6)
    ds_read_b64_tr_b16 v[16:17], v2 offset:3072
    v_add_f32 v38, v38, v5
    v_mfma_f32_16x16x32_bf16 a[48:51], v[56:59], v[20:23], a[48:51]
    ds_read_b64_tr_b16 v[18:19], v2 offset:11264
    v_xor_b32 v2, 64, v2
    v_mfma_f32_16x16x32_bf16 a[112:115], v[60:63], v[20:23], a[112:115]
    v_exp_f32 v42, v42
    v_mfma_f32_16x16x32_bf16 a[176:179], v[64:67], v[20:23], a[176:179]
    v_exp_f32 v43, v43
    v_mfma_f32_16x16x32_bf16 a[240:243], v[68:71], v[20:23], a[240:243]
    v_exp_f32 v44, v44
    v_mfma_f32_16x16x32_bf16 v[240:243], v[72:75], v[20:23], v[240:243]
    s_waitcnt lgkmcnt(6)
    ds_read_b64_tr_b16 v[20:21], v2 offset:0
    v_add_f32 v5, v40, v41
    v_mfma_f32_16x16x32_bf16 a[4:7], v[56:59], v[24:27], a[4:7]
    ds_read_b64_tr_b16 v[22:23], v2 offset:8192
    v_cvt_pk_bf16_f32 v40, v40, v41
    v_mfma_f32_16x16x32_bf16 a[68:71], v[60:63], v[24:27], a[68:71]
    v_exp_f32 v45, v45
    v_mfma_f32_16x16x32_bf16 a[132:135], v[64:67], v[24:27], a[132:135]
    v_exp_f32 v46, v46
    v_mfma_f32_16x16x32_bf16 a[196:199], v[68:71], v[24:27], a[196:199]
    v_exp_f32 v47, v47
    v_mfma_f32_16x16x32_bf16 v[196:199], v[72:75], v[24:27], v[196:199]
    s_waitcnt lgkmcnt(6)
    ds_read_b64_tr_b16 v[24:25], v2 offset:1024
    v_cvt_pk_bf16_f32 v41, v42, v43
    v_mfma_f32_16x16x32_bf16 a[20:23], v[56:59], v[28:31], a[20:23]
    ds_read_b64_tr_b16 v[26:27], v2 offset:9216
    v_add_f32 v42, v42, v43
    v_mfma_f32_16x16x32_bf16 a[84:87], v[60:63], v[28:31], a[84:87]
    v_exp_f32 v48, v48
    v_mfma_f32_16x16x32_bf16 a[148:151], v[64:67], v[28:31], a[148:151]
    v_exp_f32 v49, v49
    v_mfma_f32_16x16x32_bf16 a[212:215], v[68:71], v[28:31], a[212:215]
    v_exp_f32 v50, v50
    v_mfma_f32_16x16x32_bf16 v[212:215], v[72:75], v[28:31], v[212:215]
    s_waitcnt lgkmcnt(6)
    ds_read_b64_tr_b16 v[28:29], v2 offset:2048
    v_add_f32 v42, v42, v5
    v_mfma_f32_16x16x32_bf16 a[36:39], v[56:59], v[32:35], a[36:39]
    ds_read_b64_tr_b16 v[30:31], v2 offset:10240
    v_add_f32 v5, v44, v45
    v_mfma_f32_16x16x32_bf16 a[100:103], v[60:63], v[32:35], a[100:103]
    v_exp_f32 v51, v51
    v_mfma_f32_16x16x32_bf16 a[164:167], v[64:67], v[32:35], a[164:167]
    v_exp_f32 v52, v52
    v_mfma_f32_16x16x32_bf16 a[228:231], v[68:71], v[32:35], a[228:231]
    v_exp_f32 v53, v53
    v_mfma_f32_16x16x32_bf16 v[228:231], v[72:75], v[32:35], v[228:231]
    s_waitcnt lgkmcnt(6)
    ds_read_b64_tr_b16 v[32:33], v2 offset:3072
    v_cvt_pk_bf16_f32 v44, v44, v45
    v_mfma_f32_16x16x32_bf16 a[52:55], v[56:59], v[16:19], a[52:55]
    ds_read_b64_tr_b16 v[34:35], v2 offset:11264
    v_xor_b32 v2, 32, v2
    v_mfma_f32_16x16x32_bf16 a[116:119], v[60:63], v[16:19], a[116:119]
    v_exp_f32 v54, v54
    v_mfma_f32_16x16x32_bf16 a[180:183], v[64:67], v[16:19], a[180:183]
    v_exp_f32 v55, v55
    v_mfma_f32_16x16x32_bf16 a[244:247], v[68:71], v[16:19], a[244:247]
    v_exp_f32 v92, v92
    v_mfma_f32_16x16x32_bf16 v[244:247], v[72:75], v[16:19], v[244:247]
    s_waitcnt lgkmcnt(6)
    ds_read_b64_tr_b16 v[16:17], v2 offset:0
    v_cvt_pk_bf16_f32 v45, v46, v47
    v_mfma_f32_16x16x32_bf16 a[12:15], v[56:59], v[20:23], a[12:15]
    ds_read_b64_tr_b16 v[18:19], v2 offset:8192
    v_add_f32 v46, v46, v47
    v_mfma_f32_16x16x32_bf16 a[76:79], v[60:63], v[20:23], a[76:79]
    v_exp_f32 v93, v93
    v_mfma_f32_16x16x32_bf16 a[140:143], v[64:67], v[20:23], a[140:143]
    v_exp_f32 v94, v94
    v_mfma_f32_16x16x32_bf16 a[204:207], v[68:71], v[20:23], a[204:207]
    v_exp_f32 v95, v95
    v_mfma_f32_16x16x32_bf16 v[204:207], v[72:75], v[20:23], v[204:207]
    s_waitcnt lgkmcnt(6)
    ds_read_b64_tr_b16 v[20:21], v2 offset:1024
    v_add_f32 v46, v46, v5
    v_mfma_f32_16x16x32_bf16 a[28:31], v[56:59], v[24:27], a[28:31]
    ds_read_b64_tr_b16 v[22:23], v2 offset:9216
    v_add_f32 v5, v48, v49
    v_mfma_f32_16x16x32_bf16 a[92:95], v[60:63], v[24:27], a[92:95]
    v_exp_f32 v88, v88
    v_mfma_f32_16x16x32_bf16 a[156:159], v[64:67], v[24:27], a[156:159]
    v_exp_f32 v89, v89
    v_mfma_f32_16x16x32_bf16 a[220:223], v[68:71], v[24:27], a[220:223]
    v_exp_f32 v90, v90
    v_mfma_f32_16x16x32_bf16 v[220:223], v[72:75], v[24:27], v[220:223]
    s_waitcnt lgkmcnt(6)
    ds_read_b64_tr_b16 v[24:25], v2 offset:2048
    v_cvt_pk_bf16_f32 v48, v48, v49
    v_mfma_f32_16x16x32_bf16 a[44:47], v[56:59], v[28:31], a[44:47]
    ds_read_b64_tr_b16 v[26:27], v2 offset:10240
    v_cvt_pk_bf16_f32 v49, v50, v51
    v_mfma_f32_16x16x32_bf16 a[108:111], v[60:63], v[28:31], a[108:111]
    v_exp_f32 v91, v91
    v_mfma_f32_16x16x32_bf16 a[172:175], v[64:67], v[28:31], a[172:175]
    v_exp_f32 v84, v84
    v_mfma_f32_16x16x32_bf16 a[236:239], v[68:71], v[28:31], a[236:239]
    v_exp_f32 v85, v85
    v_mfma_f32_16x16x32_bf16 v[236:239], v[72:75], v[28:31], v[236:239]
    s_waitcnt lgkmcnt(6)
    ds_read_b64_tr_b16 v[28:29], v2 offset:3072
    v_add_f32 v50, v50, v51
    v_mfma_f32_16x16x32_bf16 a[60:63], v[56:59], v[32:35], a[60:63]
    ds_read_b64_tr_b16 v[30:31], v2 offset:11264
    v_xad_u32 v2, v2, 64, s30
    v_mfma_f32_16x16x32_bf16 a[124:127], v[60:63], v[32:35], a[124:127]
    v_exp_f32 v86, v86
    v_mfma_f32_16x16x32_bf16 a[188:191], v[64:67], v[32:35], a[188:191]
    v_exp_f32 v87, v87
    v_mfma_f32_16x16x32_bf16 a[252:255], v[68:71], v[32:35], a[252:255]
    v_exp_f32 v80, v80
    v_mfma_f32_16x16x32_bf16 v[252:255], v[72:75], v[32:35], v[252:255]
    s_waitcnt lgkmcnt(6)
    v_exp_f32 v81, v81
    v_mfma_f32_16x16x32_bf16 a[8:11], v[56:59], v[16:19], a[8:11]
    v_exp_f32 v82, v82
    v_mfma_f32_16x16x32_bf16 a[72:75], v[60:63], v[16:19], a[72:75]
    v_exp_f32 v83, v83
    v_mfma_f32_16x16x32_bf16 a[136:139], v[64:67], v[16:19], a[136:139]
    v_exp_f32 v76, v76
    v_mfma_f32_16x16x32_bf16 a[200:203], v[68:71], v[16:19], a[200:203]
    v_exp_f32 v77, v77
    v_mfma_f32_16x16x32_bf16 v[200:203], v[72:75], v[16:19], v[200:203]
    s_waitcnt vmcnt(8) lgkmcnt(0)
    s_barrier
    ds_read_b128 v[32:35], v0 offset:0
    v_mfma_f32_16x16x32_bf16 a[24:27], v[56:59], v[20:23], a[24:27]
    ds_read_b128 v[16:19], v1 offset:0
    v_add_f32 v50, v50, v5
    v_mfma_f32_16x16x32_bf16 a[88:91], v[60:63], v[20:23], a[88:91]
    v_exp_f32 v78, v78
    v_mfma_f32_16x16x32_bf16 a[152:155], v[64:67], v[20:23], a[152:155]
    v_exp_f32 v79, v79
    v_mfma_f32_16x16x32_bf16 a[216:219], v[68:71], v[20:23], a[216:219]
    v_add_f32 v5, v52, v53
    v_cvt_pk_bf16_f32 v52, v52, v53
    v_mfma_f32_16x16x32_bf16 v[216:219], v[72:75], v[20:23], v[216:219]
    ds_read_b128 v[20:23], v0 offset:1024
    v_cvt_pk_bf16_f32 v53, v54, v55
    v_mfma_f32_16x16x32_bf16 a[40:43], v[56:59], v[24:27], a[40:43]
    v_add_f32 v54, v54, v55
    v_add_f32 v54, v54, v5
    v_mfma_f32_16x16x32_bf16 a[104:107], v[60:63], v[24:27], a[104:107]
    v_add_f32 v55, v54, v92
    v_cvt_pk_bf16_f32 v54, v92, v93
    v_mfma_f32_16x16x32_bf16 a[168:171], v[64:67], v[24:27], a[168:171]
    v_add_f32 v92, v55, v93
    v_add_f32 v92, v92, v94
    v_mfma_f32_16x16x32_bf16 a[232:235], v[68:71], v[24:27], a[232:235]
    v_cvt_pk_bf16_f32 v55, v94, v95
    v_add_f32 v92, v92, v95
    v_mfma_f32_16x16x32_bf16 v[232:235], v[72:75], v[24:27], v[232:235]
    ds_read_b128 v[24:27], v0 offset:8192
    v_add_f32 v51, v50, v88
    v_mfma_f32_16x16x32_bf16 a[56:59], v[56:59], v[28:31], a[56:59]
    v_cvt_pk_bf16_f32 v50, v88, v89
    v_add_f32 v88, v51, v89
    v_mfma_f32_16x16x32_bf16 a[120:123], v[60:63], v[28:31], a[120:123]
    v_add_f32 v88, v88, v90
    v_cvt_pk_bf16_f32 v51, v90, v91
    v_mfma_f32_16x16x32_bf16 a[184:187], v[64:67], v[28:31], a[184:187]
    v_add_f32 v88, v88, v91
    v_add_f32 v47, v46, v84
    v_mfma_f32_16x16x32_bf16 a[248:251], v[68:71], v[28:31], a[248:251]
    v_cvt_pk_bf16_f32 v46, v84, v85
    v_add_f32 v84, v47, v85
    v_mfma_f32_16x16x32_bf16 v[248:251], v[72:75], v[28:31], v[248:251]
    s_waitcnt lgkmcnt(3)
    v_add_f32 v84, v84, v86
    v_cvt_pk_bf16_f32 v47, v86, v87
    s_sub_u32 s22, s22, 1
    s_cmp_lg_u32 s22, 0
    s_cbranch_scc1 L_loop
    v_mfma_f32_16x16x32_bf16 v[56:59], v[32:35], v[96:99], v[6:9]
    s_waitcnt lgkmcnt(2)
    ds_read_b128 v[28:31], v1 offset:8192
    v_add_f32 v84, v84, v87
    v_mfma_f32_16x16x32_bf16 v[56:59], v[16:19], v[100:103], v[56:59]
    s_waitcnt lgkmcnt(2)
    v_add_f32 v43, v42, v80
    v_cvt_pk_bf16_f32 v42, v80, v81
    v_mfma_f32_16x16x32_bf16 v[56:59], v[20:23], v[104:107], v[56:59]
    v_add_f32 v80, v43, v81
    v_add_f32 v80, v80, v82
    v_mfma_f32_16x16x32_bf16 v[60:63], v[20:23], v[136:139], v[6:9]
    v_add_f32 v80, v80, v83
    v_add_f32 v39, v38, v76
    v_mfma_f32_16x16x32_bf16 v[60:63], v[16:19], v[132:135], v[60:63]
    v_cvt_pk_bf16_f32 v38, v76, v77
    v_add_f32 v76, v39, v77
    v_mfma_f32_16x16x32_bf16 v[60:63], v[32:35], v[128:131], v[60:63]
    v_add_f32 v76, v76, v78
    v_add_f32 v76, v76, v79
    v_mfma_f32_16x16x32_bf16 v[64:67], v[32:35], v[156:159], v[6:9]
    v_add_f32 v93, v92, v88
    v_add_f32 v93, v93, v84
    v_mfma_f32_16x16x32_bf16 v[64:67], v[16:19], v[160:163], v[64:67]
    v_add_f32 v93, v93, v80
    v_add_f32 v93, v93, v76
    v_mfma_f32_16x16x32_bf16 v[64:67], v[20:23], v[164:167], v[64:67]
    v_cmp_ngt_f32 vcc, s21, v93
    v_cvt_pk_bf16_f32 v43, v82, v83
    v_mfma_f32_16x16x32_bf16 v[68:71], v[20:23], v[176:179], v[6:9]
    v_cvt_pk_bf16_f32 v39, v78, v79
    v_mfma_f32_16x16x32_bf16 v[68:71], v[16:19], v[172:175], v[68:71]
    v_mfma_f32_16x16x32_bf16 v[68:71], v[32:35], v[168:171], v[68:71]
    s_cbranch_vccnz L_convC
L_fretC:
    v_mfma_f32_16x16x32_bf16 v[72:75], v[32:35], v[180:183], v[6:9]
    ds_read_b128 v[32:35], v0 offset:9216
    v_add_f32 v15, v15, v92
    v_mfma_f32_16x16x32_bf16 v[72:75], v[16:19], v[184:187], v[72:75]
    ds_read_b128 v[16:19], v1 offset:1024
    v_add_f32 v14, v14, v88
    v_mfma_f32_16x16x32_bf16 v[72:75], v[20:23], v[188:191], v[72:75]
    s_waitcnt lgkmcnt(3)
    ds_read_b128 v[20:23], v3 offset:15360
    v_add_f32 v13, v13, v84
    v_mfma_f32_16x16x32_bf16 v[92:95], v[24:27], v[180:183], v[6:9]
    s_waitcnt lgkmcnt(3)
    v_add_f32 v12, v12, v80
    v_add_f32 v11, v11, v76
    v_mfma_f32_16x16x32_bf16 v[92:95], v[28:31], v[184:187], v[92:95]
    s_waitcnt lgkmcnt(2)
    v_mbcnt_lo_u32_b32 v4, -1, 0
    v_mbcnt_hi_u32_b32 v4, -1, v4
    v_mfma_f32_16x16x32_bf16 v[92:95], v[32:35], v[188:191], v[92:95]
    s_add_u32 s62, s62, L_final-L_pc0
    v_lshlrev_b32 v4, 7, v4
    v_mfma_f32_16x16x32_bf16 v[88:91], v[32:35], v[176:179], v[6:9]
    s_addc_u32 s63, s63, 0
    v_mfma_f32_16x16x32_bf16 v[88:91], v[28:31], v[172:175], v[88:91]
    global_load_dword v4, v4, s[62:63]
    v_mfma_f32_16x16x32_bf16 v[88:91], v[24:27], v[168:171], v[88:91]
    s_sub_u32 s30, s26, s25
    s_add_u32 s23, s23, 16384
    v_mfma_f32_16x16x32_bf16 v[84:87], v[24:27], v[156:159], v[6:9]
    v_mfma_f32_16x16x32_bf16 v[84:87], v[28:31], v[160:163], v[84:87]
    v_mfma_f32_16x16x32_bf16 v[84:87], v[32:35], v[164:167], v[84:87]
    v_mfma_f32_16x16x32_bf16 v[80:83], v[32:35], v[136:139], v[6:9]
    v_mfma_f32_16x16x32_bf16 v[80:83], v[28:31], v[132:135], v[80:83]
    v_mfma_f32_16x16x32_bf16 v[80:83], v[24:27], v[128:131], v[80:83]
    v_mfma_f32_16x16x32_bf16 v[76:79], v[24:27], v[96:99], v[6:9]
    ds_read_b128 v[24:27], v3 offset:5120
    v_mfma_f32_16x16x32_bf16 v[76:79], v[28:31], v[100:103], v[76:79]
    ds_read_b128 v[28:31], v3 offset:0
    v_mfma_f32_16x16x32_bf16 v[76:79], v[32:35], v[104:107], v[76:79]
    ds_read_b128 v[32:35], v3 offset:8192
    s_waitcnt lgkmcnt(4)
    v_mfma_f32_16x16x32_bf16 v[56:59], v[16:19], v[108:111], v[56:59]
    s_waitcnt lgkmcnt(3)
    v_mfma_f32_16x16x32_bf16 v[60:63], v[16:19], v[20:23], v[60:63]
    ds_read_b128 v[20:23], v1 offset:9216
    s_waitcnt lgkmcnt(3)
    v_mfma_f32_16x16x32_bf16 v[64:67], v[16:19], v[24:27], v[64:67]
    s_waitcnt lgkmcnt(2)
    v_mfma_f32_16x16x32_bf16 v[68:71], v[16:19], v[28:31], v[68:71]
    s_waitcnt lgkmcnt(1)
    v_mfma_f32_16x16x32_bf16 v[72:75], v[16:19], v[32:35], v[72:75]
    ds_read_b128 v[16:19], v3 offset:15360
    s_waitcnt lgkmcnt(1)
    v_mfma_f32_16x16x32_bf16 v[92:95], v[20:23], v[32:35], v[92:95]
    ds_read_b128 v[32:35], v0 offset:2048
    v_mfma_f32_16x16x32_bf16 v[88:91], v[20:23], v[28:31], v[88:91]
    ds_read_b128 v[28:31], v3 offset:6144
    v_mfma_f32_16x16x32_bf16 v[84:87], v[20:23], v[24:27], v[84:87]
    ds_read_b128 v[24:27], v3 offset:1024
    s_waitcnt lgkmcnt(3)
    v_mfma_f32_16x16x32_bf16 v[80:83], v[20:23], v[16:19], v[80:83]
    ds_read_b128 v[16:19], v3 offset:9216
    v_mfma_f32_16x16x32_bf16 v[76:79], v[20:23], v[108:111], v[76:79]
    ds_read_b128 v[20:23], v0 offset:10240
    s_waitcnt lgkmcnt(4)
    v_mfma_f32_16x16x32_bf16 v[56:59], v[32:35], v[112:115], v[56:59]
    v_mfma_f32_16x16x32_bf16 v[60:63], v[32:35], v[140:143], v[60:63]
    s_waitcnt lgkmcnt(3)
    v_mfma_f32_16x16x32_bf16 v[64:67], v[32:35], v[28:31], v[64:67]
    s_waitcnt lgkmcnt(2)
    v_mfma_f32_16x16x32_bf16 v[68:71], v[32:35], v[24:27], v[68:71]
    s_waitcnt lgkmcnt(1)
    v_mfma_f32_16x16x32_bf16 v[72:75], v[32:35], v[16:19], v[72:75]
    ds_read_b128 v[32:35], v1 offset:2048
    s_waitcnt lgkmcnt(1)
    v_mfma_f32_16x16x32_bf16 v[92:95], v[20:23], v[16:19], v[92:95]
    ds_read_b128 v[16:19], v3 offset:7168
    v_mfma_f32_16x16x32_bf16 v[88:91], v[20:23], v[24:27], v[88:91]
    ds_read_b128 v[24:27], v3 offset:2048
    v_mfma_f32_16x16x32_bf16 v[84:87], v[20:23], v[28:31], v[84:87]
    ds_read_b128 v[28:31], v3 offset:10240
    v_mfma_f32_16x16x32_bf16 v[80:83], v[20:23], v[140:143], v[80:83]
    v_mfma_f32_16x16x32_bf16 v[76:79], v[20:23], v[112:115], v[76:79]
    ds_read_b128 v[20:23], v1 offset:10240
    s_waitcnt lgkmcnt(4)
    v_mfma_f32_16x16x32_bf16 v[56:59], v[32:35], v[116:119], v[56:59]
    s_waitcnt vmcnt(0) lgkmcnt(0)
    s_barrier
    v_mfma_f32_16x16x32_bf16 v[60:63], v[32:35], v[144:147], v[60:63]
    v_mfma_f32_16x16x32_bf16 v[64:67], v[32:35], v[16:19], v[64:67]
    v_mfma_f32_16x16x32_bf16 v[68:71], v[32:35], v[24:27], v[68:71]
    v_mfma_f32_16x16x32_bf16 v[72:75], v[32:35], v[28:31], v[72:75]
    ds_read_b128 v[32:35], v0 offset:3072
    v_mfma_f32_16x16x32_bf16 v[92:95], v[20:23], v[28:31], v[92:95]
    ds_read_b128 v[28:31], v3 offset:13312
    v_mfma_f32_16x16x32_bf16 v[88:91], v[20:23], v[24:27], v[88:91]
    ds_read_b128 v[24:27], v3 offset:3072
    v_mfma_f32_16x16x32_bf16 v[84:87], v[20:23], v[16:19], v[84:87]
    ds_read_b128 v[16:19], v3 offset:11264
    v_mfma_f32_16x16x32_bf16 v[80:83], v[20:23], v[144:147], v[80:83]
    v_mfma_f32_16x16x32_bf16 v[76:79], v[20:23], v[116:119], v[76:79]
    ds_read_b128 v[20:23], v0 offset:11264
    s_waitcnt lgkmcnt(4)
    v_mfma_f32_16x16x32_bf16 v[56:59], v[32:35], v[120:123], v[56:59]
    v_mfma_f32_16x16x32_bf16 v[60:63], v[32:35], v[148:151], v[60:63]
    s_waitcnt lgkmcnt(3)
    v_mfma_f32_16x16x32_bf16 v[64:67], v[32:35], v[28:31], v[64:67]
    s_waitcnt lgkmcnt(2)
    v_mfma_f32_16x16x32_bf16 v[68:71], v[32:35], v[24:27], v[68:71]
    s_waitcnt lgkmcnt(1)
    v_mfma_f32_16x16x32_bf16 v[72:75], v[32:35], v[16:19], v[72:75]
    ds_read_b128 v[32:35], v1 offset:3072
    s_waitcnt lgkmcnt(1)
    v_mfma_f32_16x16x32_bf16 v[92:95], v[20:23], v[16:19], v[92:95]
    ds_read_b128 v[16:19], v3 offset:14336
    v_mfma_f32_16x16x32_bf16 v[88:91], v[20:23], v[24:27], v[88:91]
    ds_read_b128 v[24:27], v3 offset:4096
    v_mfma_f32_16x16x32_bf16 v[84:87], v[20:23], v[28:31], v[84:87]
    ds_read_b128 v[28:31], v3 offset:12288
    v_mfma_f32_16x16x32_bf16 v[80:83], v[20:23], v[148:151], v[80:83]
    v_mfma_f32_16x16x32_bf16 v[76:79], v[20:23], v[120:123], v[76:79]
    ds_read_b128 v[20:23], v1 offset:11264
    s_waitcnt lgkmcnt(4)
    v_mfma_f32_16x16x32_bf16 v[56:59], v[32:35], v[124:127], v[56:59]
    v_mfma_f32_16x16x32_bf16 v[60:63], v[32:35], v[152:155], v[60:63]
    s_waitcnt lgkmcnt(3)
    v_mfma_f32_16x16x32_bf16 v[64:67], v[32:35], v[16:19], v[64:67]
    s_waitcnt lgkmcnt(2)
    v_mfma_f32_16x16x32_bf16 v[68:71], v[32:35], v[24:27], v[68:71]
    s_waitcnt lgkmcnt(1)
    v_mfma_f32_16x16x32_bf16 v[72:75], v[32:35], v[28:31], v[72:75]
    ds_read_b64_tr_b16 v[32:33], v2 offset:0
    s_waitcnt lgkmcnt(1)
    v_mfma_f32_16x16x32_bf16 v[92:95], v[20:23], v[28:31], v[92:95]
    ds_read_b64_tr_b16 v[34:35], v2 offset:8192
    v_mfma_f32_16x16x32_bf16 v[88:91], v[20:23], v[24:27], v[88:91]
    ds_read_b64_tr_b16 v[28:29], v2 offset:1024
    v_mfma_f32_16x16x32_bf16 v[84:87], v[20:23], v[16:19], v[84:87]
    ds_read_b64_tr_b16 v[30:31], v2 offset:9216
    v_mfma_f32_16x16x32_bf16 v[80:83], v[20:23], v[152:155], v[80:83]
    ds_read_b64_tr_b16 v[24:25], v2 offset:2048
    v_mfma_f32_16x16x32_bf16 v[76:79], v[20:23], v[124:127], v[76:79]
    ds_read_b64_tr_b16 v[26:27], v2 offset:10240
    s_waitcnt lgkmcnt(4)
    v_mfma_f32_16x16x32_bf16 a[0:3], v[36:39], v[32:35], a[0:3]
    ds_read_b64_tr_b16 v[16:17], v2 offset:3072
    v_mfma_f32_16x16x32_bf16 a[64:67], v[40:43], v[32:35], a[64:67]
    ds_read_b64_tr_b16 v[18:19], v2 offset:11264
    v_xor_b32 v2, 32, v2
    v_mfma_f32_16x16x32_bf16 a[128:131], v[44:47], v[32:35], a[128:131]
    ds_read_b64_tr_b16 v[20:21], v2 offset:0
    v_mfma_f32_16x16x32_bf16 a[192:195], v[48:51], v[32:35], a[192:195]
    ds_read_b64_tr_b16 v[22:23], v2 offset:8192
    v_mfma_f32_16x16x32_bf16 v[192:195], v[52:55], v[32:35], v[192:195]
    ds_read_b64_tr_b16 v[32:33], v2 offset:1024
    s_waitcnt lgkmcnt(7)
    v_mfma_f32_16x16x32_bf16 a[16:19], v[36:39], v[28:31], a[16:19]
    ds_read_b64_tr_b16 v[34:35], v2 offset:9216
    v_mfma_f32_16x16x32_bf16 a[80:83], v[40:43], v[28:31], a[80:83]
    v_exp_f32 v56, v56
    v_mfma_f32_16x16x32_bf16 a[144:147], v[44:47], v[28:31], a[144:147]
    v_exp_f32 v57, v57
    v_mfma_f32_16x16x32_bf16 a[208:211], v[48:51], v[28:31], a[208:211]
    v_exp_f32 v58, v58
    v_mfma_f32_16x16x32_bf16 v[208:211], v[52:55], v[28:31], v[208:211]
    s_waitcnt lgkmcnt(6)
    ds_read_b64_tr_b16 v[28:29], v2 offset:2048
    v_add_f32 v5, v56, v57
    v_mfma_f32_16x16x32_bf16 a[32:35], v[36:39], v[24:27], a[32:35]
    ds_read_b64_tr_b16 v[30:31], v2 offset:10240
    v_cvt_pk_bf16_f32 v56, v56, v57
    v_mfma_f32_16x16x32_bf16 a[96:99], v[40:43], v[24:27], a[96:99]
    v_exp_f32 v59, v59
    v_mfma_f32_16x16x32_bf16 a[160:163], v[44:47], v[24:27], a[160:163]
    v_exp_f32 v60, v60
    v_mfma_f32_16x16x32_bf16 a[224:227], v[48:51], v[24:27], a[224:227]
    v_exp_f32 v61, v61
    v_mfma_f32_16x16x32_bf16 v[224:227], v[52:55], v[24:27], v[224:227]
    s_waitcnt lgkmcnt(6)
    ds_read_b64_tr_b16 v[24:25], v2 offset:3072
    v_cvt_pk_bf16_f32 v57, v58, v59
    v_mfma_f32_16x16x32_bf16 a[48:51], v[36:39], v[16:19], a[48:51]
    ds_read_b64_tr_b16 v[26:27], v2 offset:11264
    v_xor_b32 v2, 64, v2
    v_mfma_f32_16x16x32_bf16 a[112:115], v[40:43], v[16:19], a[112:115]
    v_exp_f32 v62, v62
    v_mfma_f32_16x16x32_bf16 a[176:179], v[44:47], v[16:19], a[176:179]
    v_exp_f32 v63, v63
    v_mfma_f32_16x16x32_bf16 a[240:243], v[48:51], v[16:19], a[240:243]
    v_exp_f32 v64, v64
    v_mfma_f32_16x16x32_bf16 v[240:243], v[52:55], v[16:19], v[240:243]
    s_waitcnt lgkmcnt(6)
    ds_read_b64_tr_b16 v[16:17], v2 offset:0
    v_add_f32 v58, v58, v59
    v_mfma_f32_16x16x32_bf16 a[4:7], v[36:39], v[20:23], a[4:7]
    ds_read_b64_tr_b16 v[18:19], v2 offset:8192
    v_add_f32 v58, v58, v5
    v_mfma_f32_16x16x32_bf16 a[68:71], v[40:43], v[20:23], a[68:71]
    v_exp_f32 v65, v65
    v_mfma_f32_16x16x32_bf16 a[132:135], v[44:47], v[20:23], a[132:135]
    v_exp_f32 v66, v66
    v_mfma_f32_16x16x32_bf16 a[196:199], v[48:51], v[20:23], a[196:199]
    v_exp_f32 v67, v67
    v_mfma_f32_16x16x32_bf16 v[196:199], v[52:55], v[20:23], v[196:199]
    s_waitcnt lgkmcnt(6)
    ds_read_b64_tr_b16 v[20:21], v2 offset:1024
    v_add_f32 v5, v60, v61
    v_mfma_f32_16x16x32_bf16 a[20:23], v[36:39], v[32:35], a[20:23]
    ds_read_b64_tr_b16 v[22:23], v2 offset:9216
    v_cvt_pk_bf16_f32 v60, v60, v61
    v_mfma_f32_16x16x32_bf16 a[84:87], v[40:43], v[32:35], a[84:87]
    v_exp_f32 v68, v68
    v_mfma_f32_16x16x32_bf16 a[148:151], v[44:47], v[32:35], a[148:151]
    v_exp_f32 v69, v69
    v_mfma_f32_16x16x32_bf16 a[212:215], v[48:51], v[32:35], a[212:215]
    v_exp_f32 v70, v70
    v_mfma_f32_16x16x32_bf16 v[212:215], v[52:55], v[32:35], v[212:215]
    s_waitcnt lgkmcnt(6)
    ds_read_b64_tr_b16 v[32:33], v2 offset:2048
    v_cvt_pk_bf16_f32 v61, v62, v63
    v_mfma_f32_16x16x32_bf16 a[36:39], v[36:39], v[28:31], a[36:39]
    ds_read_b64_tr_b16 v[34:35], v2 offset:10240
    v_add_f32 v62, v62, v63
    v_mfma_f32_16x16x32_bf16 a[100:103], v[40:43], v[28:31], a[100:103]
    v_exp_f32 v71, v71
    v_mfma_f32_16x16x32_bf16 a[164:167], v[44:47], v[28:31], a[164:167]
    v_exp_f32 v72, v72
    v_mfma_f32_16x16x32_bf16 a[228:231], v[48:51], v[28:31], a[228:231]
    v_exp_f32 v73, v73
    v_mfma_f32_16x16x32_bf16 v[228:231], v[52:55], v[28:31], v[228:231]
    s_waitcnt lgkmcnt(6)
    ds_read_b64_tr_b16 v[28:29], v2 offset:3072
    v_add_f32 v62, v62, v5
    v_mfma_f32_16x16x32_bf16 a[52:55], v[36:39], v[24:27], a[52:55]
    ds_read_b64_tr_b16 v[30:31], v2 offset:11264
    v_xor_b32 v2, 32, v2
    v_mfma_f32_16x16x32_bf16 a[116:119], v[40:43], v[24:27], a[116:119]
    v_exp_f32 v74, v74
    v_mfma_f32_16x16x32_bf16 a[180:183], v[44:47], v[24:27], a[180:183]
    v_exp_f32 v75, v75
    v_mfma_f32_16x16x32_bf16 a[244:247], v[48:51], v[24:27], a[244:247]
    v_exp_f32 v92, v92
    v_mfma_f32_16x16x32_bf16 v[244:247], v[52:55], v[24:27], v[244:247]
    s_waitcnt lgkmcnt(6)
    ds_read_b64_tr_b16 v[24:25], v2 offset:0
    v_add_f32 v5, v64, v65
    v_mfma_f32_16x16x32_bf16 a[12:15], v[36:39], v[16:19], a[12:15]
    ds_read_b64_tr_b16 v[26:27], v2 offset:8192
    v_cvt_pk_bf16_f32 v64, v64, v65
    v_mfma_f32_16x16x32_bf16 a[76:79], v[40:43], v[16:19], a[76:79]
    v_exp_f32 v93, v93
    v_mfma_f32_16x16x32_bf16 a[140:143], v[44:47], v[16:19], a[140:143]
    v_exp_f32 v94, v94
    v_mfma_f32_16x16x32_bf16 a[204:207], v[48:51], v[16:19], a[204:207]
    v_exp_f32 v95, v95
    v_mfma_f32_16x16x32_bf16 v[204:207], v[52:55], v[16:19], v[204:207]
    s_waitcnt lgkmcnt(6)
    ds_read_b64_tr_b16 v[16:17], v2 offset:1024
    v_cvt_pk_bf16_f32 v65, v66, v67
    v_mfma_f32_16x16x32_bf16 a[28:31], v[36:39], v[20:23], a[28:31]
    ds_read_b64_tr_b16 v[18:19], v2 offset:9216
    v_add_f32 v66, v66, v67
    v_mfma_f32_16x16x32_bf16 a[92:95], v[40:43], v[20:23], a[92:95]
    v_exp_f32 v88, v88
    v_mfma_f32_16x16x32_bf16 a[156:159], v[44:47], v[20:23], a[156:159]
    v_exp_f32 v89, v89
    v_mfma_f32_16x16x32_bf16 a[220:223], v[48:51], v[20:23], a[220:223]
    v_exp_f32 v90, v90
    v_mfma_f32_16x16x32_bf16 v[220:223], v[52:55], v[20:23], v[220:223]
    s_waitcnt lgkmcnt(6)
    ds_read_b64_tr_b16 v[20:21], v2 offset:2048
    v_add_f32 v66, v66, v5
    v_mfma_f32_16x16x32_bf16 a[44:47], v[36:39], v[32:35], a[44:47]
    ds_read_b64_tr_b16 v[22:23], v2 offset:10240
    v_add_f32 v5, v68, v69
    v_mfma_f32_16x16x32_bf16 a[108:111], v[40:43], v[32:35], a[108:111]
    v_exp_f32 v91, v91
    v_mfma_f32_16x16x32_bf16 a[172:175], v[44:47], v[32:35], a[172:175]
    v_exp_f32 v84, v84
    v_mfma_f32_16x16x32_bf16 a[236:239], v[48:51], v[32:35], a[236:239]
    v_exp_f32 v85, v85
    v_mfma_f32_16x16x32_bf16 v[236:239], v[52:55], v[32:35], v[236:239]
    s_waitcnt lgkmcnt(6)
    ds_read_b64_tr_b16 v[32:33], v2 offset:3072
    v_cvt_pk_bf16_f32 v68, v68, v69
    v_mfma_f32_16x16x32_bf16 a[60:63], v[36:39], v[28:31], a[60:63]
    ds_read_b64_tr_b16 v[34:35], v2 offset:11264
    v_xad_u32 v2, v2, 64, s30
    v_mfma_f32_16x16x32_bf16 a[124:127], v[40:43], v[28:31], a[124:127]
    v_exp_f32 v86, v86
    v_mfma_f32_16x16x32_bf16 a[188:191], v[44:47], v[28:31], a[188:191]
    v_exp_f32 v87, v87
    v_mfma_f32_16x16x32_bf16 a[252:255], v[48:51], v[28:31], a[252:255]
    v_exp_f32 v80, v80
    v_mfma_f32_16x16x32_bf16 v[252:255], v[52:55], v[28:31], v[252:255]
    s_waitcnt lgkmcnt(6)
    ds_read_b64_tr_b16 v[28:29], v2 offset:0
    v_cvt_pk_bf16_f32 v69, v70, v71
    v_mfma_f32_16x16x32_bf16 a[8:11], v[36:39], v[24:27], a[8:11]
    ds_read_b64_tr_b16 v[30:31], v2 offset:8192
    v_xor_b32 v2, 32, v2
    v_mfma_f32_16x16x32_bf16 a[72:75], v[40:43], v[24:27], a[72:75]
    v_exp_f32 v81, v81
    v_mfma_f32_16x16x32_bf16 a[136:139], v[44:47], v[24:27], a[136:139]
    v_exp_f32 v82, v82
    v_mfma_f32_16x16x32_bf16 a[200:203], v[48:51], v[24:27], a[200:203]
    v_exp_f32 v83, v83
    v_mfma_f32_16x16x32_bf16 v[200:203], v[52:55], v[24:27], v[200:203]
    s_waitcnt lgkmcnt(6)
    ds_read_b64_tr_b16 v[24:25], v2 offset:0
    v_add_f32 v70, v70, v71
    v_mfma_f32_16x16x32_bf16 a[24:27], v[36:39], v[16:19], a[24:27]
    ds_read_b64_tr_b16 v[26:27], v2 offset:8192
    v_xor_b32 v2, 64, v2
    v_mfma_f32_16x16x32_bf16 a[88:91], v[40:43], v[16:19], a[88:91]
    v_exp_f32 v76, v76
    v_mfma_f32_16x16x32_bf16 a[152:155], v[44:47], v[16:19], a[152:155]
    v_exp_f32 v77, v77
    v_mfma_f32_16x16x32_bf16 a[216:219], v[48:51], v[16:19], a[216:219]
    v_exp_f32 v78, v78
    v_mfma_f32_16x16x32_bf16 v[216:219], v[52:55], v[16:19], v[216:219]
    s_waitcnt lgkmcnt(6)
    ds_read_b64_tr_b16 v[16:17], v2 offset:0
    v_add_f32 v70, v70, v5
    v_mfma_f32_16x16x32_bf16 a[40:43], v[36:39], v[20:23], a[40:43]
    ds_read_b64_tr_b16 v[18:19], v2 offset:8192
    v_xor_b32 v2, 32, v2
    v_mfma_f32_16x16x32_bf16 a[104:107], v[40:43], v[20:23], a[104:107]
    v_exp_f32 v79, v79
    v_mfma_f32_16x16x32_bf16 a[168:171], v[44:47], v[20:23], a[168:171]
    v_add_f32 v5, v72, v73
    v_cvt_pk_bf16_f32 v72, v72, v73
    v_mfma_f32_16x16x32_bf16 a[232:235], v[48:51], v[20:23], a[232:235]
    v_cvt_pk_bf16_f32 v73, v74, v75
    v_add_f32 v74, v74, v75
    v_mfma_f32_16x16x32_bf16 v[232:235], v[52:55], v[20:23], v[232:235]
    s_waitcnt lgkmcnt(6)
    ds_read_b64_tr_b16 v[20:21], v2 offset:0
    v_add_f32 v74, v74, v5
    v_mfma_f32_16x16x32_bf16 a[56:59], v[36:39], v[32:35], a[56:59]
    ds_read_b64_tr_b16 v[22:23], v2 offset:8192
    v_add_f32 v75, v74, v92
    v_mfma_f32_16x16x32_bf16 a[120:123], v[40:43], v[32:35], a[120:123]
    v_cvt_pk_bf16_f32 v74, v92, v93
    v_add_f32 v92, v75, v93
    v_mfma_f32_16x16x32_bf16 a[184:187], v[44:47], v[32:35], a[184:187]
    v_add_f32 v92, v92, v94
    v_cvt_pk_bf16_f32 v75, v94, v95
    v_mfma_f32_16x16x32_bf16 a[248:251], v[48:51], v[32:35], a[248:251]
    v_add_f32 v92, v92, v95
    v_add_f32 v71, v70, v88
    v_mfma_f32_16x16x32_bf16 v[248:251], v[52:55], v[32:35], v[248:251]
    s_waitcnt lgkmcnt(6)
    v_cvt_pk_bf16_f32 v70, v88, v89
    s_nop 0
    v_add_f32 v88, v71, v89
    v_add_f32 v88, v88, v90
    v_cvt_pk_bf16_f32 v71, v90, v91
    v_add_f32 v88, v88, v91
    v_add_f32 v67, v66, v84
    v_cvt_pk_bf16_f32 v66, v84, v85
    v_add_f32 v84, v67, v85
    v_add_f32 v84, v84, v86
    v_cvt_pk_bf16_f32 v67, v86, v87
    v_add_f32 v84, v84, v87
    v_add_f32 v63, v62, v80
    v_cvt_pk_bf16_f32 v62, v80, v81
    v_add_f32 v80, v63, v81
    v_add_f32 v80, v80, v82
    v_cvt_pk_bf16_f32 v63, v82, v83
    v_add_f32 v80, v80, v83
    v_add_f32 v59, v58, v76
    v_cvt_pk_bf16_f32 v58, v76, v77
    v_add_f32 v76, v59, v77
    v_add_f32 v76, v76, v78
    v_cvt_pk_bf16_f32 v59, v78, v79
    v_add_f32 v76, v76, v79
    v_add_f32 v93, v92, v88
    v_add_f32 v93, v93, v84
    v_add_f32 v93, v93, v80
    v_add_f32 v93, v93, v76
    v_cmp_ngt_f32 vcc, s21, v93
    s_nop 3
    s_cbranch_vccnz L_convF
L_fretF:
L_final:
    s_add_u32 s34, s34, 98304
    s_mul_i32 s28, s31, 40960
    s_add_u32 s28, s28, s35
    s_waitcnt lgkmcnt(6)
    v_mfma_f32_16x16x32_bf16 a[0:3], v[56:59], v[28:31], a[0:3]
    s_add_u32 s56, s28, 0
    ds_read_b64_tr_b16 v[32:33], v2 offset:1024
    v_mbcnt_lo_u32_b32 v123, -1, 0
    v_mbcnt_hi_u32_b32 v123, -1, v123
    ds_read_b64_tr_b16 v[34:35], v2 offset:9216
    v_xor_b32 v2, 32, v2
    v_lshrrev_b32 v116, 4, v123
    v_lshlrev_b32 v116, 4, v116
    ds_read_b64_tr_b16 v[36:37], v2 offset:1024
    v_add_f32 v11, v11, v76
    v_add_f32 v12, v12, v80
    ds_read_b64_tr_b16 v[38:39], v2 offset:9216
    v_xor_b32 v2, 64, v2
    v_add_f32 v13, v13, v84
    s_waitcnt lgkmcnt(8)
    v_mfma_f32_16x16x32_bf16 a[4:7], v[56:59], v[24:27], a[4:7]
    s_add_u32 s57, s28, 8192
    v_add_f32 v14, v14, v88
    ds_read_b64_tr_b16 v[40:41], v2 offset:1024
    v_add_f32 v15, v15, v92
    v_mov_b32 v125, v15
    v_permlane32_swap_b32 v11, v12
    v_permlane32_swap_b32 v13, v14
    v_permlane32_swap_b32 v15, v125
    s_nop 0
    s_waitcnt lgkmcnt(7)
    v_mfma_f32_16x16x32_bf16 a[12:15], v[56:59], v[16:19], a[12:15]
    s_add_u32 s58, s28, 16384
    ds_read_b64_tr_b16 v[42:43], v2 offset:9216
    v_xor_b32 v2, 32, v2
    v_add_f32 v11, v11, v12
    v_add_f32 v13, v13, v14
    ds_read_b64_tr_b16 v[44:45], v2 offset:1024
    v_add_f32 v15, v15, v125
    v_mov_b32 v125, v15
    v_permlane16_swap_b32 v11, v13
    s_nop 0
    v_permlane16_swap_b32 v15, v125
    s_nop 0
    ds_read_b64_tr_b16 v[46:47], v2 offset:9216
    v_add_f32 v11, v11, v13
    v_add_f32 v15, v15, v125
    ds_read_b64_tr_b16 v[48:49], v2 offset:2048
    v_rcp_f32 v11, v11
    v_rcp_f32 v15, v15
    s_nop 0
    ds_bpermute_b32 v96, v116, v11 offset:0
    s_waitcnt lgkmcnt(10)
    v_mfma_f32_16x16x32_bf16 a[8:11], v[56:59], v[20:23], a[8:11]
    s_add_u32 s59, s28, 24576
    ds_read_b64_tr_b16 v[50:51], v2 offset:10240
    v_xor_b32 v2, 32, v2
    ds_bpermute_b32 v97, v116, v11 offset:4
    ds_bpermute_b32 v98, v116, v11 offset:8
    ds_read_b64_tr_b16 v[52:53], v2 offset:2048
    ds_bpermute_b32 v99, v116, v11 offset:12
    v_and_b32 v124, 7, v123
    ds_read_b64_tr_b16 v[54:55], v2 offset:10240
    v_xor_b32 v2, 64, v2
    v_lshlrev_b32 v120, 3, v124
    v_bfe_u32 v124, v123, 3, 1
    ds_read_b64_tr_b16 v[76:77], v2 offset:2048
    v_lshl_add_u32 v120, v124, 2, v120
    v_mfma_f32_16x16x32_bf16 a[64:67], v[60:63], v[28:31], a[64:67]
    s_add_u32 s60, s28, 32768
    v_lshl_add_u32 v120, v116, 2, v120
    ds_read_b64_tr_b16 v[78:79], v2 offset:10240
    v_xor_b32 v2, 32, v2
    v_add_u32 v120, s34, v120
    v_bfe_u32 v124, v123, 5, 1
    ds_read_b64_tr_b16 v[80:81], v2 offset:2048
    v_lshlrev_b32 v121, 9, v124
    v_and_b32 v124, 1, v123
    ds_read_b64_tr_b16 v[82:83], v2 offset:10240
    v_lshl_add_u32 v121, v124, 8, v121
    v_bfe_u32 v124, v123, 4, 1
    v_mfma_f32_16x16x32_bf16 a[68:71], v[60:63], v[24:27], a[68:71]
    ds_read_b64_tr_b16 v[84:85], v2 offset:3072
    v_lshl_add_u32 v121, v124, 7, v121
    v_bfe_u32 v124, v123, 1, 1
    ds_read_b64_tr_b16 v[86:87], v2 offset:11264
    v_xor_b32 v2, 32, v2
    v_lshl_add_u32 v121, v124, 6, v121
    v_bfe_u32 v124, v123, 2, 2
    ds_read_b64_tr_b16 v[88:89], v2 offset:3072
    v_lshl_add_u32 v121, v124, 3, v121
    v_add_u32 v121, s34, v121
    ds_read_b64_tr_b16 v[90:91], v2 offset:11264
    v_xor_b32 v2, 64, v2
    v_bfe_u32 v124, v123, 4, 1
    v_mfma_f32_16x16x32_bf16 a[76:79], v[60:63], v[16:19], a[76:79]
    v_lshlrev_b32 v122, 12, v124
    ds_read_b64_tr_b16 v[92:93], v2 offset:3072
    v_bfe_u32 v124, v123, 3, 1
    v_lshl_add_u32 v122, v124, 11, v122
    ds_read_b64_tr_b16 v[94:95], v2 offset:11264
    v_xor_b32 v2, 32, v2
    v_bfe_u32 v124, v123, 5, 1
    v_lshl_add_u32 v122, v124, 9, v122
    ds_read_b64_tr_b16 v[6:7], v2 offset:3072
    v_bfe_u32 v124, v123, 2, 1
    v_lshl_add_u32 v122, v124, 6, v122
    v_mfma_f32_16x16x32_bf16 a[72:75], v[60:63], v[20:23], a[72:75]
    ds_read_b64_tr_b16 v[8:9], v2 offset:11264
    v_and_b32 v124, 1, v123
    v_lshl_add_u32 v122, v124, 5, v122
    v_bfe_u32 v124, v123, 1, 1
    v_lshl_add_u32 v122, v124, 4, v122
    s_waitcnt lgkmcnt(15)
    v_mfma_f32_16x16x32_bf16 a[24:27], v[56:59], v[32:35], a[24:27]
    v_accvgpr_read_b32 v128, a0
    v_accvgpr_read_b32 v129, a4
    v_accvgpr_read_b32 v130, a8
    v_mfma_f32_16x16x32_bf16 a[28:31], v[56:59], v[36:39], a[28:31]
    v_accvgpr_read_b32 v131, a12
    v_accvgpr_read_b32 v132, a1
    v_accvgpr_read_b32 v133, a5
    v_mfma_f32_16x16x32_bf16 a[20:23], v[56:59], v[40:43], a[20:23]
    v_accvgpr_read_b32 v134, a9
    v_accvgpr_read_b32 v135, a13
    v_accvgpr_read_b32 v136, a2
    v_mfma_f32_16x16x32_bf16 a[16:19], v[56:59], v[44:47], a[16:19]
    v_accvgpr_read_b32 v137, a6
    v_accvgpr_read_b32 v138, a10
    v_accvgpr_read_b32 v139, a14
    v_accvgpr_read_b32 v140, a3
    v_accvgpr_read_b32 v141, a7
    v_accvgpr_read_b32 v142, a11
    v_accvgpr_read_b32 v143, a15
    v_pk_mul_f32 v[128:129], v[128:129], v[96:97] op_sel:[0,0] op_sel_hi:[1,0]
    v_pk_mul_f32 v[130:131], v[130:131], v[96:97] op_sel:[0,0] op_sel_hi:[1,0]
    v_pk_mul_f32 v[132:133], v[132:133], v[96:97] op_sel:[0,1] op_sel_hi:[1,1]
    ds_bpermute_b32 v100, v116, v11 offset:128
    v_pk_mul_f32 v[134:135], v[134:135], v[96:97] op_sel:[0,1] op_sel_hi:[1,1]
    s_waitcnt lgkmcnt(14)
    v_pk_mul_f32 v[136:137], v[136:137], v[98:99] op_sel:[0,0] op_sel_hi:[1,0]
    v_pk_mul_f32 v[138:139], v[138:139], v[98:99] op_sel:[0,0] op_sel_hi:[1,0]
    v_pk_mul_f32 v[140:141], v[140:141], v[98:99] op_sel:[0,1] op_sel_hi:[1,1]
    ds_bpermute_b32 v101, v116, v11 offset:132
    v_pk_mul_f32 v[142:143], v[142:143], v[98:99] op_sel:[0,1] op_sel_hi:[1,1]
    v_cvt_pk_bf16_f32 v160, v128, v129
    v_cvt_pk_bf16_f32 v161, v130, v131
    v_cvt_pk_bf16_f32 v162, v132, v133
    ds_bpermute_b32 v102, v116, v11 offset:136
    v_cvt_pk_bf16_f32 v163, v134, v135
    v_cvt_pk_bf16_f32 v164, v136, v137
    v_cvt_pk_bf16_f32 v165, v138, v139
    v_cvt_pk_bf16_f32 v166, v140, v141
    ds_bpermute_b32 v103, v116, v11 offset:140
    v_cvt_pk_bf16_f32 v167, v142, v143
    v_mfma_f32_16x16x32_bf16 a[32:35], v[56:59], v[48:51], a[32:35]
    ds_write2st64_b32 v120, v160, v161 offset0:0 offset1:1
    v_accvgpr_read_b32 v144, a16
    v_accvgpr_read_b32 v145, a20
    v_accvgpr_read_b32 v146, a24
    s_waitcnt lgkmcnt(15)
    v_mfma_f32_16x16x32_bf16 a[36:39], v[56:59], v[52:55], a[36:39]
    ds_write2st64_b32 v120, v162, v163 offset0:2 offset1:3
    v_accvgpr_read_b32 v147, a28
    v_accvgpr_read_b32 v148, a17
    v_accvgpr_read_b32 v149, a21
    v_mfma_f32_16x16x32_bf16 a[44:47], v[56:59], v[76:79], a[44:47]
    ds_write2st64_b32 v120, v164, v165 offset0:4 offset1:5
    v_accvgpr_read_b32 v150, a25
    v_accvgpr_read_b32 v151, a29
    v_accvgpr_read_b32 v152, a18
    s_waitcnt lgkmcnt(15)
    v_mfma_f32_16x16x32_bf16 a[40:43], v[56:59], v[80:83], a[40:43]
    ds_write2st64_b32 v120, v166, v167 offset0:6 offset1:7
    v_accvgpr_read_b32 v153, a22
    v_accvgpr_read_b32 v154, a26
    v_accvgpr_read_b32 v155, a30
    v_accvgpr_read_b32 v156, a19
    v_accvgpr_read_b32 v157, a23
    v_accvgpr_read_b32 v158, a27
    v_accvgpr_read_b32 v159, a31
    v_pk_mul_f32 v[144:145], v[144:145], v[96:97] op_sel:[0,0] op_sel_hi:[1,0]
    ds_read_b64_tr_b16 v[176:177], v121 offset:0
    v_pk_mul_f32 v[146:147], v[146:147], v[96:97] op_sel:[0,0] op_sel_hi:[1,0]
    v_pk_mul_f32 v[148:149], v[148:149], v[96:97] op_sel:[0,1] op_sel_hi:[1,1]
    ds_bpermute_b32 v104, v116, v11 offset:64
    v_pk_mul_f32 v[150:151], v[150:151], v[96:97] op_sel:[0,1] op_sel_hi:[1,1]
    v_pk_mul_f32 v[152:153], v[152:153], v[98:99] op_sel:[0,0] op_sel_hi:[1,0]
    ds_read_b64_tr_b16 v[178:179], v121 offset:32
    v_pk_mul_f32 v[154:155], v[154:155], v[98:99] op_sel:[0,0] op_sel_hi:[1,0]
    v_pk_mul_f32 v[156:157], v[156:157], v[98:99] op_sel:[0,1] op_sel_hi:[1,1]
    ds_bpermute_b32 v105, v116, v11 offset:68
    v_pk_mul_f32 v[158:159], v[158:159], v[98:99] op_sel:[0,1] op_sel_hi:[1,1]
    v_cvt_pk_bf16_f32 v168, v144, v145
    ds_read_b64_tr_b16 v[180:181], v121 offset:1024
    v_cvt_pk_bf16_f32 v169, v146, v147
    v_cvt_pk_bf16_f32 v170, v148, v149
    ds_bpermute_b32 v106, v116, v11 offset:72
    v_cvt_pk_bf16_f32 v171, v150, v151
    v_cvt_pk_bf16_f32 v172, v152, v153
    ds_read_b64_tr_b16 v[182:183], v121 offset:1056
    v_cvt_pk_bf16_f32 v173, v154, v155
    v_cvt_pk_bf16_f32 v174, v156, v157
    ds_bpermute_b32 v107, v116, v11 offset:76
    v_cvt_pk_bf16_f32 v175, v158, v159
    s_waitcnt lgkmcnt(15)
    v_mfma_f32_16x16x32_bf16 a[56:59], v[56:59], v[84:87], a[56:59]
    ds_write2st64_b32 v120, v168, v169 offset0:8 offset1:9
    v_accvgpr_read_b32 v128, a32
    v_accvgpr_read_b32 v129, a36
    v_accvgpr_read_b32 v130, a40
    v_mfma_f32_16x16x32_bf16 a[60:63], v[56:59], v[88:91], a[60:63]
    ds_write2st64_b32 v120, v170, v171 offset0:10 offset1:11
    v_accvgpr_read_b32 v131, a44
    v_accvgpr_read_b32 v132, a33
    v_accvgpr_read_b32 v133, a37
    v_mfma_f32_16x16x32_bf16 a[52:55], v[56:59], v[92:95], a[52:55]
    ds_write2st64_b32 v120, v172, v173 offset0:12 offset1:13
    v_accvgpr_read_b32 v134, a41
    v_accvgpr_read_b32 v135, a45
    v_accvgpr_read_b32 v136, a34
    v_mfma_f32_16x16x32_bf16 a[48:51], v[56:59], v[6:9], a[48:51]
    ds_write2st64_b32 v120, v174, v175 offset0:14 offset1:15
    v_accvgpr_read_b32 v137, a38
    v_accvgpr_read_b32 v138, a42
    v_accvgpr_read_b32 v139, a46
    s_waitcnt lgkmcnt(9)
    buffer_store_dwordx4 v[176:179], v122, s[16:19], s56 offen offset:0 nt
    v_accvgpr_read_b32 v140, a35
    v_accvgpr_read_b32 v141, a39
    v_accvgpr_read_b32 v142, a43
    s_waitcnt lgkmcnt(5)
    buffer_store_dwordx4 v[180:183], v122, s[16:19], s56 offen offset:1024 nt
    v_accvgpr_read_b32 v143, a47
    v_pk_mul_f32 v[128:129], v[128:129], v[96:97] op_sel:[0,0] op_sel_hi:[1,0]
    ds_read_b64_tr_b16 v[184:185], v121 offset:2048
    v_pk_mul_f32 v[130:131], v[130:131], v[96:97] op_sel:[0,0] op_sel_hi:[1,0]
    v_pk_mul_f32 v[132:133], v[132:133], v[96:97] op_sel:[0,1] op_sel_hi:[1,1]
    ds_bpermute_b32 v108, v116, v11 offset:192
    v_pk_mul_f32 v[134:135], v[134:135], v[96:97] op_sel:[0,1] op_sel_hi:[1,1]
    v_pk_mul_f32 v[136:137], v[136:137], v[98:99] op_sel:[0,0] op_sel_hi:[1,0]
    ds_read_b64_tr_b16 v[186:187], v121 offset:2080
    v_pk_mul_f32 v[138:139], v[138:139], v[98:99] op_sel:[0,0] op_sel_hi:[1,0]
    v_pk_mul_f32 v[140:141], v[140:141], v[98:99] op_sel:[0,1] op_sel_hi:[1,1]
    ds_bpermute_b32 v109, v116, v11 offset:196
    v_pk_mul_f32 v[142:143], v[142:143], v[98:99] op_sel:[0,1] op_sel_hi:[1,1]
    v_cvt_pk_bf16_f32 v160, v128, v129
    ds_read_b64_tr_b16 v[188:189], v121 offset:3072
    v_cvt_pk_bf16_f32 v161, v130, v131
    v_cvt_pk_bf16_f32 v162, v132, v133
    ds_bpermute_b32 v110, v116, v11 offset:200
    v_cvt_pk_bf16_f32 v163, v134, v135
    v_cvt_pk_bf16_f32 v164, v136, v137
    ds_read_b64_tr_b16 v[190:191], v121 offset:3104
    v_cvt_pk_bf16_f32 v165, v138, v139
    v_cvt_pk_bf16_f32 v166, v140, v141
    ds_bpermute_b32 v111, v116, v11 offset:204
    v_cvt_pk_bf16_f32 v167, v142, v143
    v_mfma_f32_16x16x32_bf16 a[88:91], v[60:63], v[32:35], a[88:91]
    ds_write2st64_b32 v120, v160, v161 offset0:16 offset1:17
    v_accvgpr_read_b32 v144, a48
    v_accvgpr_read_b32 v145, a52
    v_accvgpr_read_b32 v146, a56
    v_mfma_f32_16x16x32_bf16 a[92:95], v[60:63], v[36:39], a[92:95]
    ds_write2st64_b32 v120, v162, v163 offset0:18 offset1:19
    v_accvgpr_read_b32 v147, a60
    v_accvgpr_read_b32 v148, a49
    v_accvgpr_read_b32 v149, a53
    v_mfma_f32_16x16x32_bf16 a[84:87], v[60:63], v[40:43], a[84:87]
    ds_write2st64_b32 v120, v164, v165 offset0:20 offset1:21
    v_accvgpr_read_b32 v150, a57
    v_accvgpr_read_b32 v151, a61
    v_accvgpr_read_b32 v152, a50
    v_mfma_f32_16x16x32_bf16 a[80:83], v[60:63], v[44:47], a[80:83]
    ds_write2st64_b32 v120, v166, v167 offset0:22 offset1:23
    v_accvgpr_read_b32 v153, a54
    v_accvgpr_read_b32 v154, a58
    v_accvgpr_read_b32 v155, a62
    s_waitcnt lgkmcnt(9)
    buffer_store_dwordx4 v[184:187], v122, s[16:19], s56 offen offset:128 nt
    v_accvgpr_read_b32 v156, a51
    v_accvgpr_read_b32 v157, a55
    v_accvgpr_read_b32 v158, a59
    s_waitcnt lgkmcnt(5)
    buffer_store_dwordx4 v[188:191], v122, s[16:19], s56 offen offset:1152 nt
    v_accvgpr_read_b32 v159, a63
    v_pk_mul_f32 v[144:145], v[144:145], v[96:97] op_sel:[0,0] op_sel_hi:[1,0]
    ds_read_b64_tr_b16 v[176:177], v121 offset:4096
    v_pk_mul_f32 v[146:147], v[146:147], v[96:97] op_sel:[0,0] op_sel_hi:[1,0]
    v_pk_mul_f32 v[148:149], v[148:149], v[96:97] op_sel:[0,1] op_sel_hi:[1,1]
    ds_bpermute_b32 v112, v116, v15 offset:0
    v_pk_mul_f32 v[150:151], v[150:151], v[96:97] op_sel:[0,1] op_sel_hi:[1,1]
    v_pk_mul_f32 v[152:153], v[152:153], v[98:99] op_sel:[0,0] op_sel_hi:[1,0]
    ds_read_b64_tr_b16 v[178:179], v121 offset:4128
    v_pk_mul_f32 v[154:155], v[154:155], v[98:99] op_sel:[0,0] op_sel_hi:[1,0]
    v_pk_mul_f32 v[156:157], v[156:157], v[98:99] op_sel:[0,1] op_sel_hi:[1,1]
    ds_bpermute_b32 v113, v116, v15 offset:4
    v_pk_mul_f32 v[158:159], v[158:159], v[98:99] op_sel:[0,1] op_sel_hi:[1,1]
    v_cvt_pk_bf16_f32 v168, v144, v145
    ds_read_b64_tr_b16 v[180:181], v121 offset:5120
    v_cvt_pk_bf16_f32 v169, v146, v147
    v_cvt_pk_bf16_f32 v170, v148, v149
    ds_bpermute_b32 v114, v116, v15 offset:8
    v_cvt_pk_bf16_f32 v171, v150, v151
    v_cvt_pk_bf16_f32 v172, v152, v153
    ds_read_b64_tr_b16 v[182:183], v121 offset:5152
    v_cvt_pk_bf16_f32 v173, v154, v155
    v_cvt_pk_bf16_f32 v174, v156, v157
    ds_bpermute_b32 v115, v116, v15 offset:12
    v_cvt_pk_bf16_f32 v175, v158, v159
    v_mfma_f32_16x16x32_bf16 a[96:99], v[60:63], v[48:51], a[96:99]
    ds_write2st64_b32 v120, v168, v169 offset0:24 offset1:25
    v_accvgpr_read_b32 v128, a64
    v_accvgpr_read_b32 v129, a68
    v_accvgpr_read_b32 v130, a72
    v_mfma_f32_16x16x32_bf16 a[100:103], v[60:63], v[52:55], a[100:103]
    ds_write2st64_b32 v120, v170, v171 offset0:26 offset1:27
    v_accvgpr_read_b32 v131, a76
    v_accvgpr_read_b32 v132, a65
    v_accvgpr_read_b32 v133, a69
    v_mfma_f32_16x16x32_bf16 a[108:111], v[60:63], v[76:79], a[108:111]
    ds_write2st64_b32 v120, v172, v173 offset0:28 offset1:29
    v_accvgpr_read_b32 v134, a73
    v_accvgpr_read_b32 v135, a77
    v_accvgpr_read_b32 v136, a66
    v_mfma_f32_16x16x32_bf16 a[104:107], v[60:63], v[80:83], a[104:107]
    ds_write2st64_b32 v120, v174, v175 offset0:30 offset1:31
    v_accvgpr_read_b32 v137, a70
    v_accvgpr_read_b32 v138, a74
    v_accvgpr_read_b32 v139, a78
    s_waitcnt lgkmcnt(9)
    buffer_store_dwordx4 v[176:179], v122, s[16:19], s56 offen offset:256 nt
    v_accvgpr_read_b32 v140, a67
    v_accvgpr_read_b32 v141, a71
    v_accvgpr_read_b32 v142, a75
    s_waitcnt lgkmcnt(5)
    buffer_store_dwordx4 v[180:183], v122, s[16:19], s56 offen offset:1280 nt
    v_accvgpr_read_b32 v143, a79
    v_pk_mul_f32 v[128:129], v[128:129], v[100:101] op_sel:[0,0] op_sel_hi:[1,0]
    ds_read_b64_tr_b16 v[184:185], v121 offset:6144
    v_pk_mul_f32 v[130:131], v[130:131], v[100:101] op_sel:[0,0] op_sel_hi:[1,0]
    v_pk_mul_f32 v[132:133], v[132:133], v[100:101] op_sel:[0,1] op_sel_hi:[1,1]
    v_pk_mul_f32 v[134:135], v[134:135], v[100:101] op_sel:[0,1] op_sel_hi:[1,1]
    v_pk_mul_f32 v[136:137], v[136:137], v[102:103] op_sel:[0,0] op_sel_hi:[1,0]
    ds_read_b64_tr_b16 v[186:187], v121 offset:6176
    v_pk_mul_f32 v[138:139], v[138:139], v[102:103] op_sel:[0,0] op_sel_hi:[1,0]
    v_pk_mul_f32 v[140:141], v[140:141], v[102:103] op_sel:[0,1] op_sel_hi:[1,1]
    v_pk_mul_f32 v[142:143], v[142:143], v[102:103] op_sel:[0,1] op_sel_hi:[1,1]
    v_cvt_pk_bf16_f32 v160, v128, v129
    ds_read_b64_tr_b16 v[188:189], v121 offset:7168
    v_cvt_pk_bf16_f32 v161, v130, v131
    v_cvt_pk_bf16_f32 v162, v132, v133
    v_cvt_pk_bf16_f32 v163, v134, v135
    v_cvt_pk_bf16_f32 v164, v136, v137
    ds_read_b64_tr_b16 v[190:191], v121 offset:7200
    v_cvt_pk_bf16_f32 v165, v138, v139
    v_cvt_pk_bf16_f32 v166, v140, v141
    v_cvt_pk_bf16_f32 v167, v142, v143
    v_mfma_f32_16x16x32_bf16 a[120:123], v[60:63], v[84:87], a[120:123]
    ds_write2st64_b32 v120, v160, v161 offset0:32 offset1:33
    v_accvgpr_read_b32 v144, a80
    v_accvgpr_read_b32 v145, a84
    v_accvgpr_read_b32 v146, a88
    v_mfma_f32_16x16x32_bf16 a[124:127], v[60:63], v[88:91], a[124:127]
    ds_write2st64_b32 v120, v162, v163 offset0:34 offset1:35
    v_accvgpr_read_b32 v147, a92
    v_accvgpr_read_b32 v148, a81
    v_accvgpr_read_b32 v149, a85
    v_mfma_f32_16x16x32_bf16 a[116:119], v[60:63], v[92:95], a[116:119]
    ds_write2st64_b32 v120, v164, v165 offset0:36 offset1:37
    v_accvgpr_read_b32 v150, a89
    v_accvgpr_read_b32 v151, a93
    v_accvgpr_read_b32 v152, a82
    v_mfma_f32_16x16x32_bf16 a[112:115], v[60:63], v[6:9], a[112:115]
    ds_write2st64_b32 v120, v166, v167 offset0:38 offset1:39
    v_accvgpr_read_b32 v153, a86
    v_accvgpr_read_b32 v154, a90
    v_accvgpr_read_b32 v155, a94
    s_waitcnt lgkmcnt(6)
    buffer_store_dwordx4 v[184:187], v122, s[16:19], s56 offen offset:384 nt
    v_accvgpr_read_b32 v156, a83
    v_accvgpr_read_b32 v157, a87
    v_accvgpr_read_b32 v158, a91
    s_waitcnt lgkmcnt(4)
    buffer_store_dwordx4 v[188:191], v122, s[16:19], s56 offen offset:1408 nt
    v_accvgpr_read_b32 v159, a95
    v_pk_mul_f32 v[144:145], v[144:145], v[100:101] op_sel:[0,0] op_sel_hi:[1,0]
    ds_read_b64_tr_b16 v[176:177], v121 offset:8192
    v_pk_mul_f32 v[146:147], v[146:147], v[100:101] op_sel:[0,0] op_sel_hi:[1,0]
    v_pk_mul_f32 v[148:149], v[148:149], v[100:101] op_sel:[0,1] op_sel_hi:[1,1]
    v_pk_mul_f32 v[150:151], v[150:151], v[100:101] op_sel:[0,1] op_sel_hi:[1,1]
    v_pk_mul_f32 v[152:153], v[152:153], v[102:103] op_sel:[0,0] op_sel_hi:[1,0]
    ds_read_b64_tr_b16 v[178:179], v121 offset:8224
    v_pk_mul_f32 v[154:155], v[154:155], v[102:103] op_sel:[0,0] op_sel_hi:[1,0]
    v_pk_mul_f32 v[156:157], v[156:157], v[102:103] op_sel:[0,1] op_sel_hi:[1,1]
    v_pk_mul_f32 v[158:159], v[158:159], v[102:103] op_sel:[0,1] op_sel_hi:[1,1]
    v_cvt_pk_bf16_f32 v168, v144, v145
    ds_read_b64_tr_b16 v[180:181], v121 offset:9216
    v_cvt_pk_bf16_f32 v169, v146, v147
    v_cvt_pk_bf16_f32 v170, v148, v149
    v_cvt_pk_bf16_f32 v171, v150, v151
    v_cvt_pk_bf16_f32 v172, v152, v153
    ds_read_b64_tr_b16 v[182:183], v121 offset:9248
    v_cvt_pk_bf16_f32 v173, v154, v155
    v_cvt_pk_bf16_f32 v174, v156, v157
    v_cvt_pk_bf16_f32 v175, v158, v159
    v_mfma_f32_16x16x32_bf16 a[128:131], v[64:67], v[28:31], a[128:131]
    ds_write2st64_b32 v120, v168, v169 offset0:40 offset1:41
    v_accvgpr_read_b32 v128, a96
    v_accvgpr_read_b32 v129, a100
    v_accvgpr_read_b32 v130, a104
    v_mfma_f32_16x16x32_bf16 a[132:135], v[64:67], v[24:27], a[132:135]
    ds_write2st64_b32 v120, v170, v171 offset0:42 offset1:43
    v_accvgpr_read_b32 v131, a108
    v_accvgpr_read_b32 v132, a97
    v_accvgpr_read_b32 v133, a101
    v_mfma_f32_16x16x32_bf16 a[140:143], v[64:67], v[16:19], a[140:143]
    ds_write2st64_b32 v120, v172, v173 offset0:44 offset1:45
    v_accvgpr_read_b32 v134, a105
    v_accvgpr_read_b32 v135, a109
    v_accvgpr_read_b32 v136, a98
    v_mfma_f32_16x16x32_bf16 a[136:139], v[64:67], v[20:23], a[136:139]
    ds_write2st64_b32 v120, v174, v175 offset0:46 offset1:47
    v_accvgpr_read_b32 v137, a102
    v_accvgpr_read_b32 v138, a106
    v_accvgpr_read_b32 v139, a110
    s_waitcnt lgkmcnt(6)
    buffer_store_dwordx4 v[176:179], v122, s[16:19], s57 offen offset:0 nt
    v_accvgpr_read_b32 v140, a99
    v_accvgpr_read_b32 v141, a103
    v_accvgpr_read_b32 v142, a107
    s_waitcnt lgkmcnt(4)
    buffer_store_dwordx4 v[180:183], v122, s[16:19], s57 offen offset:1024 nt
    v_accvgpr_read_b32 v143, a111
    v_pk_mul_f32 v[128:129], v[128:129], v[100:101] op_sel:[0,0] op_sel_hi:[1,0]
    ds_read_b64_tr_b16 v[184:185], v121 offset:10240
    v_pk_mul_f32 v[130:131], v[130:131], v[100:101] op_sel:[0,0] op_sel_hi:[1,0]
    v_pk_mul_f32 v[132:133], v[132:133], v[100:101] op_sel:[0,1] op_sel_hi:[1,1]
    v_pk_mul_f32 v[134:135], v[134:135], v[100:101] op_sel:[0,1] op_sel_hi:[1,1]
    v_pk_mul_f32 v[136:137], v[136:137], v[102:103] op_sel:[0,0] op_sel_hi:[1,0]
    ds_read_b64_tr_b16 v[186:187], v121 offset:10272
    v_pk_mul_f32 v[138:139], v[138:139], v[102:103] op_sel:[0,0] op_sel_hi:[1,0]
    v_pk_mul_f32 v[140:141], v[140:141], v[102:103] op_sel:[0,1] op_sel_hi:[1,1]
    v_pk_mul_f32 v[142:143], v[142:143], v[102:103] op_sel:[0,1] op_sel_hi:[1,1]
    v_cvt_pk_bf16_f32 v160, v128, v129
    ds_read_b64_tr_b16 v[188:189], v121 offset:11264
    v_cvt_pk_bf16_f32 v161, v130, v131
    v_cvt_pk_bf16_f32 v162, v132, v133
    v_cvt_pk_bf16_f32 v163, v134, v135
    v_cvt_pk_bf16_f32 v164, v136, v137
    ds_read_b64_tr_b16 v[190:191], v121 offset:11296
    v_cvt_pk_bf16_f32 v165, v138, v139
    v_cvt_pk_bf16_f32 v166, v140, v141
    v_cvt_pk_bf16_f32 v167, v142, v143
    v_mfma_f32_16x16x32_bf16 a[152:155], v[64:67], v[32:35], a[152:155]
    ds_write2st64_b32 v120, v160, v161 offset0:48 offset1:49
    v_accvgpr_read_b32 v144, a112
    v_accvgpr_read_b32 v145, a116
    v_accvgpr_read_b32 v146, a120
    v_mfma_f32_16x16x32_bf16 a[156:159], v[64:67], v[36:39], a[156:159]
    ds_write2st64_b32 v120, v162, v163 offset0:50 offset1:51
    v_accvgpr_read_b32 v147, a124
    v_accvgpr_read_b32 v148, a113
    v_accvgpr_read_b32 v149, a117
    v_mfma_f32_16x16x32_bf16 a[148:151], v[64:67], v[40:43], a[148:151]
    ds_write2st64_b32 v120, v164, v165 offset0:52 offset1:53
    v_accvgpr_read_b32 v150, a121
    v_accvgpr_read_b32 v151, a125
    v_accvgpr_read_b32 v152, a114
    v_mfma_f32_16x16x32_bf16 a[144:147], v[64:67], v[44:47], a[144:147]
    ds_write2st64_b32 v120, v166, v167 offset0:54 offset1:55
    v_accvgpr_read_b32 v153, a118
    v_accvgpr_read_b32 v154, a122
    v_accvgpr_read_b32 v155, a126
    s_waitcnt lgkmcnt(6)
    buffer_store_dwordx4 v[184:187], v122, s[16:19], s57 offen offset:128 nt
    v_accvgpr_read_b32 v156, a115
    v_accvgpr_read_b32 v157, a119
    v_accvgpr_read_b32 v158, a123
    s_waitcnt lgkmcnt(4)
    buffer_store_dwordx4 v[188:191], v122, s[16:19], s57 offen offset:1152 nt
    v_accvgpr_read_b32 v159, a127
    v_pk_mul_f32 v[144:145], v[144:145], v[100:101] op_sel:[0,0] op_sel_hi:[1,0]
    ds_read_b64_tr_b16 v[176:177], v121 offset:12288
    v_pk_mul_f32 v[146:147], v[146:147], v[100:101] op_sel:[0,0] op_sel_hi:[1,0]
    v_pk_mul_f32 v[148:149], v[148:149], v[100:101] op_sel:[0,1] op_sel_hi:[1,1]
    v_pk_mul_f32 v[150:151], v[150:151], v[100:101] op_sel:[0,1] op_sel_hi:[1,1]
    v_pk_mul_f32 v[152:153], v[152:153], v[102:103] op_sel:[0,0] op_sel_hi:[1,0]
    ds_read_b64_tr_b16 v[178:179], v121 offset:12320
    v_pk_mul_f32 v[154:155], v[154:155], v[102:103] op_sel:[0,0] op_sel_hi:[1,0]
    v_pk_mul_f32 v[156:157], v[156:157], v[102:103] op_sel:[0,1] op_sel_hi:[1,1]
    v_pk_mul_f32 v[158:159], v[158:159], v[102:103] op_sel:[0,1] op_sel_hi:[1,1]
    v_cvt_pk_bf16_f32 v168, v144, v145
    ds_read_b64_tr_b16 v[180:181], v121 offset:13312
    v_cvt_pk_bf16_f32 v169, v146, v147
    v_cvt_pk_bf16_f32 v170, v148, v149
    v_cvt_pk_bf16_f32 v171, v150, v151
    v_cvt_pk_bf16_f32 v172, v152, v153
    ds_read_b64_tr_b16 v[182:183], v121 offset:13344
    v_cvt_pk_bf16_f32 v173, v154, v155
    v_cvt_pk_bf16_f32 v174, v156, v157
    v_cvt_pk_bf16_f32 v175, v158, v159
    v_mfma_f32_16x16x32_bf16 a[160:163], v[64:67], v[48:51], a[160:163]
    ds_write2st64_b32 v120, v168, v169 offset0:56 offset1:57
    v_accvgpr_read_b32 v128, a128
    v_accvgpr_read_b32 v129, a132
    v_accvgpr_read_b32 v130, a136
    v_mfma_f32_16x16x32_bf16 a[164:167], v[64:67], v[52:55], a[164:167]
    ds_write2st64_b32 v120, v170, v171 offset0:58 offset1:59
    v_accvgpr_read_b32 v131, a140
    v_accvgpr_read_b32 v132, a129
    v_accvgpr_read_b32 v133, a133
    v_mfma_f32_16x16x32_bf16 a[172:175], v[64:67], v[76:79], a[172:175]
    ds_write2st64_b32 v120, v172, v173 offset0:60 offset1:61
    v_accvgpr_read_b32 v134, a137
    v_accvgpr_read_b32 v135, a141
    v_accvgpr_read_b32 v136, a130
    v_mfma_f32_16x16x32_bf16 a[168:171], v[64:67], v[80:83], a[168:171]
    ds_write2st64_b32 v120, v174, v175 offset0:62 offset1:63
    v_accvgpr_read_b32 v137, a134
    v_accvgpr_read_b32 v138, a138
    v_accvgpr_read_b32 v139, a142
    s_waitcnt lgkmcnt(6)
    buffer_store_dwordx4 v[176:179], v122, s[16:19], s57 offen offset:256 nt
    v_accvgpr_read_b32 v140, a131
    v_accvgpr_read_b32 v141, a135
    v_accvgpr_read_b32 v142, a139
    s_waitcnt lgkmcnt(4)
    buffer_store_dwordx4 v[180:183], v122, s[16:19], s57 offen offset:1280 nt
    v_accvgpr_read_b32 v143, a143
    v_pk_mul_f32 v[128:129], v[128:129], v[104:105] op_sel:[0,0] op_sel_hi:[1,0]
    ds_read_b64_tr_b16 v[184:185], v121 offset:14336
    v_pk_mul_f32 v[130:131], v[130:131], v[104:105] op_sel:[0,0] op_sel_hi:[1,0]
    v_pk_mul_f32 v[132:133], v[132:133], v[104:105] op_sel:[0,1] op_sel_hi:[1,1]
    v_pk_mul_f32 v[134:135], v[134:135], v[104:105] op_sel:[0,1] op_sel_hi:[1,1]
    v_pk_mul_f32 v[136:137], v[136:137], v[106:107] op_sel:[0,0] op_sel_hi:[1,0]
    ds_read_b64_tr_b16 v[186:187], v121 offset:14368
    v_pk_mul_f32 v[138:139], v[138:139], v[106:107] op_sel:[0,0] op_sel_hi:[1,0]
    v_pk_mul_f32 v[140:141], v[140:141], v[106:107] op_sel:[0,1] op_sel_hi:[1,1]
    v_pk_mul_f32 v[142:143], v[142:143], v[106:107] op_sel:[0,1] op_sel_hi:[1,1]
    v_cvt_pk_bf16_f32 v160, v128, v129
    ds_read_b64_tr_b16 v[188:189], v121 offset:15360
    v_cvt_pk_bf16_f32 v161, v130, v131
    v_cvt_pk_bf16_f32 v162, v132, v133
    v_cvt_pk_bf16_f32 v163, v134, v135
    v_cvt_pk_bf16_f32 v164, v136, v137
    ds_read_b64_tr_b16 v[190:191], v121 offset:15392
    v_cvt_pk_bf16_f32 v165, v138, v139
    v_cvt_pk_bf16_f32 v166, v140, v141
    v_cvt_pk_bf16_f32 v167, v142, v143
    v_mfma_f32_16x16x32_bf16 a[184:187], v[64:67], v[84:87], a[184:187]
    ds_write2st64_b32 v120, v160, v161 offset0:0 offset1:1
    v_accvgpr_read_b32 v144, a144
    v_accvgpr_read_b32 v145, a148
    v_accvgpr_read_b32 v146, a152
    v_mfma_f32_16x16x32_bf16 a[188:191], v[64:67], v[88:91], a[188:191]
    ds_write2st64_b32 v120, v162, v163 offset0:2 offset1:3
    v_accvgpr_read_b32 v147, a156
    v_accvgpr_read_b32 v148, a145
    v_accvgpr_read_b32 v149, a149
    v_mfma_f32_16x16x32_bf16 a[180:183], v[64:67], v[92:95], a[180:183]
    ds_write2st64_b32 v120, v164, v165 offset0:4 offset1:5
    v_accvgpr_read_b32 v150, a153
    v_accvgpr_read_b32 v151, a157
    v_accvgpr_read_b32 v152, a146
    v_mfma_f32_16x16x32_bf16 a[176:179], v[64:67], v[6:9], a[176:179]
    ds_write2st64_b32 v120, v166, v167 offset0:6 offset1:7
    v_accvgpr_read_b32 v153, a150
    v_accvgpr_read_b32 v154, a154
    v_accvgpr_read_b32 v155, a158
    s_waitcnt lgkmcnt(6)
    buffer_store_dwordx4 v[184:187], v122, s[16:19], s57 offen offset:384 nt
    v_accvgpr_read_b32 v156, a147
    v_accvgpr_read_b32 v157, a151
    v_accvgpr_read_b32 v158, a155
    s_waitcnt lgkmcnt(4)
    buffer_store_dwordx4 v[188:191], v122, s[16:19], s57 offen offset:1408 nt
    v_accvgpr_read_b32 v159, a159
    v_pk_mul_f32 v[144:145], v[144:145], v[104:105] op_sel:[0,0] op_sel_hi:[1,0]
    ds_read_b64_tr_b16 v[176:177], v121 offset:0
    v_pk_mul_f32 v[146:147], v[146:147], v[104:105] op_sel:[0,0] op_sel_hi:[1,0]
    v_pk_mul_f32 v[148:149], v[148:149], v[104:105] op_sel:[0,1] op_sel_hi:[1,1]
    v_pk_mul_f32 v[150:151], v[150:151], v[104:105] op_sel:[0,1] op_sel_hi:[1,1]
    v_pk_mul_f32 v[152:153], v[152:153], v[106:107] op_sel:[0,0] op_sel_hi:[1,0]
    ds_read_b64_tr_b16 v[178:179], v121 offset:32
    v_pk_mul_f32 v[154:155], v[154:155], v[106:107] op_sel:[0,0] op_sel_hi:[1,0]
    v_pk_mul_f32 v[156:157], v[156:157], v[106:107] op_sel:[0,1] op_sel_hi:[1,1]
    v_pk_mul_f32 v[158:159], v[158:159], v[106:107] op_sel:[0,1] op_sel_hi:[1,1]
    v_cvt_pk_bf16_f32 v168, v144, v145
    ds_read_b64_tr_b16 v[180:181], v121 offset:1024
    v_cvt_pk_bf16_f32 v169, v146, v147
    v_cvt_pk_bf16_f32 v170, v148, v149
    v_cvt_pk_bf16_f32 v171, v150, v151
    v_cvt_pk_bf16_f32 v172, v152, v153
    ds_read_b64_tr_b16 v[182:183], v121 offset:1056
    v_cvt_pk_bf16_f32 v173, v154, v155
    v_cvt_pk_bf16_f32 v174, v156, v157
    v_cvt_pk_bf16_f32 v175, v158, v159
    v_mfma_f32_16x16x32_bf16 a[192:195], v[68:71], v[28:31], a[192:195]
    ds_write2st64_b32 v120, v168, v169 offset0:8 offset1:9
    v_accvgpr_read_b32 v128, a160
    v_accvgpr_read_b32 v129, a164
    v_accvgpr_read_b32 v130, a168
    v_mfma_f32_16x16x32_bf16 a[196:199], v[68:71], v[24:27], a[196:199]
    ds_write2st64_b32 v120, v170, v171 offset0:10 offset1:11
    v_accvgpr_read_b32 v131, a172
    v_accvgpr_read_b32 v132, a161
    v_accvgpr_read_b32 v133, a165
    v_mfma_f32_16x16x32_bf16 a[204:207], v[68:71], v[16:19], a[204:207]
    ds_write2st64_b32 v120, v172, v173 offset0:12 offset1:13
    v_accvgpr_read_b32 v134, a169
    v_accvgpr_read_b32 v135, a173
    v_accvgpr_read_b32 v136, a162
    v_mfma_f32_16x16x32_bf16 a[200:203], v[68:71], v[20:23], a[200:203]
    ds_write2st64_b32 v120, v174, v175 offset0:14 offset1:15
    v_accvgpr_read_b32 v137, a166
    v_accvgpr_read_b32 v138, a170
    v_accvgpr_read_b32 v139, a174
    s_waitcnt lgkmcnt(6)
    buffer_store_dwordx4 v[176:179], v122, s[16:19], s58 offen offset:0 nt
    v_accvgpr_read_b32 v140, a163
    v_accvgpr_read_b32 v141, a167
    v_accvgpr_read_b32 v142, a171
    s_waitcnt lgkmcnt(4)
    buffer_store_dwordx4 v[180:183], v122, s[16:19], s58 offen offset:1024 nt
    v_accvgpr_read_b32 v143, a175
    v_pk_mul_f32 v[128:129], v[128:129], v[104:105] op_sel:[0,0] op_sel_hi:[1,0]
    ds_read_b64_tr_b16 v[184:185], v121 offset:2048
    v_pk_mul_f32 v[130:131], v[130:131], v[104:105] op_sel:[0,0] op_sel_hi:[1,0]
    v_pk_mul_f32 v[132:133], v[132:133], v[104:105] op_sel:[0,1] op_sel_hi:[1,1]
    v_pk_mul_f32 v[134:135], v[134:135], v[104:105] op_sel:[0,1] op_sel_hi:[1,1]
    v_pk_mul_f32 v[136:137], v[136:137], v[106:107] op_sel:[0,0] op_sel_hi:[1,0]
    ds_read_b64_tr_b16 v[186:187], v121 offset:2080
    v_pk_mul_f32 v[138:139], v[138:139], v[106:107] op_sel:[0,0] op_sel_hi:[1,0]
    v_pk_mul_f32 v[140:141], v[140:141], v[106:107] op_sel:[0,1] op_sel_hi:[1,1]
    v_pk_mul_f32 v[142:143], v[142:143], v[106:107] op_sel:[0,1] op_sel_hi:[1,1]
    v_cvt_pk_bf16_f32 v160, v128, v129
    ds_read_b64_tr_b16 v[188:189], v121 offset:3072
    v_cvt_pk_bf16_f32 v161, v130, v131
    v_cvt_pk_bf16_f32 v162, v132, v133
    v_cvt_pk_bf16_f32 v163, v134, v135
    v_cvt_pk_bf16_f32 v164, v136, v137
    ds_read_b64_tr_b16 v[190:191], v121 offset:3104
    v_cvt_pk_bf16_f32 v165, v138, v139
    v_cvt_pk_bf16_f32 v166, v140, v141
    v_cvt_pk_bf16_f32 v167, v142, v143
    v_mfma_f32_16x16x32_bf16 a[216:219], v[68:71], v[32:35], a[216:219]
    ds_write2st64_b32 v120, v160, v161 offset0:16 offset1:17
    v_accvgpr_read_b32 v144, a176
    v_accvgpr_read_b32 v145, a180
    v_accvgpr_read_b32 v146, a184
    v_mfma_f32_16x16x32_bf16 a[220:223], v[68:71], v[36:39], a[220:223]
    ds_write2st64_b32 v120, v162, v163 offset0:18 offset1:19
    v_accvgpr_read_b32 v147, a188
    v_accvgpr_read_b32 v148, a177
    v_accvgpr_read_b32 v149, a181
    v_mfma_f32_16x16x32_bf16 a[212:215], v[68:71], v[40:43], a[212:215]
    ds_write2st64_b32 v120, v164, v165 offset0:20 offset1:21
    v_accvgpr_read_b32 v150, a185
    v_accvgpr_read_b32 v151, a189
    v_accvgpr_read_b32 v152, a178
    v_mfma_f32_16x16x32_bf16 a[208:211], v[68:71], v[44:47], a[208:211]
    ds_write2st64_b32 v120, v166, v167 offset0:22 offset1:23
    v_accvgpr_read_b32 v153, a182
    v_accvgpr_read_b32 v154, a186
    v_accvgpr_read_b32 v155, a190
    s_waitcnt lgkmcnt(6)
    buffer_store_dwordx4 v[184:187], v122, s[16:19], s58 offen offset:128 nt
    v_accvgpr_read_b32 v156, a179
    v_accvgpr_read_b32 v157, a183
    v_accvgpr_read_b32 v158, a187
    s_waitcnt lgkmcnt(4)
    buffer_store_dwordx4 v[188:191], v122, s[16:19], s58 offen offset:1152 nt
    v_accvgpr_read_b32 v159, a191
    v_pk_mul_f32 v[144:145], v[144:145], v[104:105] op_sel:[0,0] op_sel_hi:[1,0]
    ds_read_b64_tr_b16 v[176:177], v121 offset:4096
    v_pk_mul_f32 v[146:147], v[146:147], v[104:105] op_sel:[0,0] op_sel_hi:[1,0]
    v_pk_mul_f32 v[148:149], v[148:149], v[104:105] op_sel:[0,1] op_sel_hi:[1,1]
    v_pk_mul_f32 v[150:151], v[150:151], v[104:105] op_sel:[0,1] op_sel_hi:[1,1]
    v_pk_mul_f32 v[152:153], v[152:153], v[106:107] op_sel:[0,0] op_sel_hi:[1,0]
    ds_read_b64_tr_b16 v[178:179], v121 offset:4128
    v_pk_mul_f32 v[154:155], v[154:155], v[106:107] op_sel:[0,0] op_sel_hi:[1,0]
    v_pk_mul_f32 v[156:157], v[156:157], v[106:107] op_sel:[0,1] op_sel_hi:[1,1]
    v_pk_mul_f32 v[158:159], v[158:159], v[106:107] op_sel:[0,1] op_sel_hi:[1,1]
    v_cvt_pk_bf16_f32 v168, v144, v145
    ds_read_b64_tr_b16 v[180:181], v121 offset:5120
    v_cvt_pk_bf16_f32 v169, v146, v147
    v_cvt_pk_bf16_f32 v170, v148, v149
    v_cvt_pk_bf16_f32 v171, v150, v151
    v_cvt_pk_bf16_f32 v172, v152, v153
    ds_read_b64_tr_b16 v[182:183], v121 offset:5152
    v_cvt_pk_bf16_f32 v173, v154, v155
    v_cvt_pk_bf16_f32 v174, v156, v157
    v_cvt_pk_bf16_f32 v175, v158, v159
    v_mfma_f32_16x16x32_bf16 a[224:227], v[68:71], v[48:51], a[224:227]
    ds_write2st64_b32 v120, v168, v169 offset0:24 offset1:25
    v_accvgpr_read_b32 v128, a192
    v_accvgpr_read_b32 v129, a196
    v_accvgpr_read_b32 v130, a200
    v_mfma_f32_16x16x32_bf16 a[228:231], v[68:71], v[52:55], a[228:231]
    ds_write2st64_b32 v120, v170, v171 offset0:26 offset1:27
    v_accvgpr_read_b32 v131, a204
    v_accvgpr_read_b32 v132, a193
    v_accvgpr_read_b32 v133, a197
    v_mfma_f32_16x16x32_bf16 a[236:239], v[68:71], v[76:79], a[236:239]
    ds_write2st64_b32 v120, v172, v173 offset0:28 offset1:29
    v_accvgpr_read_b32 v134, a201
    v_accvgpr_read_b32 v135, a205
    v_accvgpr_read_b32 v136, a194
    v_mfma_f32_16x16x32_bf16 a[232:235], v[68:71], v[80:83], a[232:235]
    ds_write2st64_b32 v120, v174, v175 offset0:30 offset1:31
    v_accvgpr_read_b32 v137, a198
    v_accvgpr_read_b32 v138, a202
    v_accvgpr_read_b32 v139, a206
    s_waitcnt lgkmcnt(6)
    buffer_store_dwordx4 v[176:179], v122, s[16:19], s58 offen offset:256 nt
    v_accvgpr_read_b32 v140, a195
    v_accvgpr_read_b32 v141, a199
    v_accvgpr_read_b32 v142, a203
    s_waitcnt lgkmcnt(4)
    buffer_store_dwordx4 v[180:183], v122, s[16:19], s58 offen offset:1280 nt
    v_accvgpr_read_b32 v143, a207
    v_pk_mul_f32 v[128:129], v[128:129], v[108:109] op_sel:[0,0] op_sel_hi:[1,0]
    ds_read_b64_tr_b16 v[184:185], v121 offset:6144
    v_pk_mul_f32 v[130:131], v[130:131], v[108:109] op_sel:[0,0] op_sel_hi:[1,0]
    v_pk_mul_f32 v[132:133], v[132:133], v[108:109] op_sel:[0,1] op_sel_hi:[1,1]
    v_pk_mul_f32 v[134:135], v[134:135], v[108:109] op_sel:[0,1] op_sel_hi:[1,1]
    v_pk_mul_f32 v[136:137], v[136:137], v[110:111] op_sel:[0,0] op_sel_hi:[1,0]
    ds_read_b64_tr_b16 v[186:187], v121 offset:6176
    v_pk_mul_f32 v[138:139], v[138:139], v[110:111] op_sel:[0,0] op_sel_hi:[1,0]
    v_pk_mul_f32 v[140:141], v[140:141], v[110:111] op_sel:[0,1] op_sel_hi:[1,1]
    v_pk_mul_f32 v[142:143], v[142:143], v[110:111] op_sel:[0,1] op_sel_hi:[1,1]
    v_cvt_pk_bf16_f32 v160, v128, v129
    ds_read_b64_tr_b16 v[188:189], v121 offset:7168
    v_cvt_pk_bf16_f32 v161, v130, v131
    v_cvt_pk_bf16_f32 v162, v132, v133
    v_cvt_pk_bf16_f32 v163, v134, v135
    v_cvt_pk_bf16_f32 v164, v136, v137
    ds_read_b64_tr_b16 v[190:191], v121 offset:7200
    v_cvt_pk_bf16_f32 v165, v138, v139
    v_cvt_pk_bf16_f32 v166, v140, v141
    v_cvt_pk_bf16_f32 v167, v142, v143
    v_mfma_f32_16x16x32_bf16 a[248:251], v[68:71], v[84:87], a[248:251]
    ds_write2st64_b32 v120, v160, v161 offset0:32 offset1:33
    v_accvgpr_read_b32 v144, a208
    v_accvgpr_read_b32 v145, a212
    v_accvgpr_read_b32 v146, a216
    v_mfma_f32_16x16x32_bf16 a[252:255], v[68:71], v[88:91], a[252:255]
    ds_write2st64_b32 v120, v162, v163 offset0:34 offset1:35
    v_accvgpr_read_b32 v147, a220
    v_accvgpr_read_b32 v148, a209
    v_accvgpr_read_b32 v149, a213
    v_mfma_f32_16x16x32_bf16 a[244:247], v[68:71], v[92:95], a[244:247]
    ds_write2st64_b32 v120, v164, v165 offset0:36 offset1:37
    v_accvgpr_read_b32 v150, a217
    v_accvgpr_read_b32 v151, a221
    v_accvgpr_read_b32 v152, a210
    v_mfma_f32_16x16x32_bf16 a[240:243], v[68:71], v[6:9], a[240:243]
    ds_write2st64_b32 v120, v166, v167 offset0:38 offset1:39
    v_accvgpr_read_b32 v153, a214
    v_accvgpr_read_b32 v154, a218
    v_accvgpr_read_b32 v155, a222
    s_waitcnt lgkmcnt(6)
    buffer_store_dwordx4 v[184:187], v122, s[16:19], s58 offen offset:384 nt
    v_accvgpr_read_b32 v156, a211
    v_accvgpr_read_b32 v157, a215
    v_accvgpr_read_b32 v158, a219
    s_waitcnt lgkmcnt(4)
    buffer_store_dwordx4 v[188:191], v122, s[16:19], s58 offen offset:1408 nt
    v_accvgpr_read_b32 v159, a223
    v_pk_mul_f32 v[144:145], v[144:145], v[108:109] op_sel:[0,0] op_sel_hi:[1,0]
    ds_read_b64_tr_b16 v[176:177], v121 offset:8192
    v_pk_mul_f32 v[146:147], v[146:147], v[108:109] op_sel:[0,0] op_sel_hi:[1,0]
    v_pk_mul_f32 v[148:149], v[148:149], v[108:109] op_sel:[0,1] op_sel_hi:[1,1]
    v_pk_mul_f32 v[150:151], v[150:151], v[108:109] op_sel:[0,1] op_sel_hi:[1,1]
    v_pk_mul_f32 v[152:153], v[152:153], v[110:111] op_sel:[0,0] op_sel_hi:[1,0]
    ds_read_b64_tr_b16 v[178:179], v121 offset:8224
    v_pk_mul_f32 v[154:155], v[154:155], v[110:111] op_sel:[0,0] op_sel_hi:[1,0]
    v_pk_mul_f32 v[156:157], v[156:157], v[110:111] op_sel:[0,1] op_sel_hi:[1,1]
    v_pk_mul_f32 v[158:159], v[158:159], v[110:111] op_sel:[0,1] op_sel_hi:[1,1]
    v_cvt_pk_bf16_f32 v168, v144, v145
    ds_read_b64_tr_b16 v[180:181], v121 offset:9216
    v_cvt_pk_bf16_f32 v169, v146, v147
    v_cvt_pk_bf16_f32 v170, v148, v149
    v_cvt_pk_bf16_f32 v171, v150, v151
    v_cvt_pk_bf16_f32 v172, v152, v153
    ds_read_b64_tr_b16 v[182:183], v121 offset:9248
    v_cvt_pk_bf16_f32 v173, v154, v155
    v_cvt_pk_bf16_f32 v174, v156, v157
    v_cvt_pk_bf16_f32 v175, v158, v159
    v_mfma_f32_16x16x32_bf16 v[192:195], v[72:75], v[28:31], v[192:195]
    ds_write2st64_b32 v120, v168, v169 offset0:40 offset1:41
    v_accvgpr_read_b32 v128, a224
    v_accvgpr_read_b32 v129, a228
    v_accvgpr_read_b32 v130, a232
    v_mfma_f32_16x16x32_bf16 v[196:199], v[72:75], v[24:27], v[196:199]
    ds_write2st64_b32 v120, v170, v171 offset0:42 offset1:43
    v_accvgpr_read_b32 v131, a236
    v_accvgpr_read_b32 v132, a225
    v_accvgpr_read_b32 v133, a229
    v_mfma_f32_16x16x32_bf16 v[204:207], v[72:75], v[16:19], v[204:207]
    ds_write2st64_b32 v120, v172, v173 offset0:44 offset1:45
    v_accvgpr_read_b32 v134, a233
    v_accvgpr_read_b32 v135, a237
    v_accvgpr_read_b32 v136, a226
    v_mfma_f32_16x16x32_bf16 v[200:203], v[72:75], v[20:23], v[200:203]
    ds_write2st64_b32 v120, v174, v175 offset0:46 offset1:47
    v_accvgpr_read_b32 v137, a230
    v_accvgpr_read_b32 v138, a234
    v_accvgpr_read_b32 v139, a238
    s_waitcnt lgkmcnt(6)
    buffer_store_dwordx4 v[176:179], v122, s[16:19], s59 offen offset:0 nt
    v_accvgpr_read_b32 v140, a227
    v_accvgpr_read_b32 v141, a231
    v_accvgpr_read_b32 v142, a235
    s_waitcnt lgkmcnt(4)
    buffer_store_dwordx4 v[180:183], v122, s[16:19], s59 offen offset:1024 nt
    v_accvgpr_read_b32 v143, a239
    v_pk_mul_f32 v[128:129], v[128:129], v[108:109] op_sel:[0,0] op_sel_hi:[1,0]
    ds_read_b64_tr_b16 v[184:185], v121 offset:10240
    v_pk_mul_f32 v[130:131], v[130:131], v[108:109] op_sel:[0,0] op_sel_hi:[1,0]
    v_pk_mul_f32 v[132:133], v[132:133], v[108:109] op_sel:[0,1] op_sel_hi:[1,1]
    v_pk_mul_f32 v[134:135], v[134:135], v[108:109] op_sel:[0,1] op_sel_hi:[1,1]
    v_pk_mul_f32 v[136:137], v[136:137], v[110:111] op_sel:[0,0] op_sel_hi:[1,0]
    ds_read_b64_tr_b16 v[186:187], v121 offset:10272
    v_pk_mul_f32 v[138:139], v[138:139], v[110:111] op_sel:[0,0] op_sel_hi:[1,0]
    v_pk_mul_f32 v[140:141], v[140:141], v[110:111] op_sel:[0,1] op_sel_hi:[1,1]
    v_pk_mul_f32 v[142:143], v[142:143], v[110:111] op_sel:[0,1] op_sel_hi:[1,1]
    v_cvt_pk_bf16_f32 v160, v128, v129
    ds_read_b64_tr_b16 v[188:189], v121 offset:11264
    v_cvt_pk_bf16_f32 v161, v130, v131
    v_cvt_pk_bf16_f32 v162, v132, v133
    v_cvt_pk_bf16_f32 v163, v134, v135
    v_cvt_pk_bf16_f32 v164, v136, v137
    ds_read_b64_tr_b16 v[190:191], v121 offset:11296
    v_cvt_pk_bf16_f32 v165, v138, v139
    v_cvt_pk_bf16_f32 v166, v140, v141
    v_cvt_pk_bf16_f32 v167, v142, v143
    v_mfma_f32_16x16x32_bf16 v[216:219], v[72:75], v[32:35], v[216:219]
    ds_write2st64_b32 v120, v160, v161 offset0:48 offset1:49
    v_accvgpr_read_b32 v144, a240
    v_accvgpr_read_b32 v145, a244
    v_accvgpr_read_b32 v146, a248
    v_mfma_f32_16x16x32_bf16 v[220:223], v[72:75], v[36:39], v[220:223]
    ds_write2st64_b32 v120, v162, v163 offset0:50 offset1:51
    v_accvgpr_read_b32 v147, a252
    v_accvgpr_read_b32 v148, a241
    v_accvgpr_read_b32 v149, a245
    v_mfma_f32_16x16x32_bf16 v[212:215], v[72:75], v[40:43], v[212:215]
    ds_write2st64_b32 v120, v164, v165 offset0:52 offset1:53
    v_accvgpr_read_b32 v150, a249
    v_accvgpr_read_b32 v151, a253
    v_accvgpr_read_b32 v152, a242
    v_mfma_f32_16x16x32_bf16 v[208:211], v[72:75], v[44:47], v[208:211]
    ds_write2st64_b32 v120, v166, v167 offset0:54 offset1:55
    v_accvgpr_read_b32 v153, a246
    v_accvgpr_read_b32 v154, a250
    v_accvgpr_read_b32 v155, a254
    s_waitcnt lgkmcnt(6)
    buffer_store_dwordx4 v[184:187], v122, s[16:19], s59 offen offset:128 nt
    v_accvgpr_read_b32 v156, a243
    v_accvgpr_read_b32 v157, a247
    v_accvgpr_read_b32 v158, a251
    s_waitcnt lgkmcnt(4)
    buffer_store_dwordx4 v[188:191], v122, s[16:19], s59 offen offset:1152 nt
    v_accvgpr_read_b32 v159, a255
    v_pk_mul_f32 v[144:145], v[144:145], v[108:109] op_sel:[0,0] op_sel_hi:[1,0]
    ds_read_b64_tr_b16 v[176:177], v121 offset:12288
    v_pk_mul_f32 v[146:147], v[146:147], v[108:109] op_sel:[0,0] op_sel_hi:[1,0]
    v_pk_mul_f32 v[148:149], v[148:149], v[108:109] op_sel:[0,1] op_sel_hi:[1,1]
    v_pk_mul_f32 v[150:151], v[150:151], v[108:109] op_sel:[0,1] op_sel_hi:[1,1]
    v_pk_mul_f32 v[152:153], v[152:153], v[110:111] op_sel:[0,0] op_sel_hi:[1,0]
    ds_read_b64_tr_b16 v[178:179], v121 offset:12320
    v_pk_mul_f32 v[154:155], v[154:155], v[110:111] op_sel:[0,0] op_sel_hi:[1,0]
    v_pk_mul_f32 v[156:157], v[156:157], v[110:111] op_sel:[0,1] op_sel_hi:[1,1]
    v_pk_mul_f32 v[158:159], v[158:159], v[110:111] op_sel:[0,1] op_sel_hi:[1,1]
    v_cvt_pk_bf16_f32 v168, v144, v145
    ds_read_b64_tr_b16 v[180:181], v121 offset:13312
    v_cvt_pk_bf16_f32 v169, v146, v147
    v_cvt_pk_bf16_f32 v170, v148, v149
    v_cvt_pk_bf16_f32 v171, v150, v151
    v_cvt_pk_bf16_f32 v172, v152, v153
    ds_read_b64_tr_b16 v[182:183], v121 offset:13344
    v_cvt_pk_bf16_f32 v173, v154, v155
    v_cvt_pk_bf16_f32 v174, v156, v157
    v_cvt_pk_bf16_f32 v175, v158, v159
    v_mfma_f32_16x16x32_bf16 v[224:227], v[72:75], v[48:51], v[224:227]
    ds_write2st64_b32 v120, v168, v169 offset0:56 offset1:57
    v_mul_f32 v128, v192, v112
    v_mul_f32 v129, v196, v112
    v_mul_f32 v130, v200, v112
    v_mfma_f32_16x16x32_bf16 v[228:231], v[72:75], v[52:55], v[228:231]
    ds_write2st64_b32 v120, v170, v171 offset0:58 offset1:59
    v_mul_f32 v131, v204, v112
    v_mul_f32 v132, v193, v113
    v_mul_f32 v133, v197, v113
    v_mfma_f32_16x16x32_bf16 v[236:239], v[72:75], v[76:79], v[236:239]
    ds_write2st64_b32 v120, v172, v173 offset0:60 offset1:61
    v_mul_f32 v134, v201, v113
    v_mul_f32 v135, v205, v113
    v_mul_f32 v136, v194, v114
    v_mfma_f32_16x16x32_bf16 v[232:235], v[72:75], v[80:83], v[232:235]
    ds_write2st64_b32 v120, v174, v175 offset0:62 offset1:63
    s_waitcnt lgkmcnt(6)
    buffer_store_dwordx4 v[176:179], v122, s[16:19], s59 offen offset:256 nt
    v_mul_f32 v137, v198, v114
    v_mul_f32 v138, v202, v114
    s_waitcnt lgkmcnt(4)
    buffer_store_dwordx4 v[180:183], v122, s[16:19], s59 offen offset:1280 nt
    v_mul_f32 v139, v206, v114
    ds_read_b64_tr_b16 v[184:185], v121 offset:14336
    v_mul_f32 v140, v195, v115
    v_mul_f32 v141, v199, v115
    v_mul_f32 v142, v203, v115
    ds_read_b64_tr_b16 v[186:187], v121 offset:14368
    v_mul_f32 v143, v207, v115
    v_cvt_pk_bf16_f32 v160, v128, v129
    v_cvt_pk_bf16_f32 v161, v130, v131
    ds_read_b64_tr_b16 v[188:189], v121 offset:15360
    v_cvt_pk_bf16_f32 v162, v132, v133
    v_cvt_pk_bf16_f32 v163, v134, v135
    v_cvt_pk_bf16_f32 v164, v136, v137
    ds_read_b64_tr_b16 v[190:191], v121 offset:15392
    v_cvt_pk_bf16_f32 v165, v138, v139
    v_cvt_pk_bf16_f32 v166, v140, v141
    v_cvt_pk_bf16_f32 v167, v142, v143
    v_mfma_f32_16x16x32_bf16 v[248:251], v[72:75], v[84:87], v[248:251]
    ds_write2st64_b32 v120, v160, v161 offset0:0 offset1:1
    v_mul_f32 v144, v208, v112
    v_mul_f32 v145, v212, v112
    v_mul_f32 v146, v216, v112
    v_mfma_f32_16x16x32_bf16 v[252:255], v[72:75], v[88:91], v[252:255]
    ds_write2st64_b32 v120, v162, v163 offset0:2 offset1:3
    v_mul_f32 v147, v220, v112
    v_mul_f32 v148, v209, v113
    v_mul_f32 v149, v213, v113
    v_mfma_f32_16x16x32_bf16 v[244:247], v[72:75], v[92:95], v[244:247]
    ds_write2st64_b32 v120, v164, v165 offset0:4 offset1:5
    v_mul_f32 v150, v217, v113
    v_mul_f32 v151, v221, v113
    v_mul_f32 v152, v210, v114
    v_mfma_f32_16x16x32_bf16 v[240:243], v[72:75], v[6:9], v[240:243]
    ds_write2st64_b32 v120, v166, v167 offset0:6 offset1:7
    s_waitcnt lgkmcnt(6)
    buffer_store_dwordx4 v[184:187], v122, s[16:19], s59 offen offset:384 nt
    v_mul_f32 v153, v214, v114
    v_mul_f32 v154, v218, v114
    s_waitcnt lgkmcnt(4)
    buffer_store_dwordx4 v[188:191], v122, s[16:19], s59 offen offset:1408 nt
    v_mul_f32 v155, v222, v114
    ds_read_b64_tr_b16 v[176:177], v121 offset:0
    v_mul_f32 v156, v211, v115
    v_mul_f32 v157, v215, v115
    v_mul_f32 v158, v219, v115
    ds_read_b64_tr_b16 v[178:179], v121 offset:32
    v_mul_f32 v159, v223, v115
    v_cvt_pk_bf16_f32 v168, v144, v145
    v_cvt_pk_bf16_f32 v169, v146, v147
    ds_read_b64_tr_b16 v[180:181], v121 offset:1024
    v_cvt_pk_bf16_f32 v170, v148, v149
    v_cvt_pk_bf16_f32 v171, v150, v151
    v_cvt_pk_bf16_f32 v172, v152, v153
    ds_read_b64_tr_b16 v[182:183], v121 offset:1056
    v_cvt_pk_bf16_f32 v173, v154, v155
    v_cvt_pk_bf16_f32 v174, v156, v157
    v_cvt_pk_bf16_f32 v175, v158, v159
    ds_write2st64_b32 v120, v168, v169 offset0:8 offset1:9
    v_mul_f32 v128, v224, v112
    v_mul_f32 v129, v228, v112
    v_mul_f32 v130, v232, v112
    ds_write2st64_b32 v120, v170, v171 offset0:10 offset1:11
    v_mul_f32 v131, v236, v112
    v_mul_f32 v132, v225, v113
    v_mul_f32 v133, v229, v113
    ds_write2st64_b32 v120, v172, v173 offset0:12 offset1:13
    v_mul_f32 v134, v233, v113
    v_mul_f32 v135, v237, v113
    v_mul_f32 v136, v226, v114
    ds_write2st64_b32 v120, v174, v175 offset0:14 offset1:15
    s_waitcnt lgkmcnt(6)
    buffer_store_dwordx4 v[176:179], v122, s[16:19], s60 offen offset:0 nt
    v_mul_f32 v137, v230, v114
    v_mul_f32 v138, v234, v114
    s_waitcnt lgkmcnt(4)
    buffer_store_dwordx4 v[180:183], v122, s[16:19], s60 offen offset:1024 nt
    v_mul_f32 v139, v238, v114
    ds_read_b64_tr_b16 v[184:185], v121 offset:2048
    v_mul_f32 v140, v227, v115
    v_mul_f32 v141, v231, v115
    v_mul_f32 v142, v235, v115
    ds_read_b64_tr_b16 v[186:187], v121 offset:2080
    v_mul_f32 v143, v239, v115
    v_cvt_pk_bf16_f32 v160, v128, v129
    v_cvt_pk_bf16_f32 v161, v130, v131
    ds_read_b64_tr_b16 v[188:189], v121 offset:3072
    v_cvt_pk_bf16_f32 v162, v132, v133
    v_cvt_pk_bf16_f32 v163, v134, v135
    v_cvt_pk_bf16_f32 v164, v136, v137
    ds_read_b64_tr_b16 v[190:191], v121 offset:3104
    v_cvt_pk_bf16_f32 v165, v138, v139
    v_cvt_pk_bf16_f32 v166, v140, v141
    v_cvt_pk_bf16_f32 v167, v142, v143
    ds_write2st64_b32 v120, v160, v161 offset0:16 offset1:17
    v_mul_f32 v144, v240, v112
    v_mul_f32 v145, v244, v112
    v_mul_f32 v146, v248, v112
    ds_write2st64_b32 v120, v162, v163 offset0:18 offset1:19
    v_mul_f32 v147, v252, v112
    v_mul_f32 v148, v241, v113
    v_mul_f32 v149, v245, v113
    ds_write2st64_b32 v120, v164, v165 offset0:20 offset1:21
    v_mul_f32 v150, v249, v113
    v_mul_f32 v151, v253, v113
    v_mul_f32 v152, v242, v114
    ds_write2st64_b32 v120, v166, v167 offset0:22 offset1:23
    s_waitcnt lgkmcnt(6)
    buffer_store_dwordx4 v[184:187], v122, s[16:19], s60 offen offset:128 nt
    v_mul_f32 v153, v246, v114
    v_mul_f32 v154, v250, v114
    s_waitcnt lgkmcnt(4)
    buffer_store_dwordx4 v[188:191], v122, s[16:19], s60 offen offset:1152 nt
    v_mul_f32 v155, v254, v114
    ds_read_b64_tr_b16 v[176:177], v121 offset:4096
    v_mul_f32 v156, v243, v115
    v_mul_f32 v157, v247, v115
    v_mul_f32 v158, v251, v115
    ds_read_b64_tr_b16 v[178:179], v121 offset:4128
    v_mul_f32 v159, v255, v115
    v_cvt_pk_bf16_f32 v168, v144, v145
    v_cvt_pk_bf16_f32 v169, v146, v147
    ds_read_b64_tr_b16 v[180:181], v121 offset:5120
    v_cvt_pk_bf16_f32 v170, v148, v149
    v_cvt_pk_bf16_f32 v171, v150, v151
    v_cvt_pk_bf16_f32 v172, v152, v153
    ds_read_b64_tr_b16 v[182:183], v121 offset:5152
    v_cvt_pk_bf16_f32 v173, v154, v155
    v_cvt_pk_bf16_f32 v174, v156, v157
    v_cvt_pk_bf16_f32 v175, v158, v159
    s_waitcnt lgkmcnt(2)
    buffer_store_dwordx4 v[176:179], v122, s[16:19], s60 offen offset:256 nt
    s_waitcnt lgkmcnt(0)
    buffer_store_dwordx4 v[180:183], v122, s[16:19], s60 offen offset:1280 nt
    ds_write2st64_b32 v120, v168, v169 offset0:24 offset1:25
    ds_write2st64_b32 v120, v170, v171 offset0:26 offset1:27
    ds_write2st64_b32 v120, v172, v173 offset0:28 offset1:29
    ds_write2st64_b32 v120, v174, v175 offset0:30 offset1:31
    ds_read_b64_tr_b16 v[184:185], v121 offset:6144
    ds_read_b64_tr_b16 v[186:187], v121 offset:6176
    ds_read_b64_tr_b16 v[188:189], v121 offset:7168
    ds_read_b64_tr_b16 v[190:191], v121 offset:7200
    s_waitcnt lgkmcnt(2)
    buffer_store_dwordx4 v[184:187], v122, s[16:19], s60 offen offset:384 nt
    s_waitcnt lgkmcnt(0)
    buffer_store_dwordx4 v[188:191], v122, s[16:19], s60 offen offset:1408 nt
L_end:
    s_endpgm
L_sloop:
    v_mfma_f32_16x16x32_bf16 v[56:59], v[32:35], v[96:99], 0
    s_waitcnt lgkmcnt(2)
    ds_read_b128 v[28:31], v1 offset:8192
    v_add_f32 v84, v84, v87
    v_mfma_f32_16x16x32_bf16 v[56:59], v[16:19], v[100:103], v[56:59]
    s_waitcnt lgkmcnt(2)
    v_add_f32 v43, v42, v80
    v_cvt_pk_bf16_f32 v42, v80, v81
    v_mfma_f32_16x16x32_bf16 v[56:59], v[20:23], v[104:107], v[56:59]
    s_sub_u32 s29, s27, s26
    v_add_f32 v80, v43, v81
    v_add_f32 v80, v80, v82
    v_mfma_f32_16x16x32_bf16 v[60:63], v[20:23], v[136:139], 0
    s_sub_u32 s30, s26, s25
    v_add_f32 v80, v80, v83
    v_add_f32 v39, v38, v76
    v_mfma_f32_16x16x32_bf16 v[60:63], v[16:19], v[132:135], v[60:63]
    s_add_u32 m0, s25, 0
    v_cvt_pk_bf16_f32 v38, v76, v77
    v_add_f32 v76, v39, v77
    v_mfma_f32_16x16x32_bf16 v[60:63], v[32:35], v[128:131], v[60:63]
    v_add_f32 v76, v76, v78
    v_add_f32 v76, v76, v79
    v_mfma_f32_16x16x32_bf16 v[64:67], v[32:35], v[156:159], 0
    v_add_f32 v93, v92, v88
    v_add_f32 v93, v93, v84
    v_mfma_f32_16x16x32_bf16 v[64:67], v[16:19], v[160:163], v[64:67]
    v_add_f32 v93, v93, v80
    v_add_f32 v93, v93, v76
    v_mfma_f32_16x16x32_bf16 v[64:67], v[20:23], v[164:167], v[64:67]
    v_cmp_ngt_f32 vcc, s21, v93
    v_cvt_pk_bf16_f32 v43, v82, v83
    v_mfma_f32_16x16x32_bf16 v[68:71], v[20:23], v[176:179], 0
    v_cvt_pk_bf16_f32 v39, v78, v79
    v_mfma_f32_16x16x32_bf16 v[68:71], v[16:19], v[172:175], v[68:71]
    v_mfma_f32_16x16x32_bf16 v[68:71], v[32:35], v[168:171], v[68:71]
    s_cbranch_vccnz L_slowA
L_retA:
    v_mfma_f32_16x16x32_bf16 v[72:75], v[32:35], v[180:183], 0
    ds_read_b128 v[32:35], v0 offset:9216
    v_add_f32 v15, v15, v92
    v_mfma_f32_16x16x32_bf16 v[72:75], v[16:19], v[184:187], v[72:75]
    ds_read_b128 v[16:19], v1 offset:1024
    v_add_f32 v14, v14, v88
    v_mfma_f32_16x16x32_bf16 v[72:75], v[20:23], v[188:191], v[72:75]
    s_waitcnt lgkmcnt(3)
    ds_read_b128 v[20:23], v3 offset:15360
    v_add_f32 v13, v13, v84
    v_mfma_f32_16x16x32_bf16 v[92:95], v[24:27], v[180:183], 0
    s_waitcnt lgkmcnt(3)
    v_add_f32 v12, v12, v80
    v_add_f32 v11, v11, v76
    v_mfma_f32_16x16x32_bf16 v[92:95], v[28:31], v[184:187], v[92:95]
    s_waitcnt lgkmcnt(2)
    v_mfma_f32_16x16x32_bf16 v[92:95], v[32:35], v[188:191], v[92:95]
    buffer_load_dwordx4 v4, s[8:11], s23 offen offset:0 nt lds
    v_mfma_f32_16x16x32_bf16 v[88:91], v[32:35], v[176:179], 0
    s_add_u32 m0, s25, 896
    v_mfma_f32_16x16x32_bf16 v[88:91], v[28:31], v[172:175], v[88:91]
    v_mfma_f32_16x16x32_bf16 v[88:91], v[24:27], v[168:171], v[88:91]
    v_mfma_f32_16x16x32_bf16 v[84:87], v[24:27], v[156:159], 0
    v_mfma_f32_16x16x32_bf16 v[84:87], v[28:31], v[160:163], v[84:87]
    buffer_load_dwordx4 v4, s[8:11], s23 offen offset:128 nt lds
    v_mfma_f32_16x16x32_bf16 v[84:87], v[32:35], v[164:167], v[84:87]
    s_add_u32 m0, s25, 1792
    v_mfma_f32_16x16x32_bf16 v[80:83], v[32:35], v[136:139], 0
    v_mfma_f32_16x16x32_bf16 v[80:83], v[28:31], v[132:135], v[80:83]
    v_mfma_f32_16x16x32_bf16 v[80:83], v[24:27], v[128:131], v[80:83]
    v_mfma_f32_16x16x32_bf16 v[76:79], v[24:27], v[96:99], 0
    ds_read_b128 v[24:27], v3 offset:5120
    v_mfma_f32_16x16x32_bf16 v[76:79], v[28:31], v[100:103], v[76:79]
    ds_read_b128 v[28:31], v3 offset:0
    v_mfma_f32_16x16x32_bf16 v[76:79], v[32:35], v[104:107], v[76:79]
    ds_read_b128 v[32:35], v3 offset:8192
    s_waitcnt lgkmcnt(4)
    v_mfma_f32_16x16x32_bf16 v[56:59], v[16:19], v[108:111], v[56:59]
    buffer_load_dwordx4 v4, s[8:11], s23 offen offset:256 nt lds
    s_waitcnt lgkmcnt(3)
    v_mfma_f32_16x16x32_bf16 v[60:63], v[16:19], v[20:23], v[60:63]
    s_add_u32 m0, s25, 2688
    ds_read_b128 v[20:23], v1 offset:9216
    s_waitcnt lgkmcnt(3)
    v_mfma_f32_16x16x32_bf16 v[64:67], v[16:19], v[24:27], v[64:67]
    buffer_load_dwordx4 v4, s[8:11], s23 offen offset:384 nt lds
    s_waitcnt lgkmcnt(2)
    v_mfma_f32_16x16x32_bf16 v[68:71], v[16:19], v[28:31], v[68:71]
    s_add_u32 m0, s27, 49152
    s_waitcnt lgkmcnt(1)
    v_mfma_f32_16x16x32_bf16 v[72:75], v[16:19], v[32:35], v[72:75]
    ds_read_b128 v[16:19], v3 offset:15360
    s_waitcnt lgkmcnt(1)
    v_mfma_f32_16x16x32_bf16 v[92:95], v[20:23], v[32:35], v[92:95]
    ds_read_b128 v[32:35], v0 offset:2048
    v_mfma_f32_16x16x32_bf16 v[88:91], v[20:23], v[28:31], v[88:91]
    ds_read_b128 v[28:31], v3 offset:6144
    v_mfma_f32_16x16x32_bf16 v[84:87], v[20:23], v[24:27], v[84:87]
    ds_read_b128 v[24:27], v3 offset:1024
    s_waitcnt lgkmcnt(3)
    v_mfma_f32_16x16x32_bf16 v[80:83], v[20:23], v[16:19], v[80:83]
    ds_read_b128 v[16:19], v3 offset:9216
    v_mfma_f32_16x16x32_bf16 v[76:79], v[20:23], v[108:111], v[76:79]
    ds_read_b128 v[20:23], v0 offset:10240
    s_waitcnt lgkmcnt(4)
    v_mfma_f32_16x16x32_bf16 v[56:59], v[32:35], v[112:115], v[56:59]
    buffer_load_dwordx4 v4, s[12:15], s24 offen offset:0 nt lds
    v_mfma_f32_16x16x32_bf16 v[60:63], v[32:35], v[140:143], v[60:63]
    s_add_u32 m0, s27, 50048
    s_waitcnt lgkmcnt(3)
    v_mfma_f32_16x16x32_bf16 v[64:67], v[32:35], v[28:31], v[64:67]
    buffer_load_dwordx4 v4, s[12:15], s24 offen offset:128 nt lds
    s_waitcnt lgkmcnt(2)
    v_mfma_f32_16x16x32_bf16 v[68:71], v[32:35], v[24:27], v[68:71]
    s_add_u32 m0, s27, 50944
    s_waitcnt lgkmcnt(1)
    v_mfma_f32_16x16x32_bf16 v[72:75], v[32:35], v[16:19], v[72:75]
    ds_read_b128 v[32:35], v1 offset:2048
    s_waitcnt lgkmcnt(1)
    v_mfma_f32_16x16x32_bf16 v[92:95], v[20:23], v[16:19], v[92:95]
    ds_read_b128 v[16:19], v3 offset:7168
    v_mfma_f32_16x16x32_bf16 v[88:91], v[20:23], v[24:27], v[88:91]
    ds_read_b128 v[24:27], v3 offset:2048
    v_mfma_f32_16x16x32_bf16 v[84:87], v[20:23], v[28:31], v[84:87]
    ds_read_b128 v[28:31], v3 offset:10240
    v_mfma_f32_16x16x32_bf16 v[80:83], v[20:23], v[140:143], v[80:83]
    buffer_load_dwordx4 v4, s[12:15], s24 offen offset:256 nt lds
    v_mfma_f32_16x16x32_bf16 v[76:79], v[20:23], v[112:115], v[76:79]
    s_add_u32 m0, s27, 51840
    ds_read_b128 v[20:23], v1 offset:10240
    s_waitcnt lgkmcnt(4)
    v_mfma_f32_16x16x32_bf16 v[56:59], v[32:35], v[116:119], v[56:59]
    v_mfma_f32_16x16x32_bf16 v[60:63], v[32:35], v[144:147], v[60:63]
    s_waitcnt lgkmcnt(3)
    v_mfma_f32_16x16x32_bf16 v[64:67], v[32:35], v[16:19], v[64:67]
    buffer_load_dwordx4 v4, s[12:15], s24 offen offset:384 nt lds
    s_waitcnt lgkmcnt(2)
    v_mfma_f32_16x16x32_bf16 v[68:71], v[32:35], v[24:27], v[68:71]
    s_mov_b32 s28, s25
    s_waitcnt lgkmcnt(1)
    v_mfma_f32_16x16x32_bf16 v[72:75], v[32:35], v[28:31], v[72:75]
    s_mov_b32 s25, s26
    ds_read_b128 v[32:35], v0 offset:3072
    s_waitcnt lgkmcnt(1)
    v_mfma_f32_16x16x32_bf16 v[92:95], v[20:23], v[28:31], v[92:95]
    s_mov_b32 s26, s27
    ds_read_b128 v[28:31], v3 offset:13312
    s_mov_b32 s27, s28
    v_mfma_f32_16x16x32_bf16 v[88:91], v[20:23], v[24:27], v[88:91]
    s_add_u32 s23, s23, 16384
    ds_read_b128 v[24:27], v3 offset:3072
    s_add_u32 s24, s24, 16384
    v_mfma_f32_16x16x32_bf16 v[84:87], v[20:23], v[16:19], v[84:87]
    ds_read_b128 v[16:19], v3 offset:11264
    v_mfma_f32_16x16x32_bf16 v[80:83], v[20:23], v[144:147], v[80:83]
    v_mfma_f32_16x16x32_bf16 v[76:79], v[20:23], v[116:119], v[76:79]
    s_waitcnt lgkmcnt(3)
    ds_read_b128 v[20:23], v0 offset:11264
    v_add_u32 v0, s29, v0
    v_mfma_f32_16x16x32_bf16 v[56:59], v[32:35], v[120:123], v[56:59]
    v_mfma_f32_16x16x32_bf16 v[60:63], v[32:35], v[148:151], v[60:63]
    s_waitcnt lgkmcnt(3)
    v_mfma_f32_16x16x32_bf16 v[64:67], v[32:35], v[28:31], v[64:67]
    s_waitcnt lgkmcnt(2)
    v_mfma_f32_16x16x32_bf16 v[68:71], v[32:35], v[24:27], v[68:71]
    s_waitcnt lgkmcnt(1)
    v_mfma_f32_16x16x32_bf16 v[72:75], v[32:35], v[16:19], v[72:75]
    ds_read_b128 v[32:35], v1 offset:3072
    s_waitcnt lgkmcnt(1)
    v_mfma_f32_16x16x32_bf16 v[92:95], v[20:23], v[16:19], v[92:95]
    ds_read_b128 v[16:19], v3 offset:14336
    v_mfma_f32_16x16x32_bf16 v[88:91], v[20:23], v[24:27], v[88:91]
    ds_read_b128 v[24:27], v3 offset:4096
    v_mfma_f32_16x16x32_bf16 v[84:87], v[20:23], v[28:31], v[84:87]
    ds_read_b128 v[28:31], v3 offset:12288
    v_mfma_f32_16x16x32_bf16 v[80:83], v[20:23], v[148:151], v[80:83]
    v_mfma_f32_16x16x32_bf16 v[76:79], v[20:23], v[120:123], v[76:79]
    s_waitcnt lgkmcnt(3)
    ds_read_b128 v[20:23], v1 offset:11264
    v_add_u32 v1, s29, v1
    v_mfma_f32_16x16x32_bf16 v[56:59], v[32:35], v[124:127], v[56:59]
    v_mfma_f32_16x16x32_bf16 v[60:63], v[32:35], v[152:155], v[60:63]
    s_waitcnt lgkmcnt(3)
    v_mfma_f32_16x16x32_bf16 v[64:67], v[32:35], v[16:19], v[64:67]
    s_waitcnt lgkmcnt(2)
    v_mfma_f32_16x16x32_bf16 v[68:71], v[32:35], v[24:27], v[68:71]
    s_waitcnt lgkmcnt(1)
    v_mfma_f32_16x16x32_bf16 v[72:75], v[32:35], v[28:31], v[72:75]
    ds_read_b64_tr_b16 v[32:33], v2 offset:0
    s_waitcnt lgkmcnt(1)
    v_mfma_f32_16x16x32_bf16 v[92:95], v[20:23], v[28:31], v[92:95]
    ds_read_b64_tr_b16 v[34:35], v2 offset:8192
    v_mfma_f32_16x16x32_bf16 v[88:91], v[20:23], v[24:27], v[88:91]
    ds_read_b64_tr_b16 v[28:29], v2 offset:1024
    v_mfma_f32_16x16x32_bf16 v[84:87], v[20:23], v[16:19], v[84:87]
    ds_read_b64_tr_b16 v[30:31], v2 offset:9216
    v_mfma_f32_16x16x32_bf16 v[80:83], v[20:23], v[152:155], v[80:83]
    ds_read_b64_tr_b16 v[16:17], v2 offset:2048
    v_mfma_f32_16x16x32_bf16 v[76:79], v[20:23], v[124:127], v[76:79]
    ds_read_b64_tr_b16 v[18:19], v2 offset:10240
    s_waitcnt lgkmcnt(4)
    v_mfma_f32_16x16x32_bf16 a[0:3], v[36:39], v[32:35], a[0:3]
    ds_read_b64_tr_b16 v[20:21], v2 offset:3072
    v_mfma_f32_16x16x32_bf16 a[64:67], v[40:43], v[32:35], a[64:67]
    ds_read_b64_tr_b16 v[22:23], v2 offset:11264
    v_xor_b32 v2, 32, v2
    v_mfma_f32_16x16x32_bf16 a[128:131], v[44:47], v[32:35], a[128:131]
    ds_read_b64_tr_b16 v[24:25], v2 offset:0
    v_mfma_f32_16x16x32_bf16 a[192:195], v[48:51], v[32:35], a[192:195]
    ds_read_b64_tr_b16 v[26:27], v2 offset:8192
    v_mfma_f32_16x16x32_bf16 v[192:195], v[52:55], v[32:35], v[192:195]
    s_waitcnt lgkmcnt(6)
    v_sub_f32 v56, v56, v6
    v_exp_f32 v56, v56
    v_mfma_f32_16x16x32_bf16 a[16:19], v[36:39], v[28:31], a[16:19]
    v_sub_f32 v57, v57, v6
    v_exp_f32 v57, v57
    v_mfma_f32_16x16x32_bf16 a[80:83], v[40:43], v[28:31], a[80:83]
    v_sub_f32 v58, v58, v6
    v_exp_f32 v58, v58
    v_mfma_f32_16x16x32_bf16 a[144:147], v[44:47], v[28:31], a[144:147]
    v_sub_f32 v59, v59, v6
    v_exp_f32 v59, v59
    v_mfma_f32_16x16x32_bf16 a[208:211], v[48:51], v[28:31], a[208:211]
    v_sub_f32 v60, v60, v7
    v_exp_f32 v60, v60
    v_mfma_f32_16x16x32_bf16 v[208:211], v[52:55], v[28:31], v[208:211]
    s_waitcnt lgkmcnt(4)
    ds_read_b64_tr_b16 v[28:29], v2 offset:1024
    v_add_f32 v5, v56, v57
    v_mfma_f32_16x16x32_bf16 a[32:35], v[36:39], v[16:19], a[32:35]
    ds_read_b64_tr_b16 v[30:31], v2 offset:9216
    v_cvt_pk_bf16_f32 v56, v56, v57
    v_mfma_f32_16x16x32_bf16 a[96:99], v[40:43], v[16:19], a[96:99]
    ds_read_b64_tr_b16 v[32:33], v2 offset:2048
    v_cvt_pk_bf16_f32 v57, v58, v59
    v_mfma_f32_16x16x32_bf16 a[160:163], v[44:47], v[16:19], a[160:163]
    ds_read_b64_tr_b16 v[34:35], v2 offset:10240
    v_add_f32 v58, v58, v59
    v_mfma_f32_16x16x32_bf16 a[224:227], v[48:51], v[16:19], a[224:227]
    v_sub_f32 v61, v61, v7
    v_exp_f32 v61, v61
    v_mfma_f32_16x16x32_bf16 v[224:227], v[52:55], v[16:19], v[224:227]
    s_waitcnt lgkmcnt(6)
    ds_read_b64_tr_b16 v[16:17], v2 offset:3072
    v_add_f32 v58, v58, v5
    v_mfma_f32_16x16x32_bf16 a[48:51], v[36:39], v[20:23], a[48:51]
    ds_read_b64_tr_b16 v[18:19], v2 offset:11264
    v_xor_b32 v2, 64, v2
    v_mfma_f32_16x16x32_bf16 a[112:115], v[40:43], v[20:23], a[112:115]
    v_sub_f32 v62, v62, v7
    v_exp_f32 v62, v62
    v_mfma_f32_16x16x32_bf16 a[176:179], v[44:47], v[20:23], a[176:179]
    v_sub_f32 v63, v63, v7
    v_exp_f32 v63, v63
    v_mfma_f32_16x16x32_bf16 a[240:243], v[48:51], v[20:23], a[240:243]
    v_sub_f32 v64, v64, v8
    v_exp_f32 v64, v64
    v_mfma_f32_16x16x32_bf16 v[240:243], v[52:55], v[20:23], v[240:243]
    s_waitcnt lgkmcnt(6)
    ds_read_b64_tr_b16 v[20:21], v2 offset:0
    v_add_f32 v5, v60, v61
    v_mfma_f32_16x16x32_bf16 a[4:7], v[36:39], v[24:27], a[4:7]
    ds_read_b64_tr_b16 v[22:23], v2 offset:8192
    v_cvt_pk_bf16_f32 v60, v60, v61
    v_mfma_f32_16x16x32_bf16 a[68:71], v[40:43], v[24:27], a[68:71]
    v_sub_f32 v65, v65, v8
    v_exp_f32 v65, v65
    v_mfma_f32_16x16x32_bf16 a[132:135], v[44:47], v[24:27], a[132:135]
    v_sub_f32 v66, v66, v8
    v_exp_f32 v66, v66
    v_mfma_f32_16x16x32_bf16 a[196:199], v[48:51], v[24:27], a[196:199]
    v_sub_f32 v67, v67, v8
    v_exp_f32 v67, v67
    v_mfma_f32_16x16x32_bf16 v[196:199], v[52:55], v[24:27], v[196:199]
    s_waitcnt lgkmcnt(6)
    ds_read_b64_tr_b16 v[24:25], v2 offset:1024
    v_cvt_pk_bf16_f32 v61, v62, v63
    v_mfma_f32_16x16x32_bf16 a[20:23], v[36:39], v[28:31], a[20:23]
    ds_read_b64_tr_b16 v[26:27], v2 offset:9216
    v_add_f32 v62, v62, v63
    v_mfma_f32_16x16x32_bf16 a[84:87], v[40:43], v[28:31], a[84:87]
    v_sub_f32 v68, v68, v9
    v_exp_f32 v68, v68
    v_mfma_f32_16x16x32_bf16 a[148:151], v[44:47], v[28:31], a[148:151]
    v_sub_f32 v69, v69, v9
    v_exp_f32 v69, v69
    v_mfma_f32_16x16x32_bf16 a[212:215], v[48:51], v[28:31], a[212:215]
    v_sub_f32 v70, v70, v9
    v_exp_f32 v70, v70
    v_mfma_f32_16x16x32_bf16 v[212:215], v[52:55], v[28:31], v[212:215]
    s_waitcnt lgkmcnt(6)
    ds_read_b64_tr_b16 v[28:29], v2 offset:2048
    v_add_f32 v62, v62, v5
    v_mfma_f32_16x16x32_bf16 a[36:39], v[36:39], v[32:35], a[36:39]
    ds_read_b64_tr_b16 v[30:31], v2 offset:10240
    v_add_f32 v5, v64, v65
    v_mfma_f32_16x16x32_bf16 a[100:103], v[40:43], v[32:35], a[100:103]
    v_sub_f32 v71, v71, v9
    v_exp_f32 v71, v71
    v_mfma_f32_16x16x32_bf16 a[164:167], v[44:47], v[32:35], a[164:167]
    v_sub_f32 v72, v72, v10
    v_exp_f32 v72, v72
    v_mfma_f32_16x16x32_bf16 a[228:231], v[48:51], v[32:35], a[228:231]
    v_sub_f32 v73, v73, v10
    v_exp_f32 v73, v73
    v_mfma_f32_16x16x32_bf16 v[228:231], v[52:55], v[32:35], v[228:231]
    s_waitcnt lgkmcnt(6)
    ds_read_b64_tr_b16 v[32:33], v2 offset:3072
    v_cvt_pk_bf16_f32 v64, v64, v65
    v_mfma_f32_16x16x32_bf16 a[52:55], v[36:39], v[16:19], a[52:55]
    ds_read_b64_tr_b16 v[34:35], v2 offset:11264
    v_xor_b32 v2, 32, v2
    v_mfma_f32_16x16x32_bf16 a[116:119], v[40:43], v[16:19], a[116:119]
    v_sub_f32 v74, v74, v10
    v_exp_f32 v74, v74
    v_mfma_f32_16x16x32_bf16 a[180:183], v[44:47], v[16:19], a[180:183]
    v_sub_f32 v75, v75, v10
    v_exp_f32 v75, v75
    v_mfma_f32_16x16x32_bf16 a[244:247], v[48:51], v[16:19], a[244:247]
    v_sub_f32 v92, v92, v10
    v_exp_f32 v92, v92
    v_mfma_f32_16x16x32_bf16 v[244:247], v[52:55], v[16:19], v[244:247]
    s_waitcnt lgkmcnt(6)
    ds_read_b64_tr_b16 v[16:17], v2 offset:0
    v_cvt_pk_bf16_f32 v65, v66, v67
    v_mfma_f32_16x16x32_bf16 a[12:15], v[36:39], v[20:23], a[12:15]
    ds_read_b64_tr_b16 v[18:19], v2 offset:8192
    v_add_f32 v66, v66, v67
    v_mfma_f32_16x16x32_bf16 a[76:79], v[40:43], v[20:23], a[76:79]
    v_sub_f32 v93, v93, v10
    v_exp_f32 v93, v93
    v_mfma_f32_16x16x32_bf16 a[140:143], v[44:47], v[20:23], a[140:143]
    v_sub_f32 v94, v94, v10
    v_exp_f32 v94, v94
    v_mfma_f32_16x16x32_bf16 a[204:207], v[48:51], v[20:23], a[204:207]
    v_sub_f32 v95, v95, v10
    v_exp_f32 v95, v95
    v_mfma_f32_16x16x32_bf16 v[204:207], v[52:55], v[20:23], v[204:207]
    s_waitcnt lgkmcnt(6)
    ds_read_b64_tr_b16 v[20:21], v2 offset:1024
    v_add_f32 v66, v66, v5
    v_mfma_f32_16x16x32_bf16 a[28:31], v[36:39], v[24:27], a[28:31]
    ds_read_b64_tr_b16 v[22:23], v2 offset:9216
    v_add_f32 v5, v68, v69
    v_mfma_f32_16x16x32_bf16 a[92:95], v[40:43], v[24:27], a[92:95]
    v_sub_f32 v88, v88, v9
    v_exp_f32 v88, v88
    v_mfma_f32_16x16x32_bf16 a[156:159], v[44:47], v[24:27], a[156:159]
    v_sub_f32 v89, v89, v9
    v_exp_f32 v89, v89
    v_mfma_f32_16x16x32_bf16 a[220:223], v[48:51], v[24:27], a[220:223]
    v_sub_f32 v90, v90, v9
    v_exp_f32 v90, v90
    v_mfma_f32_16x16x32_bf16 v[220:223], v[52:55], v[24:27], v[220:223]
    s_waitcnt lgkmcnt(6)
    ds_read_b64_tr_b16 v[24:25], v2 offset:2048
    v_cvt_pk_bf16_f32 v68, v68, v69
    v_mfma_f32_16x16x32_bf16 a[44:47], v[36:39], v[28:31], a[44:47]
    ds_read_b64_tr_b16 v[26:27], v2 offset:10240
    v_cvt_pk_bf16_f32 v69, v70, v71
    v_mfma_f32_16x16x32_bf16 a[108:111], v[40:43], v[28:31], a[108:111]
    v_sub_f32 v91, v91, v9
    v_exp_f32 v91, v91
    v_mfma_f32_16x16x32_bf16 a[172:175], v[44:47], v[28:31], a[172:175]
    v_sub_f32 v84, v84, v8
    v_exp_f32 v84, v84
    v_mfma_f32_16x16x32_bf16 a[236:239], v[48:51], v[28:31], a[236:239]
    v_sub_f32 v85, v85, v8
    v_exp_f32 v85, v85
    v_mfma_f32_16x16x32_bf16 v[236:239], v[52:55], v[28:31], v[236:239]
    s_waitcnt lgkmcnt(6)
    ds_read_b64_tr_b16 v[28:29], v2 offset:3072
    v_add_f32 v70, v70, v71
    v_mfma_f32_16x16x32_bf16 a[60:63], v[36:39], v[32:35], a[60:63]
    ds_read_b64_tr_b16 v[30:31], v2 offset:11264
    v_xad_u32 v2, v2, 64, s30
    v_mfma_f32_16x16x32_bf16 a[124:127], v[40:43], v[32:35], a[124:127]
    v_sub_f32 v86, v86, v8
    v_exp_f32 v86, v86
    v_mfma_f32_16x16x32_bf16 a[188:191], v[44:47], v[32:35], a[188:191]
    v_sub_f32 v87, v87, v8
    v_exp_f32 v87, v87
    v_mfma_f32_16x16x32_bf16 a[252:255], v[48:51], v[32:35], a[252:255]
    v_sub_f32 v80, v80, v7
    v_exp_f32 v80, v80
    v_mfma_f32_16x16x32_bf16 v[252:255], v[52:55], v[32:35], v[252:255]
    s_waitcnt lgkmcnt(6)
    v_sub_f32 v81, v81, v7
    v_exp_f32 v81, v81
    v_mfma_f32_16x16x32_bf16 a[8:11], v[36:39], v[16:19], a[8:11]
    v_sub_f32 v82, v82, v7
    v_exp_f32 v82, v82
    v_mfma_f32_16x16x32_bf16 a[72:75], v[40:43], v[16:19], a[72:75]
    v_sub_f32 v83, v83, v7
    v_exp_f32 v83, v83
    v_mfma_f32_16x16x32_bf16 a[136:139], v[44:47], v[16:19], a[136:139]
    v_sub_f32 v76, v76, v6
    v_exp_f32 v76, v76
    v_mfma_f32_16x16x32_bf16 a[200:203], v[48:51], v[16:19], a[200:203]
    v_sub_f32 v77, v77, v6
    v_exp_f32 v77, v77
    v_mfma_f32_16x16x32_bf16 v[200:203], v[52:55], v[16:19], v[200:203]
    s_waitcnt vmcnt(8) lgkmcnt(0)
    s_barrier
    ds_read_b128 v[32:35], v0 offset:0
    v_mfma_f32_16x16x32_bf16 a[24:27], v[36:39], v[20:23], a[24:27]
    ds_read_b128 v[16:19], v1 offset:0
    v_add_f32 v70, v70, v5
    v_mfma_f32_16x16x32_bf16 a[88:91], v[40:43], v[20:23], a[88:91]
    v_sub_f32 v78, v78, v6
    v_exp_f32 v78, v78
    v_mfma_f32_16x16x32_bf16 a[152:155], v[44:47], v[20:23], a[152:155]
    v_sub_f32 v79, v79, v6
    v_exp_f32 v79, v79
    v_mfma_f32_16x16x32_bf16 a[216:219], v[48:51], v[20:23], a[216:219]
    v_add_f32 v5, v72, v73
    v_cvt_pk_bf16_f32 v72, v72, v73
    v_mfma_f32_16x16x32_bf16 v[216:219], v[52:55], v[20:23], v[216:219]
    ds_read_b128 v[20:23], v0 offset:1024
    v_cvt_pk_bf16_f32 v73, v74, v75
    v_mfma_f32_16x16x32_bf16 a[40:43], v[36:39], v[24:27], a[40:43]
    v_add_f32 v74, v74, v75
    v_add_f32 v74, v74, v5
    v_mfma_f32_16x16x32_bf16 a[104:107], v[40:43], v[24:27], a[104:107]
    v_add_f32 v75, v74, v92
    v_cvt_pk_bf16_f32 v74, v92, v93
    v_mfma_f32_16x16x32_bf16 a[168:171], v[44:47], v[24:27], a[168:171]
    v_add_f32 v92, v75, v93
    v_add_f32 v92, v92, v94
    v_mfma_f32_16x16x32_bf16 a[232:235], v[48:51], v[24:27], a[232:235]
    v_cvt_pk_bf16_f32 v75, v94, v95
    v_add_f32 v92, v92, v95
    v_mfma_f32_16x16x32_bf16 v[232:235], v[52:55], v[24:27], v[232:235]
    ds_read_b128 v[24:27], v0 offset:8192
    v_add_f32 v71, v70, v88
    v_mfma_f32_16x16x32_bf16 a[56:59], v[36:39], v[28:31], a[56:59]
    v_cvt_pk_bf16_f32 v70, v88, v89
    v_add_f32 v88, v71, v89
    v_mfma_f32_16x16x32_bf16 a[120:123], v[40:43], v[28:31], a[120:123]
    v_add_f32 v88, v88, v90
    v_cvt_pk_bf16_f32 v71, v90, v91
    v_mfma_f32_16x16x32_bf16 a[184:187], v[44:47], v[28:31], a[184:187]
    v_add_f32 v88, v88, v91
    v_add_f32 v67, v66, v84
    v_mfma_f32_16x16x32_bf16 a[248:251], v[48:51], v[28:31], a[248:251]
    v_cvt_pk_bf16_f32 v66, v84, v85
    v_add_f32 v84, v67, v85
    v_mfma_f32_16x16x32_bf16 v[248:251], v[52:55], v[28:31], v[248:251]
    s_waitcnt lgkmcnt(3)
    v_add_f32 v84, v84, v86
    v_cvt_pk_bf16_f32 v67, v86, v87
    v_mfma_f32_16x16x32_bf16 v[36:39], v[32:35], v[96:99], 0
    s_waitcnt lgkmcnt(2)
    ds_read_b128 v[28:31], v1 offset:8192
    v_add_f32 v84, v84, v87
    v_mfma_f32_16x16x32_bf16 v[36:39], v[16:19], v[100:103], v[36:39]
    s_waitcnt lgkmcnt(2)
    v_add_f32 v63, v62, v80
    v_cvt_pk_bf16_f32 v62, v80, v81
    v_mfma_f32_16x16x32_bf16 v[36:39], v[20:23], v[104:107], v[36:39]
    s_sub_u32 s29, s27, s26
    v_add_f32 v80, v63, v81
    v_add_f32 v80, v80, v82
    v_mfma_f32_16x16x32_bf16 v[40:43], v[20:23], v[136:139], 0
    s_sub_u32 s30, s26, s25
    v_add_f32 v80, v80, v83
    v_add_f32 v59, v58, v76
    v_mfma_f32_16x16x32_bf16 v[40:43], v[16:19], v[132:135], v[40:43]
    s_add_u32 m0, s25, 0
    v_cvt_pk_bf16_f32 v58, v76, v77
    v_add_f32 v76, v59, v77
    v_mfma_f32_16x16x32_bf16 v[40:43], v[32:35], v[128:131], v[40:43]
    v_add_f32 v76, v76, v78
    v_add_f32 v76, v76, v79
    v_mfma_f32_16x16x32_bf16 v[44:47], v[32:35], v[156:159], 0
    v_add_f32 v93, v92, v88
    v_add_f32 v93, v93, v84
    v_mfma_f32_16x16x32_bf16 v[44:47], v[16:19], v[160:163], v[44:47]
    v_add_f32 v93, v93, v80
    v_add_f32 v93, v93, v76
    v_mfma_f32_16x16x32_bf16 v[44:47], v[20:23], v[164:167], v[44:47]
    v_cmp_ngt_f32 vcc, s21, v93
    v_cvt_pk_bf16_f32 v63, v82, v83
    v_mfma_f32_16x16x32_bf16 v[48:51], v[20:23], v[176:179], 0
    v_cvt_pk_bf16_f32 v59, v78, v79
    v_mfma_f32_16x16x32_bf16 v[48:51], v[16:19], v[172:175], v[48:51]
    v_mfma_f32_16x16x32_bf16 v[48:51], v[32:35], v[168:171], v[48:51]
    s_cbranch_vccnz L_slowB
L_retB:
    v_mfma_f32_16x16x32_bf16 v[52:55], v[32:35], v[180:183], 0
    ds_read_b128 v[32:35], v0 offset:9216
    v_add_f32 v15, v15, v92
    v_mfma_f32_16x16x32_bf16 v[52:55], v[16:19], v[184:187], v[52:55]
    ds_read_b128 v[16:19], v1 offset:1024
    v_add_f32 v14, v14, v88
    v_mfma_f32_16x16x32_bf16 v[52:55], v[20:23], v[188:191], v[52:55]
    s_waitcnt lgkmcnt(3)
    ds_read_b128 v[20:23], v3 offset:15360
    v_add_f32 v13, v13, v84
    v_mfma_f32_16x16x32_bf16 v[92:95], v[24:27], v[180:183], 0
    s_waitcnt lgkmcnt(3)
    v_add_f32 v12, v12, v80
    v_add_f32 v11, v11, v76
    v_mfma_f32_16x16x32_bf16 v[92:95], v[28:31], v[184:187], v[92:95]
    s_waitcnt lgkmcnt(2)
    v_mfma_f32_16x16x32_bf16 v[92:95], v[32:35], v[188:191], v[92:95]
    buffer_load_dwordx4 v4, s[8:11], s23 offen offset:0 nt lds
    v_mfma_f32_16x16x32_bf16 v[88:91], v[32:35], v[176:179], 0
    s_add_u32 m0, s25, 896
    v_mfma_f32_16x16x32_bf16 v[88:91], v[28:31], v[172:175], v[88:91]
    v_mfma_f32_16x16x32_bf16 v[88:91], v[24:27], v[168:171], v[88:91]
    v_mfma_f32_16x16x32_bf16 v[84:87], v[24:27], v[156:159], 0
    v_mfma_f32_16x16x32_bf16 v[84:87], v[28:31], v[160:163], v[84:87]
    buffer_load_dwordx4 v4, s[8:11], s23 offen offset:128 nt lds
    v_mfma_f32_16x16x32_bf16 v[84:87], v[32:35], v[164:167], v[84:87]
    s_add_u32 m0, s25, 1792
    v_mfma_f32_16x16x32_bf16 v[80:83], v[32:35], v[136:139], 0
    v_mfma_f32_16x16x32_bf16 v[80:83], v[28:31], v[132:135], v[80:83]
    v_mfma_f32_16x16x32_bf16 v[80:83], v[24:27], v[128:131], v[80:83]
    v_mfma_f32_16x16x32_bf16 v[76:79], v[24:27], v[96:99], 0
    ds_read_b128 v[24:27], v3 offset:5120
    v_mfma_f32_16x16x32_bf16 v[76:79], v[28:31], v[100:103], v[76:79]
    ds_read_b128 v[28:31], v3 offset:0
    v_mfma_f32_16x16x32_bf16 v[76:79], v[32:35], v[104:107], v[76:79]
    ds_read_b128 v[32:35], v3 offset:8192
    s_waitcnt lgkmcnt(4)
    v_mfma_f32_16x16x32_bf16 v[36:39], v[16:19], v[108:111], v[36:39]
    buffer_load_dwordx4 v4, s[8:11], s23 offen offset:256 nt lds
    s_waitcnt lgkmcnt(3)
    v_mfma_f32_16x16x32_bf16 v[40:43], v[16:19], v[20:23], v[40:43]
    s_add_u32 m0, s25, 2688
    ds_read_b128 v[20:23], v1 offset:9216
    s_waitcnt lgkmcnt(3)
    v_mfma_f32_16x16x32_bf16 v[44:47], v[16:19], v[24:27], v[44:47]
    buffer_load_dwordx4 v4, s[8:11], s23 offen offset:384 nt lds
    s_waitcnt lgkmcnt(2)
    v_mfma_f32_16x16x32_bf16 v[48:51], v[16:19], v[28:31], v[48:51]
    s_add_u32 m0, s27, 49152
    s_waitcnt lgkmcnt(1)
    v_mfma_f32_16x16x32_bf16 v[52:55], v[16:19], v[32:35], v[52:55]
    ds_read_b128 v[16:19], v3 offset:15360
    s_waitcnt lgkmcnt(1)
    v_mfma_f32_16x16x32_bf16 v[92:95], v[20:23], v[32:35], v[92:95]
    ds_read_b128 v[32:35], v0 offset:2048
    v_mfma_f32_16x16x32_bf16 v[88:91], v[20:23], v[28:31], v[88:91]
    ds_read_b128 v[28:31], v3 offset:6144
    v_mfma_f32_16x16x32_bf16 v[84:87], v[20:23], v[24:27], v[84:87]
    ds_read_b128 v[24:27], v3 offset:1024
    s_waitcnt lgkmcnt(3)
    v_mfma_f32_16x16x32_bf16 v[80:83], v[20:23], v[16:19], v[80:83]
    ds_read_b128 v[16:19], v3 offset:9216
    v_mfma_f32_16x16x32_bf16 v[76:79], v[20:23], v[108:111], v[76:79]
    ds_read_b128 v[20:23], v0 offset:10240
    s_waitcnt lgkmcnt(4)
    v_mfma_f32_16x16x32_bf16 v[36:39], v[32:35], v[112:115], v[36:39]
    buffer_load_dwordx4 v4, s[12:15], s24 offen offset:0 nt lds
    v_mfma_f32_16x16x32_bf16 v[40:43], v[32:35], v[140:143], v[40:43]
    s_add_u32 m0, s27, 50048
    s_waitcnt lgkmcnt(3)
    v_mfma_f32_16x16x32_bf16 v[44:47], v[32:35], v[28:31], v[44:47]
    buffer_load_dwordx4 v4, s[12:15], s24 offen offset:128 nt lds
    s_waitcnt lgkmcnt(2)
    v_mfma_f32_16x16x32_bf16 v[48:51], v[32:35], v[24:27], v[48:51]
    s_add_u32 m0, s27, 50944
    s_waitcnt lgkmcnt(1)
    v_mfma_f32_16x16x32_bf16 v[52:55], v[32:35], v[16:19], v[52:55]
    ds_read_b128 v[32:35], v1 offset:2048
    s_waitcnt lgkmcnt(1)
    v_mfma_f32_16x16x32_bf16 v[92:95], v[20:23], v[16:19], v[92:95]
    ds_read_b128 v[16:19], v3 offset:7168
    v_mfma_f32_16x16x32_bf16 v[88:91], v[20:23], v[24:27], v[88:91]
    ds_read_b128 v[24:27], v3 offset:2048
    v_mfma_f32_16x16x32_bf16 v[84:87], v[20:23], v[28:31], v[84:87]
    ds_read_b128 v[28:31], v3 offset:10240
    v_mfma_f32_16x16x32_bf16 v[80:83], v[20:23], v[140:143], v[80:83]
    buffer_load_dwordx4 v4, s[12:15], s24 offen offset:256 nt lds
    v_mfma_f32_16x16x32_bf16 v[76:79], v[20:23], v[112:115], v[76:79]
    s_add_u32 m0, s27, 51840
    ds_read_b128 v[20:23], v1 offset:10240
    s_waitcnt lgkmcnt(4)
    v_mfma_f32_16x16x32_bf16 v[36:39], v[32:35], v[116:119], v[36:39]
    v_mfma_f32_16x16x32_bf16 v[40:43], v[32:35], v[144:147], v[40:43]
    s_waitcnt lgkmcnt(3)
    v_mfma_f32_16x16x32_bf16 v[44:47], v[32:35], v[16:19], v[44:47]
    buffer_load_dwordx4 v4, s[12:15], s24 offen offset:384 nt lds
    s_waitcnt lgkmcnt(2)
    v_mfma_f32_16x16x32_bf16 v[48:51], v[32:35], v[24:27], v[48:51]
    s_mov_b32 s28, s25
    s_waitcnt lgkmcnt(1)
    v_mfma_f32_16x16x32_bf16 v[52:55], v[32:35], v[28:31], v[52:55]
    s_mov_b32 s25, s26
    ds_read_b128 v[32:35], v0 offset:3072
    s_waitcnt lgkmcnt(1)
    v_mfma_f32_16x16x32_bf16 v[92:95], v[20:23], v[28:31], v[92:95]
    s_mov_b32 s26, s27
    ds_read_b128 v[28:31], v3 offset:13312
    s_mov_b32 s27, s28
    v_mfma_f32_16x16x32_bf16 v[88:91], v[20:23], v[24:27], v[88:91]
    s_add_u32 s23, s23, 16384
    ds_read_b128 v[24:27], v3 offset:3072
    s_add_u32 s24, s24, 16384
    v_mfma_f32_16x16x32_bf16 v[84:87], v[20:23], v[16:19], v[84:87]
    ds_read_b128 v[16:19], v3 offset:11264
    v_mfma_f32_16x16x32_bf16 v[80:83], v[20:23], v[144:147], v[80:83]
    v_mfma_f32_16x16x32_bf16 v[76:79], v[20:23], v[116:119], v[76:79]
    s_waitcnt lgkmcnt(3)
    ds_read_b128 v[20:23], v0 offset:11264
    v_add_u32 v0, s29, v0
    v_mfma_f32_16x16x32_bf16 v[36:39], v[32:35], v[120:123], v[36:39]
    v_mfma_f32_16x16x32_bf16 v[40:43], v[32:35], v[148:151], v[40:43]
    s_waitcnt lgkmcnt(3)
    v_mfma_f32_16x16x32_bf16 v[44:47], v[32:35], v[28:31], v[44:47]
    s_waitcnt lgkmcnt(2)
    v_mfma_f32_16x16x32_bf16 v[48:51], v[32:35], v[24:27], v[48:51]
    s_waitcnt lgkmcnt(1)
    v_mfma_f32_16x16x32_bf16 v[52:55], v[32:35], v[16:19], v[52:55]
    ds_read_b128 v[32:35], v1 offset:3072
    s_waitcnt lgkmcnt(1)
    v_mfma_f32_16x16x32_bf16 v[92:95], v[20:23], v[16:19], v[92:95]
    ds_read_b128 v[16:19], v3 offset:14336
    v_mfma_f32_16x16x32_bf16 v[88:91], v[20:23], v[24:27], v[88:91]
    ds_read_b128 v[24:27], v3 offset:4096
    v_mfma_f32_16x16x32_bf16 v[84:87], v[20:23], v[28:31], v[84:87]
    ds_read_b128 v[28:31], v3 offset:12288
    v_mfma_f32_16x16x32_bf16 v[80:83], v[20:23], v[148:151], v[80:83]
    v_mfma_f32_16x16x32_bf16 v[76:79], v[20:23], v[120:123], v[76:79]
    s_waitcnt lgkmcnt(3)
    ds_read_b128 v[20:23], v1 offset:11264
    v_add_u32 v1, s29, v1
    v_mfma_f32_16x16x32_bf16 v[36:39], v[32:35], v[124:127], v[36:39]
    v_mfma_f32_16x16x32_bf16 v[40:43], v[32:35], v[152:155], v[40:43]
    s_waitcnt lgkmcnt(3)
    v_mfma_f32_16x16x32_bf16 v[44:47], v[32:35], v[16:19], v[44:47]
    s_waitcnt lgkmcnt(2)
    v_mfma_f32_16x16x32_bf16 v[48:51], v[32:35], v[24:27], v[48:51]
    s_waitcnt lgkmcnt(1)
    v_mfma_f32_16x16x32_bf16 v[52:55], v[32:35], v[28:31], v[52:55]
    ds_read_b64_tr_b16 v[32:33], v2 offset:0
    s_waitcnt lgkmcnt(1)
    v_mfma_f32_16x16x32_bf16 v[92:95], v[20:23], v[28:31], v[92:95]
    ds_read_b64_tr_b16 v[34:35], v2 offset:8192
    v_mfma_f32_16x16x32_bf16 v[88:91], v[20:23], v[24:27], v[88:91]
    ds_read_b64_tr_b16 v[28:29], v2 offset:1024
    v_mfma_f32_16x16x32_bf16 v[84:87], v[20:23], v[16:19], v[84:87]
    ds_read_b64_tr_b16 v[30:31], v2 offset:9216
    v_mfma_f32_16x16x32_bf16 v[80:83], v[20:23], v[152:155], v[80:83]
    ds_read_b64_tr_b16 v[16:17], v2 offset:2048
    v_mfma_f32_16x16x32_bf16 v[76:79], v[20:23], v[124:127], v[76:79]
    ds_read_b64_tr_b16 v[18:19], v2 offset:10240
    s_waitcnt lgkmcnt(4)
    v_mfma_f32_16x16x32_bf16 a[0:3], v[56:59], v[32:35], a[0:3]
    ds_read_b64_tr_b16 v[20:21], v2 offset:3072
    v_mfma_f32_16x16x32_bf16 a[64:67], v[60:63], v[32:35], a[64:67]
    ds_read_b64_tr_b16 v[22:23], v2 offset:11264
    v_xor_b32 v2, 32, v2
    v_mfma_f32_16x16x32_bf16 a[128:131], v[64:67], v[32:35], a[128:131]
    ds_read_b64_tr_b16 v[24:25], v2 offset:0
    v_mfma_f32_16x16x32_bf16 a[192:195], v[68:71], v[32:35], a[192:195]
    ds_read_b64_tr_b16 v[26:27], v2 offset:8192
    v_mfma_f32_16x16x32_bf16 v[192:195], v[72:75], v[32:35], v[192:195]
    s_waitcnt lgkmcnt(6)
    v_sub_f32 v36, v36, v6
    v_exp_f32 v36, v36
    v_mfma_f32_16x16x32_bf16 a[16:19], v[56:59], v[28:31], a[16:19]
    v_sub_f32 v37, v37, v6
    v_exp_f32 v37, v37
    v_mfma_f32_16x16x32_bf16 a[80:83], v[60:63], v[28:31], a[80:83]
    v_sub_f32 v38, v38, v6
    v_exp_f32 v38, v38
    v_mfma_f32_16x16x32_bf16 a[144:147], v[64:67], v[28:31], a[144:147]
    v_sub_f32 v39, v39, v6
    v_exp_f32 v39, v39
    v_mfma_f32_16x16x32_bf16 a[208:211], v[68:71], v[28:31], a[208:211]
    v_sub_f32 v40, v40, v7
    v_exp_f32 v40, v40
    v_mfma_f32_16x16x32_bf16 v[208:211], v[72:75], v[28:31], v[208:211]
    s_waitcnt lgkmcnt(4)
    ds_read_b64_tr_b16 v[28:29], v2 offset:1024
    v_add_f32 v5, v36, v37
    v_mfma_f32_16x16x32_bf16 a[32:35], v[56:59], v[16:19], a[32:35]
    ds_read_b64_tr_b16 v[30:31], v2 offset:9216
    v_cvt_pk_bf16_f32 v36, v36, v37
    v_mfma_f32_16x16x32_bf16 a[96:99], v[60:63], v[16:19], a[96:99]
    ds_read_b64_tr_b16 v[32:33], v2 offset:2048
    v_cvt_pk_bf16_f32 v37, v38, v39
    v_mfma_f32_16x16x32_bf16 a[160:163], v[64:67], v[16:19], a[160:163]
    ds_read_b64_tr_b16 v[34:35], v2 offset:10240
    v_add_f32 v38, v38, v39
    v_mfma_f32_16x16x32_bf16 a[224:227], v[68:71], v[16:19], a[224:227]
    v_sub_f32 v41, v41, v7
    v_exp_f32 v41, v41
    v_mfma_f32_16x16x32_bf16 v[224:227], v[72:75], v[16:19], v[224:227]
    s_waitcnt lgkmcnt(6)
    ds_read_b64_tr_b16 v[16:17], v2 offset:3072
    v_add_f32 v38, v38, v5
    v_mfma_f32_16x16x32_bf16 a[48:51], v[56:59], v[20:23], a[48:51]
    ds_read_b64_tr_b16 v[18:19], v2 offset:11264
    v_xor_b32 v2, 64, v2
    v_mfma_f32_16x16x32_bf16 a[112:115], v[60:63], v[20:23], a[112:115]
    v_sub_f32 v42, v42, v7
    v_exp_f32 v42, v42
    v_mfma_f32_16x16x32_bf16 a[176:179], v[64:67], v[20:23], a[176:179]
    v_sub_f32 v43, v43, v7
    v_exp_f32 v43, v43
    v_mfma_f32_16x16x32_bf16 a[240:243], v[68:71], v[20:23], a[240:243]
    v_sub_f32 v44, v44, v8
    v_exp_f32 v44, v44
    v_mfma_f32_16x16x32_bf16 v[240:243], v[72:75], v[20:23], v[240:243]
    s_waitcnt lgkmcnt(6)
    ds_read_b64_tr_b16 v[20:21], v2 offset:0
    v_add_f32 v5, v40, v41
    v_mfma_f32_16x16x32_bf16 a[4:7], v[56:59], v[24:27], a[4:7]
    ds_read_b64_tr_b16 v[22:23], v2 offset:8192
    v_cvt_pk_bf16_f32 v40, v40, v41
    v_mfma_f32_16x16x32_bf16 a[68:71], v[60:63], v[24:27], a[68:71]
    v_sub_f32 v45, v45, v8
    v_exp_f32 v45, v45
    v_mfma_f32_16x16x32_bf16 a[132:135], v[64:67], v[24:27], a[132:135]
    v_sub_f32 v46, v46, v8
    v_exp_f32 v46, v46
    v_mfma_f32_16x16x32_bf16 a[196:199], v[68:71], v[24:27], a[196:199]
    v_sub_f32 v47, v47, v8
    v_exp_f32 v47, v47
    v_mfma_f32_16x16x32_bf16 v[196:199], v[72:75], v[24:27], v[196:199]
    s_waitcnt lgkmcnt(6)
    ds_read_b64_tr_b16 v[24:25], v2 offset:1024
    v_cvt_pk_bf16_f32 v41, v42, v43
    v_mfma_f32_16x16x32_bf16 a[20:23], v[56:59], v[28:31], a[20:23]
    ds_read_b64_tr_b16 v[26:27], v2 offset:9216
    v_add_f32 v42, v42, v43
    v_mfma_f32_16x16x32_bf16 a[84:87], v[60:63], v[28:31], a[84:87]
    v_sub_f32 v48, v48, v9
    v_exp_f32 v48, v48
    v_mfma_f32_16x16x32_bf16 a[148:151], v[64:67], v[28:31], a[148:151]
    v_sub_f32 v49, v49, v9
    v_exp_f32 v49, v49
    v_mfma_f32_16x16x32_bf16 a[212:215], v[68:71], v[28:31], a[212:215]
    v_sub_f32 v50, v50, v9
    v_exp_f32 v50, v50
    v_mfma_f32_16x16x32_bf16 v[212:215], v[72:75], v[28:31], v[212:215]
    s_waitcnt lgkmcnt(6)
    ds_read_b64_tr_b16 v[28:29], v2 offset:2048
    v_add_f32 v42, v42, v5
    v_mfma_f32_16x16x32_bf16 a[36:39], v[56:59], v[32:35], a[36:39]
    ds_read_b64_tr_b16 v[30:31], v2 offset:10240
    v_add_f32 v5, v44, v45
    v_mfma_f32_16x16x32_bf16 a[100:103], v[60:63], v[32:35], a[100:103]
    v_sub_f32 v51, v51, v9
    v_exp_f32 v51, v51
    v_mfma_f32_16x16x32_bf16 a[164:167], v[64:67], v[32:35], a[164:167]
    v_sub_f32 v52, v52, v10
    v_exp_f32 v52, v52
    v_mfma_f32_16x16x32_bf16 a[228:231], v[68:71], v[32:35], a[228:231]
    v_sub_f32 v53, v53, v10
    v_exp_f32 v53, v53
    v_mfma_f32_16x16x32_bf16 v[228:231], v[72:75], v[32:35], v[228:231]
    s_waitcnt lgkmcnt(6)
    ds_read_b64_tr_b16 v[32:33], v2 offset:3072
    v_cvt_pk_bf16_f32 v44, v44, v45
    v_mfma_f32_16x16x32_bf16 a[52:55], v[56:59], v[16:19], a[52:55]
    ds_read_b64_tr_b16 v[34:35], v2 offset:11264
    v_xor_b32 v2, 32, v2
    v_mfma_f32_16x16x32_bf16 a[116:119], v[60:63], v[16:19], a[116:119]
    v_sub_f32 v54, v54, v10
    v_exp_f32 v54, v54
    v_mfma_f32_16x16x32_bf16 a[180:183], v[64:67], v[16:19], a[180:183]
    v_sub_f32 v55, v55, v10
    v_exp_f32 v55, v55
    v_mfma_f32_16x16x32_bf16 a[244:247], v[68:71], v[16:19], a[244:247]
    v_sub_f32 v92, v92, v10
    v_exp_f32 v92, v92
    v_mfma_f32_16x16x32_bf16 v[244:247], v[72:75], v[16:19], v[244:247]
    s_waitcnt lgkmcnt(6)
    ds_read_b64_tr_b16 v[16:17], v2 offset:0
    v_cvt_pk_bf16_f32 v45, v46, v47
    v_mfma_f32_16x16x32_bf16 a[12:15], v[56:59], v[20:23], a[12:15]
    ds_read_b64_tr_b16 v[18:19], v2 offset:8192
    v_add_f32 v46, v46, v47
    v_mfma_f32_16x16x32_bf16 a[76:79], v[60:63], v[20:23], a[76:79]
    v_sub_f32 v93, v93, v10
    v_exp_f32 v93, v93
    v_mfma_f32_16x16x32_bf16 a[140:143], v[64:67], v[20:23], a[140:143]
    v_sub_f32 v94, v94, v10
    v_exp_f32 v94, v94
    v_mfma_f32_16x16x32_bf16 a[204:207], v[68:71], v[20:23], a[204:207]
    v_sub_f32 v95, v95, v10
    v_exp_f32 v95, v95
    v_mfma_f32_16x16x32_bf16 v[204:207], v[72:75], v[20:23], v[204:207]
    s_waitcnt lgkmcnt(6)
    ds_read_b64_tr_b16 v[20:21], v2 offset:1024
    v_add_f32 v46, v46, v5
    v_mfma_f32_16x16x32_bf16 a[28:31], v[56:59], v[24:27], a[28:31]
    ds_read_b64_tr_b16 v[22:23], v2 offset:9216
    v_add_f32 v5, v48, v49
    v_mfma_f32_16x16x32_bf16 a[92:95], v[60:63], v[24:27], a[92:95]
    v_sub_f32 v88, v88, v9
    v_exp_f32 v88, v88
    v_mfma_f32_16x16x32_bf16 a[156:159], v[64:67], v[24:27], a[156:159]
    v_sub_f32 v89, v89, v9
    v_exp_f32 v89, v89
    v_mfma_f32_16x16x32_bf16 a[220:223], v[68:71], v[24:27], a[220:223]
    v_sub_f32 v90, v90, v9
    v_exp_f32 v90, v90
    v_mfma_f32_16x16x32_bf16 v[220:223], v[72:75], v[24:27], v[220:223]
    s_waitcnt lgkmcnt(6)
    ds_read_b64_tr_b16 v[24:25], v2 offset:2048
    v_cvt_pk_bf16_f32 v48, v48, v49
    v_mfma_f32_16x16x32_bf16 a[44:47], v[56:59], v[28:31], a[44:47]
    ds_read_b64_tr_b16 v[26:27], v2 offset:10240
    v_cvt_pk_bf16_f32 v49, v50, v51
    v_mfma_f32_16x16x32_bf16 a[108:111], v[60:63], v[28:31], a[108:111]
    v_sub_f32 v91, v91, v9
    v_exp_f32 v91, v91
    v_mfma_f32_16x16x32_bf16 a[172:175], v[64:67], v[28:31], a[172:175]
    v_sub_f32 v84, v84, v8
    v_exp_f32 v84, v84
    v_mfma_f32_16x16x32_bf16 a[236:239], v[68:71], v[28:31], a[236:239]
    v_sub_f32 v85, v85, v8
    v_exp_f32 v85, v85
    v_mfma_f32_16x16x32_bf16 v[236:239], v[72:75], v[28:31], v[236:239]
    s_waitcnt lgkmcnt(6)
    ds_read_b64_tr_b16 v[28:29], v2 offset:3072
    v_add_f32 v50, v50, v51
    v_mfma_f32_16x16x32_bf16 a[60:63], v[56:59], v[32:35], a[60:63]
    ds_read_b64_tr_b16 v[30:31], v2 offset:11264
    v_xad_u32 v2, v2, 64, s30
    v_mfma_f32_16x16x32_bf16 a[124:127], v[60:63], v[32:35], a[124:127]
    v_sub_f32 v86, v86, v8
    v_exp_f32 v86, v86
    v_mfma_f32_16x16x32_bf16 a[188:191], v[64:67], v[32:35], a[188:191]
    v_sub_f32 v87, v87, v8
    v_exp_f32 v87, v87
    v_mfma_f32_16x16x32_bf16 a[252:255], v[68:71], v[32:35], a[252:255]
    v_sub_f32 v80, v80, v7
    v_exp_f32 v80, v80
    v_mfma_f32_16x16x32_bf16 v[252:255], v[72:75], v[32:35], v[252:255]
    s_waitcnt lgkmcnt(6)
    v_sub_f32 v81, v81, v7
    v_exp_f32 v81, v81
    v_mfma_f32_16x16x32_bf16 a[8:11], v[56:59], v[16:19], a[8:11]
    v_sub_f32 v82, v82, v7
    v_exp_f32 v82, v82
    v_mfma_f32_16x16x32_bf16 a[72:75], v[60:63], v[16:19], a[72:75]
    v_sub_f32 v83, v83, v7
    v_exp_f32 v83, v83
    v_mfma_f32_16x16x32_bf16 a[136:139], v[64:67], v[16:19], a[136:139]
    v_sub_f32 v76, v76, v6
    v_exp_f32 v76, v76
    v_mfma_f32_16x16x32_bf16 a[200:203], v[68:71], v[16:19], a[200:203]
    v_sub_f32 v77, v77, v6
    v_exp_f32 v77, v77
    v_mfma_f32_16x16x32_bf16 v[200:203], v[72:75], v[16:19], v[200:203]
    s_waitcnt vmcnt(8) lgkmcnt(0)
    s_barrier
    ds_read_b128 v[32:35], v0 offset:0
    v_mfma_f32_16x16x32_bf16 a[24:27], v[56:59], v[20:23], a[24:27]
    ds_read_b128 v[16:19], v1 offset:0
    v_add_f32 v50, v50, v5
    v_mfma_f32_16x16x32_bf16 a[88:91], v[60:63], v[20:23], a[88:91]
    v_sub_f32 v78, v78, v6
    v_exp_f32 v78, v78
    v_mfma_f32_16x16x32_bf16 a[152:155], v[64:67], v[20:23], a[152:155]
    v_sub_f32 v79, v79, v6
    v_exp_f32 v79, v79
    v_mfma_f32_16x16x32_bf16 a[216:219], v[68:71], v[20:23], a[216:219]
    v_add_f32 v5, v52, v53
    v_cvt_pk_bf16_f32 v52, v52, v53
    v_mfma_f32_16x16x32_bf16 v[216:219], v[72:75], v[20:23], v[216:219]
    ds_read_b128 v[20:23], v0 offset:1024
    v_cvt_pk_bf16_f32 v53, v54, v55
    v_mfma_f32_16x16x32_bf16 a[40:43], v[56:59], v[24:27], a[40:43]
    v_add_f32 v54, v54, v55
    v_add_f32 v54, v54, v5
    v_mfma_f32_16x16x32_bf16 a[104:107], v[60:63], v[24:27], a[104:107]
    v_add_f32 v55, v54, v92
    v_cvt_pk_bf16_f32 v54, v92, v93
    v_mfma_f32_16x16x32_bf16 a[168:171], v[64:67], v[24:27], a[168:171]
    v_add_f32 v92, v55, v93
    v_add_f32 v92, v92, v94
    v_mfma_f32_16x16x32_bf16 a[232:235], v[68:71], v[24:27], a[232:235]
    v_cvt_pk_bf16_f32 v55, v94, v95
    v_add_f32 v92, v92, v95
    v_mfma_f32_16x16x32_bf16 v[232:235], v[72:75], v[24:27], v[232:235]
    ds_read_b128 v[24:27], v0 offset:8192
    v_add_f32 v51, v50, v88
    v_mfma_f32_16x16x32_bf16 a[56:59], v[56:59], v[28:31], a[56:59]
    v_cvt_pk_bf16_f32 v50, v88, v89
    v_add_f32 v88, v51, v89
    v_mfma_f32_16x16x32_bf16 a[120:123], v[60:63], v[28:31], a[120:123]
    v_add_f32 v88, v88, v90
    v_cvt_pk_bf16_f32 v51, v90, v91
    v_mfma_f32_16x16x32_bf16 a[184:187], v[64:67], v[28:31], a[184:187]
    v_add_f32 v88, v88, v91
    v_add_f32 v47, v46, v84
    v_mfma_f32_16x16x32_bf16 a[248:251], v[68:71], v[28:31], a[248:251]
    v_cvt_pk_bf16_f32 v46, v84, v85
    v_add_f32 v84, v47, v85
    v_mfma_f32_16x16x32_bf16 v[248:251], v[72:75], v[28:31], v[248:251]
    s_waitcnt lgkmcnt(3)
    v_add_f32 v84, v84, v86
    v_cvt_pk_bf16_f32 v47, v86, v87
    s_sub_u32 s22, s22, 1
    s_cmp_lg_u32 s22, 0
    s_cbranch_scc1 L_sloop
    v_mfma_f32_16x16x32_bf16 v[56:59], v[32:35], v[96:99], 0
    s_waitcnt lgkmcnt(2)
    ds_read_b128 v[28:31], v1 offset:8192
    v_add_f32 v84, v84, v87
    v_mfma_f32_16x16x32_bf16 v[56:59], v[16:19], v[100:103], v[56:59]
    s_waitcnt lgkmcnt(2)
    v_add_f32 v43, v42, v80
    v_cvt_pk_bf16_f32 v42, v80, v81
    v_mfma_f32_16x16x32_bf16 v[56:59], v[20:23], v[104:107], v[56:59]
    v_add_f32 v80, v43, v81
    v_add_f32 v80, v80, v82
    v_mfma_f32_16x16x32_bf16 v[60:63], v[20:23], v[136:139], 0
    v_add_f32 v80, v80, v83
    v_add_f32 v39, v38, v76
    v_mfma_f32_16x16x32_bf16 v[60:63], v[16:19], v[132:135], v[60:63]
    v_cvt_pk_bf16_f32 v38, v76, v77
    v_add_f32 v76, v39, v77
    v_mfma_f32_16x16x32_bf16 v[60:63], v[32:35], v[128:131], v[60:63]
    v_add_f32 v76, v76, v78
    v_add_f32 v76, v76, v79
    v_mfma_f32_16x16x32_bf16 v[64:67], v[32:35], v[156:159], 0
    v_add_f32 v93, v92, v88
    v_add_f32 v93, v93, v84
    v_mfma_f32_16x16x32_bf16 v[64:67], v[16:19], v[160:163], v[64:67]
    v_add_f32 v93, v93, v80
    v_add_f32 v93, v93, v76
    v_mfma_f32_16x16x32_bf16 v[64:67], v[20:23], v[164:167], v[64:67]
    v_cmp_ngt_f32 vcc, s21, v93
    v_cvt_pk_bf16_f32 v43, v82, v83
    v_mfma_f32_16x16x32_bf16 v[68:71], v[20:23], v[176:179], 0
    v_cvt_pk_bf16_f32 v39, v78, v79
    v_mfma_f32_16x16x32_bf16 v[68:71], v[16:19], v[172:175], v[68:71]
    v_mfma_f32_16x16x32_bf16 v[68:71], v[32:35], v[168:171], v[68:71]
    s_cbranch_vccnz L_slowC
L_retC:
    v_mfma_f32_16x16x32_bf16 v[72:75], v[32:35], v[180:183], 0
    ds_read_b128 v[32:35], v0 offset:9216
    v_add_f32 v15, v15, v92
    v_mfma_f32_16x16x32_bf16 v[72:75], v[16:19], v[184:187], v[72:75]
    ds_read_b128 v[16:19], v1 offset:1024
    v_add_f32 v14, v14, v88
    v_mfma_f32_16x16x32_bf16 v[72:75], v[20:23], v[188:191], v[72:75]
    s_waitcnt lgkmcnt(3)
    ds_read_b128 v[20:23], v3 offset:15360
    v_add_f32 v13, v13, v84
    v_mfma_f32_16x16x32_bf16 v[92:95], v[24:27], v[180:183], 0
    s_waitcnt lgkmcnt(3)
    v_add_f32 v12, v12, v80
    v_add_f32 v11, v11, v76
    v_mfma_f32_16x16x32_bf16 v[92:95], v[28:31], v[184:187], v[92:95]
    s_waitcnt lgkmcnt(2)
    v_mbcnt_lo_u32_b32 v4, -1, 0
    v_mbcnt_hi_u32_b32 v4, -1, v4
    v_mfma_f32_16x16x32_bf16 v[92:95], v[32:35], v[188:191], v[92:95]
    s_add_u32 s62, s62, L_final-L_pc0
    v_lshlrev_b32 v4, 7, v4
    v_mfma_f32_16x16x32_bf16 v[88:91], v[32:35], v[176:179], 0
    s_addc_u32 s63, s63, 0
    v_mfma_f32_16x16x32_bf16 v[88:91], v[28:31], v[172:175], v[88:91]
    global_load_dword v4, v4, s[62:63]
    v_mfma_f32_16x16x32_bf16 v[88:91], v[24:27], v[168:171], v[88:91]
    s_sub_u32 s30, s26, s25
    s_add_u32 s23, s23, 16384
    v_mfma_f32_16x16x32_bf16 v[84:87], v[24:27], v[156:159], 0
    v_mfma_f32_16x16x32_bf16 v[84:87], v[28:31], v[160:163], v[84:87]
    v_mfma_f32_16x16x32_bf16 v[84:87], v[32:35], v[164:167], v[84:87]
    v_mfma_f32_16x16x32_bf16 v[80:83], v[32:35], v[136:139], 0
    v_mfma_f32_16x16x32_bf16 v[80:83], v[28:31], v[132:135], v[80:83]
    v_mfma_f32_16x16x32_bf16 v[80:83], v[24:27], v[128:131], v[80:83]
    v_mfma_f32_16x16x32_bf16 v[76:79], v[24:27], v[96:99], 0
    ds_read_b128 v[24:27], v3 offset:5120
    v_mfma_f32_16x16x32_bf16 v[76:79], v[28:31], v[100:103], v[76:79]
    ds_read_b128 v[28:31], v3 offset:0
    v_mfma_f32_16x16x32_bf16 v[76:79], v[32:35], v[104:107], v[76:79]
    ds_read_b128 v[32:35], v3 offset:8192
    s_waitcnt lgkmcnt(4)
    v_mfma_f32_16x16x32_bf16 v[56:59], v[16:19], v[108:111], v[56:59]
    s_waitcnt lgkmcnt(3)
    v_mfma_f32_16x16x32_bf16 v[60:63], v[16:19], v[20:23], v[60:63]
    ds_read_b128 v[20:23], v1 offset:9216
    s_waitcnt lgkmcnt(3)
    v_mfma_f32_16x16x32_bf16 v[64:67], v[16:19], v[24:27], v[64:67]
    s_waitcnt lgkmcnt(2)
    v_mfma_f32_16x16x32_bf16 v[68:71], v[16:19], v[28:31], v[68:71]
    s_waitcnt lgkmcnt(1)
    v_mfma_f32_16x16x32_bf16 v[72:75], v[16:19], v[32:35], v[72:75]
    ds_read_b128 v[16:19], v3 offset:15360
    s_waitcnt lgkmcnt(1)
    v_mfma_f32_16x16x32_bf16 v[92:95], v[20:23], v[32:35], v[92:95]
    ds_read_b128 v[32:35], v0 offset:2048
    v_mfma_f32_16x16x32_bf16 v[88:91], v[20:23], v[28:31], v[88:91]
    ds_read_b128 v[28:31], v3 offset:6144
    v_mfma_f32_16x16x32_bf16 v[84:87], v[20:23], v[24:27], v[84:87]
    ds_read_b128 v[24:27], v3 offset:1024
    s_waitcnt lgkmcnt(3)
    v_mfma_f32_16x16x32_bf16 v[80:83], v[20:23], v[16:19], v[80:83]
    ds_read_b128 v[16:19], v3 offset:9216
    v_mfma_f32_16x16x32_bf16 v[76:79], v[20:23], v[108:111], v[76:79]
    ds_read_b128 v[20:23], v0 offset:10240
    s_waitcnt lgkmcnt(4)
    v_mfma_f32_16x16x32_bf16 v[56:59], v[32:35], v[112:115], v[56:59]
    v_mfma_f32_16x16x32_bf16 v[60:63], v[32:35], v[140:143], v[60:63]
    s_waitcnt lgkmcnt(3)
    v_mfma_f32_16x16x32_bf16 v[64:67], v[32:35], v[28:31], v[64:67]
    s_waitcnt lgkmcnt(2)
    v_mfma_f32_16x16x32_bf16 v[68:71], v[32:35], v[24:27], v[68:71]
    s_waitcnt lgkmcnt(1)
    v_mfma_f32_16x16x32_bf16 v[72:75], v[32:35], v[16:19], v[72:75]
    ds_read_b128 v[32:35], v1 offset:2048
    s_waitcnt lgkmcnt(1)
    v_mfma_f32_16x16x32_bf16 v[92:95], v[20:23], v[16:19], v[92:95]
    ds_read_b128 v[16:19], v3 offset:7168
    v_mfma_f32_16x16x32_bf16 v[88:91], v[20:23], v[24:27], v[88:91]
    ds_read_b128 v[24:27], v3 offset:2048
    v_mfma_f32_16x16x32_bf16 v[84:87], v[20:23], v[28:31], v[84:87]
    ds_read_b128 v[28:31], v3 offset:10240
    v_mfma_f32_16x16x32_bf16 v[80:83], v[20:23], v[140:143], v[80:83]
    v_mfma_f32_16x16x32_bf16 v[76:79], v[20:23], v[112:115], v[76:79]
    ds_read_b128 v[20:23], v1 offset:10240
    s_waitcnt lgkmcnt(4)
    v_mfma_f32_16x16x32_bf16 v[56:59], v[32:35], v[116:119], v[56:59]
    s_waitcnt vmcnt(0) lgkmcnt(0)
    s_barrier
    v_mfma_f32_16x16x32_bf16 v[60:63], v[32:35], v[144:147], v[60:63]
    v_mfma_f32_16x16x32_bf16 v[64:67], v[32:35], v[16:19], v[64:67]
    v_mfma_f32_16x16x32_bf16 v[68:71], v[32:35], v[24:27], v[68:71]
    v_mfma_f32_16x16x32_bf16 v[72:75], v[32:35], v[28:31], v[72:75]
    ds_read_b128 v[32:35], v0 offset:3072
    v_mfma_f32_16x16x32_bf16 v[92:95], v[20:23], v[28:31], v[92:95]
    ds_read_b128 v[28:31], v3 offset:13312
    v_mfma_f32_16x16x32_bf16 v[88:91], v[20:23], v[24:27], v[88:91]
    ds_read_b128 v[24:27], v3 offset:3072
    v_mfma_f32_16x16x32_bf16 v[84:87], v[20:23], v[16:19], v[84:87]
    ds_read_b128 v[16:19], v3 offset:11264
    v_mfma_f32_16x16x32_bf16 v[80:83], v[20:23], v[144:147], v[80:83]
    v_mfma_f32_16x16x32_bf16 v[76:79], v[20:23], v[116:119], v[76:79]
    ds_read_b128 v[20:23], v0 offset:11264
    s_waitcnt lgkmcnt(4)
    v_mfma_f32_16x16x32_bf16 v[56:59], v[32:35], v[120:123], v[56:59]
    v_mfma_f32_16x16x32_bf16 v[60:63], v[32:35], v[148:151], v[60:63]
    s_waitcnt lgkmcnt(3)
    v_mfma_f32_16x16x32_bf16 v[64:67], v[32:35], v[28:31], v[64:67]
    s_waitcnt lgkmcnt(2)
    v_mfma_f32_16x16x32_bf16 v[68:71], v[32:35], v[24:27], v[68:71]
    s_waitcnt lgkmcnt(1)
    v_mfma_f32_16x16x32_bf16 v[72:75], v[32:35], v[16:19], v[72:75]
    ds_read_b128 v[32:35], v1 offset:3072
    s_waitcnt lgkmcnt(1)
    v_mfma_f32_16x16x32_bf16 v[92:95], v[20:23], v[16:19], v[92:95]
    ds_read_b128 v[16:19], v3 offset:14336
    v_mfma_f32_16x16x32_bf16 v[88:91], v[20:23], v[24:27], v[88:91]
    ds_read_b128 v[24:27], v3 offset:4096
    v_mfma_f32_16x16x32_bf16 v[84:87], v[20:23], v[28:31], v[84:87]
    ds_read_b128 v[28:31], v3 offset:12288
    v_mfma_f32_16x16x32_bf16 v[80:83], v[20:23], v[148:151], v[80:83]
    v_mfma_f32_16x16x32_bf16 v[76:79], v[20:23], v[120:123], v[76:79]
    ds_read_b128 v[20:23], v1 offset:11264
    s_waitcnt lgkmcnt(4)
    v_mfma_f32_16x16x32_bf16 v[56:59], v[32:35], v[124:127], v[56:59]
    v_mfma_f32_16x16x32_bf16 v[60:63], v[32:35], v[152:155], v[60:63]
    s_waitcnt lgkmcnt(3)
    v_mfma_f32_16x16x32_bf16 v[64:67], v[32:35], v[16:19], v[64:67]
    s_waitcnt lgkmcnt(2)
    v_mfma_f32_16x16x32_bf16 v[68:71], v[32:35], v[24:27], v[68:71]
    s_waitcnt lgkmcnt(1)
    v_mfma_f32_16x16x32_bf16 v[72:75], v[32:35], v[28:31], v[72:75]
    ds_read_b64_tr_b16 v[32:33], v2 offset:0
    s_waitcnt lgkmcnt(1)
    v_mfma_f32_16x16x32_bf16 v[92:95], v[20:23], v[28:31], v[92:95]
    ds_read_b64_tr_b16 v[34:35], v2 offset:8192
    v_mfma_f32_16x16x32_bf16 v[88:91], v[20:23], v[24:27], v[88:91]
    ds_read_b64_tr_b16 v[28:29], v2 offset:1024
    v_mfma_f32_16x16x32_bf16 v[84:87], v[20:23], v[16:19], v[84:87]
    ds_read_b64_tr_b16 v[30:31], v2 offset:9216
    v_mfma_f32_16x16x32_bf16 v[80:83], v[20:23], v[152:155], v[80:83]
    ds_read_b64_tr_b16 v[24:25], v2 offset:2048
    v_mfma_f32_16x16x32_bf16 v[76:79], v[20:23], v[124:127], v[76:79]
    ds_read_b64_tr_b16 v[26:27], v2 offset:10240
    s_waitcnt lgkmcnt(4)
    v_mfma_f32_16x16x32_bf16 a[0:3], v[36:39], v[32:35], a[0:3]
    ds_read_b64_tr_b16 v[16:17], v2 offset:3072
    v_mfma_f32_16x16x32_bf16 a[64:67], v[40:43], v[32:35], a[64:67]
    ds_read_b64_tr_b16 v[18:19], v2 offset:11264
    v_xor_b32 v2, 32, v2
    v_mfma_f32_16x16x32_bf16 a[128:131], v[44:47], v[32:35], a[128:131]
    ds_read_b64_tr_b16 v[20:21], v2 offset:0
    v_mfma_f32_16x16x32_bf16 a[192:195], v[48:51], v[32:35], a[192:195]
    ds_read_b64_tr_b16 v[22:23], v2 offset:8192
    v_mfma_f32_16x16x32_bf16 v[192:195], v[52:55], v[32:35], v[192:195]
    ds_read_b64_tr_b16 v[32:33], v2 offset:1024
    s_waitcnt lgkmcnt(7)
    v_mfma_f32_16x16x32_bf16 a[16:19], v[36:39], v[28:31], a[16:19]
    ds_read_b64_tr_b16 v[34:35], v2 offset:9216
    v_mfma_f32_16x16x32_bf16 a[80:83], v[40:43], v[28:31], a[80:83]
    v_sub_f32 v56, v56, v6
    v_exp_f32 v56, v56
    v_mfma_f32_16x16x32_bf16 a[144:147], v[44:47], v[28:31], a[144:147]
    v_sub_f32 v57, v57, v6
    v_exp_f32 v57, v57
    v_mfma_f32_16x16x32_bf16 a[208:211], v[48:51], v[28:31], a[208:211]
    v_sub_f32 v58, v58, v6
    v_exp_f32 v58, v58
    v_mfma_f32_16x16x32_bf16 v[208:211], v[52:55], v[28:31], v[208:211]
    s_waitcnt lgkmcnt(6)
    ds_read_b64_tr_b16 v[28:29], v2 offset:2048
    v_add_f32 v5, v56, v57
    v_mfma_f32_16x16x32_bf16 a[32:35], v[36:39], v[24:27], a[32:35]
    ds_read_b64_tr_b16 v[30:31], v2 offset:10240
    v_cvt_pk_bf16_f32 v56, v56, v57
    v_mfma_f32_16x16x32_bf16 a[96:99], v[40:43], v[24:27], a[96:99]
    v_sub_f32 v59, v59, v6
    v_exp_f32 v59, v59
    v_mfma_f32_16x16x32_bf16 a[160:163], v[44:47], v[24:27], a[160:163]
    v_sub_f32 v60, v60, v7
    v_exp_f32 v60, v60
    v_mfma_f32_16x16x32_bf16 a[224:227], v[48:51], v[24:27], a[224:227]
    v_sub_f32 v61, v61, v7
    v_exp_f32 v61, v61
    v_mfma_f32_16x16x32_bf16 v[224:227], v[52:55], v[24:27], v[224:227]
    s_waitcnt lgkmcnt(6)
    ds_read_b64_tr_b16 v[24:25], v2 offset:3072
    v_cvt_pk_bf16_f32 v57, v58, v59
    v_mfma_f32_16x16x32_bf16 a[48:51], v[36:39], v[16:19], a[48:51]
    ds_read_b64_tr_b16 v[26:27], v2 offset:11264
    v_xor_b32 v2, 64, v2
    v_mfma_f32_16x16x32_bf16 a[112:115], v[40:43], v[16:19], a[112:115]
    v_sub_f32 v62, v62, v7
    v_exp_f32 v62, v62
    v_mfma_f32_16x16x32_bf16 a[176:179], v[44:47], v[16:19], a[176:179]
    v_sub_f32 v63, v63, v7
    v_exp_f32 v63, v63
    v_mfma_f32_16x16x32_bf16 a[240:243], v[48:51], v[16:19], a[240:243]
    v_sub_f32 v64, v64, v8
    v_exp_f32 v64, v64
    v_mfma_f32_16x16x32_bf16 v[240:243], v[52:55], v[16:19], v[240:243]
    s_waitcnt lgkmcnt(6)
    ds_read_b64_tr_b16 v[16:17], v2 offset:0
    v_add_f32 v58, v58, v59
    v_mfma_f32_16x16x32_bf16 a[4:7], v[36:39], v[20:23], a[4:7]
    ds_read_b64_tr_b16 v[18:19], v2 offset:8192
    v_add_f32 v58, v58, v5
    v_mfma_f32_16x16x32_bf16 a[68:71], v[40:43], v[20:23], a[68:71]
    v_sub_f32 v65, v65, v8
    v_exp_f32 v65, v65
    v_mfma_f32_16x16x32_bf16 a[132:135], v[44:47], v[20:23], a[132:135]
    v_sub_f32 v66, v66, v8
    v_exp_f32 v66, v66
    v_mfma_f32_16x16x32_bf16 a[196:199], v[48:51], v[20:23], a[196:199]
    v_sub_f32 v67, v67, v8
    v_exp_f32 v67, v67
    v_mfma_f32_16x16x32_bf16 v[196:199], v[52:55], v[20:23], v[196:199]
    s_waitcnt lgkmcnt(6)
    ds_read_b64_tr_b16 v[20:21], v2 offset:1024
    v_add_f32 v5, v60, v61
    v_mfma_f32_16x16x32_bf16 a[20:23], v[36:39], v[32:35], a[20:23]
    ds_read_b64_tr_b16 v[22:23], v2 offset:9216
    v_cvt_pk_bf16_f32 v60, v60, v61
    v_mfma_f32_16x16x32_bf16 a[84:87], v[40:43], v[32:35], a[84:87]
    v_sub_f32 v68, v68, v9
    v_exp_f32 v68, v68
    v_mfma_f32_16x16x32_bf16 a[148:151], v[44:47], v[32:35], a[148:151]
    v_sub_f32 v69, v69, v9
    v_exp_f32 v69, v69
    v_mfma_f32_16x16x32_bf16 a[212:215], v[48:51], v[32:35], a[212:215]
    v_sub_f32 v70, v70, v9
    v_exp_f32 v70, v70
    v_mfma_f32_16x16x32_bf16 v[212:215], v[52:55], v[32:35], v[212:215]
    s_waitcnt lgkmcnt(6)
    ds_read_b64_tr_b16 v[32:33], v2 offset:2048
    v_cvt_pk_bf16_f32 v61, v62, v63
    v_mfma_f32_16x16x32_bf16 a[36:39], v[36:39], v[28:31], a[36:39]
    ds_read_b64_tr_b16 v[34:35], v2 offset:10240
    v_add_f32 v62, v62, v63
    v_mfma_f32_16x16x32_bf16 a[100:103], v[40:43], v[28:31], a[100:103]
    v_sub_f32 v71, v71, v9
    v_exp_f32 v71, v71
    v_mfma_f32_16x16x32_bf16 a[164:167], v[44:47], v[28:31], a[164:167]
    v_sub_f32 v72, v72, v10
    v_exp_f32 v72, v72
    v_mfma_f32_16x16x32_bf16 a[228:231], v[48:51], v[28:31], a[228:231]
    v_sub_f32 v73, v73, v10
    v_exp_f32 v73, v73
    v_mfma_f32_16x16x32_bf16 v[228:231], v[52:55], v[28:31], v[228:231]
    s_waitcnt lgkmcnt(6)
    ds_read_b64_tr_b16 v[28:29], v2 offset:3072
    v_add_f32 v62, v62, v5
    v_mfma_f32_16x16x32_bf16 a[52:55], v[36:39], v[24:27], a[52:55]
    ds_read_b64_tr_b16 v[30:31], v2 offset:11264
    v_xor_b32 v2, 32, v2
    v_mfma_f32_16x16x32_bf16 a[116:119], v[40:43], v[24:27], a[116:119]
    v_sub_f32 v74, v74, v10
    v_exp_f32 v74, v74
    v_mfma_f32_16x16x32_bf16 a[180:183], v[44:47], v[24:27], a[180:183]
    v_sub_f32 v75, v75, v10
    v_exp_f32 v75, v75
    v_mfma_f32_16x16x32_bf16 a[244:247], v[48:51], v[24:27], a[244:247]
    v_sub_f32 v92, v92, v10
    v_exp_f32 v92, v92
    v_mfma_f32_16x16x32_bf16 v[244:247], v[52:55], v[24:27], v[244:247]
    s_waitcnt lgkmcnt(6)
    ds_read_b64_tr_b16 v[24:25], v2 offset:0
    v_add_f32 v5, v64, v65
    v_mfma_f32_16x16x32_bf16 a[12:15], v[36:39], v[16:19], a[12:15]
    ds_read_b64_tr_b16 v[26:27], v2 offset:8192
    v_cvt_pk_bf16_f32 v64, v64, v65
    v_mfma_f32_16x16x32_bf16 a[76:79], v[40:43], v[16:19], a[76:79]
    v_sub_f32 v93, v93, v10
    v_exp_f32 v93, v93
    v_mfma_f32_16x16x32_bf16 a[140:143], v[44:47], v[16:19], a[140:143]
    v_sub_f32 v94, v94, v10
    v_exp_f32 v94, v94
    v_mfma_f32_16x16x32_bf16 a[204:207], v[48:51], v[16:19], a[204:207]
    v_sub_f32 v95, v95, v10
    v_exp_f32 v95, v95
    v_mfma_f32_16x16x32_bf16 v[204:207], v[52:55], v[16:19], v[204:207]
    s_waitcnt lgkmcnt(6)
    ds_read_b64_tr_b16 v[16:17], v2 offset:1024
    v_cvt_pk_bf16_f32 v65, v66, v67
    v_mfma_f32_16x16x32_bf16 a[28:31], v[36:39], v[20:23], a[28:31]
    ds_read_b64_tr_b16 v[18:19], v2 offset:9216
    v_add_f32 v66, v66, v67
    v_mfma_f32_16x16x32_bf16 a[92:95], v[40:43], v[20:23], a[92:95]
    v_sub_f32 v88, v88, v9
    v_exp_f32 v88, v88
    v_mfma_f32_16x16x32_bf16 a[156:159], v[44:47], v[20:23], a[156:159]
    v_sub_f32 v89, v89, v9
    v_exp_f32 v89, v89
    v_mfma_f32_16x16x32_bf16 a[220:223], v[48:51], v[20:23], a[220:223]
    v_sub_f32 v90, v90, v9
    v_exp_f32 v90, v90
    v_mfma_f32_16x16x32_bf16 v[220:223], v[52:55], v[20:23], v[220:223]
    s_waitcnt lgkmcnt(6)
    ds_read_b64_tr_b16 v[20:21], v2 offset:2048
    v_add_f32 v66, v66, v5
    v_mfma_f32_16x16x32_bf16 a[44:47], v[36:39], v[32:35], a[44:47]
    ds_read_b64_tr_b16 v[22:23], v2 offset:10240
    v_add_f32 v5, v68, v69
    v_mfma_f32_16x16x32_bf16 a[108:111], v[40:43], v[32:35], a[108:111]
    v_sub_f32 v91, v91, v9
    v_exp_f32 v91, v91
    v_mfma_f32_16x16x32_bf16 a[172:175], v[44:47], v[32:35], a[172:175]
    v_sub_f32 v84, v84, v8
    v_exp_f32 v84, v84
    v_mfma_f32_16x16x32_bf16 a[236:239], v[48:51], v[32:35], a[236:239]
    v_sub_f32 v85, v85, v8
    v_exp_f32 v85, v85
    v_mfma_f32_16x16x32_bf16 v[236:239], v[52:55], v[32:35], v[236:239]
    s_waitcnt lgkmcnt(6)
    ds_read_b64_tr_b16 v[32:33], v2 offset:3072
    v_cvt_pk_bf16_f32 v68, v68, v69
    v_mfma_f32_16x16x32_bf16 a[60:63], v[36:39], v[28:31], a[60:63]
    ds_read_b64_tr_b16 v[34:35], v2 offset:11264
    v_xad_u32 v2, v2, 64, s30
    v_mfma_f32_16x16x32_bf16 a[124:127], v[40:43], v[28:31], a[124:127]
    v_sub_f32 v86, v86, v8
    v_exp_f32 v86, v86
    v_mfma_f32_16x16x32_bf16 a[188:191], v[44:47], v[28:31], a[188:191]
    v_sub_f32 v87, v87, v8
    v_exp_f32 v87, v87
    v_mfma_f32_16x16x32_bf16 a[252:255], v[48:51], v[28:31], a[252:255]
    v_sub_f32 v80, v80, v7
    v_exp_f32 v80, v80
    v_mfma_f32_16x16x32_bf16 v[252:255], v[52:55], v[28:31], v[252:255]
    s_waitcnt lgkmcnt(6)
    ds_read_b64_tr_b16 v[28:29], v2 offset:0
    v_cvt_pk_bf16_f32 v69, v70, v71
    v_mfma_f32_16x16x32_bf16 a[8:11], v[36:39], v[24:27], a[8:11]
    ds_read_b64_tr_b16 v[30:31], v2 offset:8192
    v_xor_b32 v2, 32, v2
    v_mfma_f32_16x16x32_bf16 a[72:75], v[40:43], v[24:27], a[72:75]
    v_sub_f32 v81, v81, v7
    v_exp_f32 v81, v81
    v_mfma_f32_16x16x32_bf16 a[136:139], v[44:47], v[24:27], a[136:139]
    v_sub_f32 v82, v82, v7
    v_exp_f32 v82, v82
    v_mfma_f32_16x16x32_bf16 a[200:203], v[48:51], v[24:27], a[200:203]
    v_sub_f32 v83, v83, v7
    v_exp_f32 v83, v83
    v_mfma_f32_16x16x32_bf16 v[200:203], v[52:55], v[24:27], v[200:203]
    s_waitcnt lgkmcnt(6)
    ds_read_b64_tr_b16 v[24:25], v2 offset:0
    v_add_f32 v70, v70, v71
    v_mfma_f32_16x16x32_bf16 a[24:27], v[36:39], v[16:19], a[24:27]
    ds_read_b64_tr_b16 v[26:27], v2 offset:8192
    v_xor_b32 v2, 64, v2
    v_mfma_f32_16x16x32_bf16 a[88:91], v[40:43], v[16:19], a[88:91]
    v_sub_f32 v76, v76, v6
    v_exp_f32 v76, v76
    v_mfma_f32_16x16x32_bf16 a[152:155], v[44:47], v[16:19], a[152:155]
    v_sub_f32 v77, v77, v6
    v_exp_f32 v77, v77
    v_mfma_f32_16x16x32_bf16 a[216:219], v[48:51], v[16:19], a[216:219]
    v_sub_f32 v78, v78, v6
    v_exp_f32 v78, v78
    v_mfma_f32_16x16x32_bf16 v[216:219], v[52:55], v[16:19], v[216:219]
    s_waitcnt lgkmcnt(6)
    ds_read_b64_tr_b16 v[16:17], v2 offset:0
    v_add_f32 v70, v70, v5
    v_mfma_f32_16x16x32_bf16 a[40:43], v[36:39], v[20:23], a[40:43]
    ds_read_b64_tr_b16 v[18:19], v2 offset:8192
    v_xor_b32 v2, 32, v2
    v_mfma_f32_16x16x32_bf16 a[104:107], v[40:43], v[20:23], a[104:107]
    v_sub_f32 v79, v79, v6
    v_exp_f32 v79, v79
    v_mfma_f32_16x16x32_bf16 a[168:171], v[44:47], v[20:23], a[168:171]
    v_add_f32 v5, v72, v73
    v_cvt_pk_bf16_f32 v72, v72, v73
    v_mfma_f32_16x16x32_bf16 a[232:235], v[48:51], v[20:23], a[232:235]
    v_cvt_pk_bf16_f32 v73, v74, v75
    v_add_f32 v74, v74, v75
    v_mfma_f32_16x16x32_bf16 v[232:235], v[52:55], v[20:23], v[232:235]
    s_waitcnt lgkmcnt(6)
    ds_read_b64_tr_b16 v[20:21], v2 offset:0
    v_add_f32 v74, v74, v5
    v_mfma_f32_16x16x32_bf16 a[56:59], v[36:39], v[32:35], a[56:59]
    ds_read_b64_tr_b16 v[22:23], v2 offset:8192
    v_add_f32 v75, v74, v92
    v_mfma_f32_16x16x32_bf16 a[120:123], v[40:43], v[32:35], a[120:123]
    v_cvt_pk_bf16_f32 v74, v92, v93
    v_add_f32 v92, v75, v93
    v_mfma_f32_16x16x32_bf16 a[184:187], v[44:47], v[32:35], a[184:187]
    v_add_f32 v92, v92, v94
    v_cvt_pk_bf16_f32 v75, v94, v95
    v_mfma_f32_16x16x32_bf16 a[248:251], v[48:51], v[32:35], a[248:251]
    v_add_f32 v92, v92, v95
    v_add_f32 v71, v70, v88
    v_mfma_f32_16x16x32_bf16 v[248:251], v[52:55], v[32:35], v[248:251]
    s_waitcnt lgkmcnt(6)
    v_cvt_pk_bf16_f32 v70, v88, v89
    s_nop 0
    v_add_f32 v88, v71, v89
    v_add_f32 v88, v88, v90
    v_cvt_pk_bf16_f32 v71, v90, v91
    v_add_f32 v88, v88, v91
    v_add_f32 v67, v66, v84
    v_cvt_pk_bf16_f32 v66, v84, v85
    v_add_f32 v84, v67, v85
    v_add_f32 v84, v84, v86
    v_cvt_pk_bf16_f32 v67, v86, v87
    v_add_f32 v84, v84, v87
    v_add_f32 v63, v62, v80
    v_cvt_pk_bf16_f32 v62, v80, v81
    v_add_f32 v80, v63, v81
    v_add_f32 v80, v80, v82
    v_cvt_pk_bf16_f32 v63, v82, v83
    v_add_f32 v80, v80, v83
    v_add_f32 v59, v58, v76
    v_cvt_pk_bf16_f32 v58, v76, v77
    v_add_f32 v76, v59, v77
    v_add_f32 v76, v76, v78
    v_cvt_pk_bf16_f32 v59, v78, v79
    v_add_f32 v76, v76, v79
    v_add_f32 v93, v92, v88
    v_add_f32 v93, v93, v84
    v_add_f32 v93, v93, v80
    v_add_f32 v93, v93, v76
    v_cmp_ngt_f32 vcc, s21, v93
    s_nop 3
    s_cbranch_vccnz L_slowF
L_retF:
    s_branch L_final
L_convA:
    s_nop 7
    s_nop 7
    v_sub_f32 v56, v56, v6
    v_sub_f32 v57, v57, v6
    v_sub_f32 v58, v58, v6
    v_sub_f32 v59, v59, v6
    v_sub_f32 v60, v60, v6
    v_sub_f32 v61, v61, v6
    v_sub_f32 v62, v62, v6
    v_sub_f32 v63, v63, v6
    v_sub_f32 v64, v64, v6
    v_sub_f32 v65, v65, v6
    v_sub_f32 v66, v66, v6
    v_sub_f32 v67, v67, v6
    v_sub_f32 v68, v68, v6
    v_sub_f32 v69, v69, v6
    v_sub_f32 v70, v70, v6
    v_sub_f32 v71, v71, v6
    v_sub_f32 v5, 0, v6
    s_cmp_eq_u64 s[50:51], 0
    s_cbranch_scc1 L_cvA
    v_mov_b32 v5, 0xf149f2ca
L_cvA:
    v_mov_b32 v6, v5
    v_mov_b32 v7, v5
    v_mov_b32 v8, v5
    v_mov_b32 v9, v5
    v_mov_b32 v10, v5
    s_branch L_slowA
L_convB:
    s_nop 7
    s_nop 7
    v_sub_f32 v36, v36, v6
    v_sub_f32 v37, v37, v6
    v_sub_f32 v38, v38, v6
    v_sub_f32 v39, v39, v6
    v_sub_f32 v40, v40, v6
    v_sub_f32 v41, v41, v6
    v_sub_f32 v42, v42, v6
    v_sub_f32 v43, v43, v6
    v_sub_f32 v44, v44, v6
    v_sub_f32 v45, v45, v6
    v_sub_f32 v46, v46, v6
    v_sub_f32 v47, v47, v6
    v_sub_f32 v48, v48, v6
    v_sub_f32 v49, v49, v6
    v_sub_f32 v50, v50, v6
    v_sub_f32 v51, v51, v6
    v_sub_f32 v5, 0, v6
    s_cmp_eq_u64 s[50:51], 0
    s_cbranch_scc1 L_cvB
    v_mov_b32 v5, 0xf149f2ca
L_cvB:
    v_mov_b32 v6, v5
    v_mov_b32 v7, v5
    v_mov_b32 v8, v5
    v_mov_b32 v9, v5
    v_mov_b32 v10, v5
    s_branch L_slowB
L_convC:
    s_nop 7
    s_nop 7
    v_sub_f32 v56, v56, v6
    v_sub_f32 v57, v57, v6
    v_sub_f32 v58, v58, v6
    v_sub_f32 v59, v59, v6
    v_sub_f32 v60, v60, v6
    v_sub_f32 v61, v61, v6
    v_sub_f32 v62, v62, v6
    v_sub_f32 v63, v63, v6
    v_sub_f32 v64, v64, v6
    v_sub_f32 v65, v65, v6
    v_sub_f32 v66, v66, v6
    v_sub_f32 v67, v67, v6
    v_sub_f32 v68, v68, v6
    v_sub_f32 v69, v69, v6
    v_sub_f32 v70, v70, v6
    v_sub_f32 v71, v71, v6
    v_sub_f32 v5, 0, v6
    s_cmp_eq_u64 s[50:51], 0
    s_cbranch_scc1 L_cvC
    v_mov_b32 v5, 0xf149f2ca
L_cvC:
    v_mov_b32 v6, v5
    v_mov_b32 v7, v5
    v_mov_b32 v8, v5
    v_mov_b32 v9, v5
    v_mov_b32 v10, v5
    s_branch L_slowC
L_convF:
    s_nop 7
    s_nop 7
    v_sub_f32 v5, 0, v6
    s_cmp_eq_u64 s[50:51], 0
    s_cbranch_scc1 L_cvF
    v_mov_b32 v5, 0xf149f2ca
L_cvF:
    v_mov_b32 v6, v5
    v_mov_b32 v7, v5
    v_mov_b32 v8, v5
    v_mov_b32 v9, v5
    v_mov_b32 v10, v5
    s_branch L_slowF
L_slowA:
    s_waitcnt vmcnt(0) lgkmcnt(0)
    s_nop 7
    v_mbcnt_lo_u32_b32 v32, -1, 0
    v_mbcnt_hi_u32_b32 v32, -1, v32
    v_and_b32 v33, 15, v32
    v_lshrrev_b32 v32, 4, v32
    v_lshlrev_b32 v35, 4, v32
    v_lshl_add_u32 v32, v33, 9, v35
    s_sub_u32 s33, s23, 49152
    buffer_load_dwordx4 v[16:19], v32, s[8:11], s33 offen offset:0
    s_waitcnt vmcnt(0)
    v_mfma_f32_16x16x32_bf16 v[36:39], v[16:19], v[96:99], 0
    v_mfma_f32_16x16x32_bf16 v[40:43], v[16:19], v[128:131], 0
    v_mfma_f32_16x16x32_bf16 v[44:47], v[16:19], v[156:159], 0
    v_mfma_f32_16x16x32_bf16 v[48:51], v[16:19], v[168:171], 0
    v_mfma_f32_16x16x32_bf16 v[52:55], v[16:19], v[180:183], 0
    s_nop 7
    buffer_load_dwordx4 v[16:19], v32, s[8:11], s33 offen offset:64
    s_waitcnt vmcnt(0)
    v_mfma_f32_16x16x32_bf16 v[36:39], v[16:19], v[100:103], v[36:39]
    v_mfma_f32_16x16x32_bf16 v[40:43], v[16:19], v[132:135], v[40:43]
    v_mfma_f32_16x16x32_bf16 v[44:47], v[16:19], v[160:163], v[44:47]
    v_mfma_f32_16x16x32_bf16 v[48:51], v[16:19], v[172:175], v[48:51]
    v_mfma_f32_16x16x32_bf16 v[52:55], v[16:19], v[184:187], v[52:55]
    s_nop 7
    buffer_load_dwordx4 v[16:19], v32, s[8:11], s33 offen offset:128
    s_waitcnt vmcnt(0)
    v_mfma_f32_16x16x32_bf16 v[36:39], v[16:19], v[104:107], v[36:39]
    v_mfma_f32_16x16x32_bf16 v[40:43], v[16:19], v[136:139], v[40:43]
    v_mfma_f32_16x16x32_bf16 v[44:47], v[16:19], v[164:167], v[44:47]
    v_mfma_f32_16x16x32_bf16 v[48:51], v[16:19], v[176:179], v[48:51]
    v_mfma_f32_16x16x32_bf16 v[52:55], v[16:19], v[188:191], v[52:55]
    s_nop 7
    buffer_load_dwordx4 v[16:19], v32, s[8:11], s33 offen offset:192
    s_waitcnt vmcnt(0)
    v_mfma_f32_16x16x32_bf16 v[36:39], v[16:19], v[108:111], v[36:39]
    ds_read_b128 v[24:27], v3 offset:15360
    s_waitcnt lgkmcnt(0)
    v_mfma_f32_16x16x32_bf16 v[40:43], v[16:19], v[24:27], v[40:43]
    ds_read_b128 v[28:31], v3 offset:5120
    s_waitcnt lgkmcnt(0)
    v_mfma_f32_16x16x32_bf16 v[44:47], v[16:19], v[28:31], v[44:47]
    ds_read_b128 v[20:23], v3 offset:0
    s_waitcnt lgkmcnt(0)
    v_mfma_f32_16x16x32_bf16 v[48:51], v[16:19], v[20:23], v[48:51]
    ds_read_b128 v[24:27], v3 offset:8192
    s_waitcnt lgkmcnt(0)
    v_mfma_f32_16x16x32_bf16 v[52:55], v[16:19], v[24:27], v[52:55]
    s_nop 7
    buffer_load_dwordx4 v[16:19], v32, s[8:11], s33 offen offset:256
    s_waitcnt vmcnt(0)
    v_mfma_f32_16x16x32_bf16 v[36:39], v[16:19], v[112:115], v[36:39]
    v_mfma_f32_16x16x32_bf16 v[40:43], v[16:19], v[140:143], v[40:43]
    ds_read_b128 v[28:31], v3 offset:6144
    s_waitcnt lgkmcnt(0)
    v_mfma_f32_16x16x32_bf16 v[44:47], v[16:19], v[28:31], v[44:47]
    ds_read_b128 v[20:23], v3 offset:1024
    s_waitcnt lgkmcnt(0)
    v_mfma_f32_16x16x32_bf16 v[48:51], v[16:19], v[20:23], v[48:51]
    ds_read_b128 v[24:27], v3 offset:9216
    s_waitcnt lgkmcnt(0)
    v_mfma_f32_16x16x32_bf16 v[52:55], v[16:19], v[24:27], v[52:55]
    s_nop 7
    buffer_load_dwordx4 v[16:19], v32, s[8:11], s33 offen offset:320
    s_waitcnt vmcnt(0)
    v_mfma_f32_16x16x32_bf16 v[36:39], v[16:19], v[116:119], v[36:39]
    v_mfma_f32_16x16x32_bf16 v[40:43], v[16:19], v[144:147], v[40:43]
    ds_read_b128 v[28:31], v3 offset:7168
    s_waitcnt lgkmcnt(0)
    v_mfma_f32_16x16x32_bf16 v[44:47], v[16:19], v[28:31], v[44:47]
    ds_read_b128 v[20:23], v3 offset:2048
    s_waitcnt lgkmcnt(0)
    v_mfma_f32_16x16x32_bf16 v[48:51], v[16:19], v[20:23], v[48:51]
    ds_read_b128 v[24:27], v3 offset:10240
    s_waitcnt lgkmcnt(0)
    v_mfma_f32_16x16x32_bf16 v[52:55], v[16:19], v[24:27], v[52:55]
    s_nop 7
    buffer_load_dwordx4 v[16:19], v32, s[8:11], s33 offen offset:384
    s_waitcnt vmcnt(0)
    v_mfma_f32_16x16x32_bf16 v[36:39], v[16:19], v[120:123], v[36:39]
    v_mfma_f32_16x16x32_bf16 v[40:43], v[16:19], v[148:151], v[40:43]
    ds_read_b128 v[28:31], v3 offset:13312
    s_waitcnt lgkmcnt(0)
    v_mfma_f32_16x16x32_bf16 v[44:47], v[16:19], v[28:31], v[44:47]
    ds_read_b128 v[20:23], v3 offset:3072
    s_waitcnt lgkmcnt(0)
    v_mfma_f32_16x16x32_bf16 v[48:51], v[16:19], v[20:23], v[48:51]
    ds_read_b128 v[24:27], v3 offset:11264
    s_waitcnt lgkmcnt(0)
    v_mfma_f32_16x16x32_bf16 v[52:55], v[16:19], v[24:27], v[52:55]
    s_nop 7
    buffer_load_dwordx4 v[16:19], v32, s[8:11], s33 offen offset:448
    s_waitcnt vmcnt(0)
    v_mfma_f32_16x16x32_bf16 v[36:39], v[16:19], v[124:127], v[36:39]
    v_mfma_f32_16x16x32_bf16 v[40:43], v[16:19], v[152:155], v[40:43]
    ds_read_b128 v[28:31], v3 offset:14336
    s_waitcnt lgkmcnt(0)
    v_mfma_f32_16x16x32_bf16 v[44:47], v[16:19], v[28:31], v[44:47]
    ds_read_b128 v[20:23], v3 offset:4096
    s_waitcnt lgkmcnt(0)
    v_mfma_f32_16x16x32_bf16 v[48:51], v[16:19], v[20:23], v[48:51]
    ds_read_b128 v[24:27], v3 offset:12288
    s_waitcnt lgkmcnt(0)
    v_mfma_f32_16x16x32_bf16 v[52:55], v[16:19], v[24:27], v[52:55]
    s_nop 7
    s_sub_u32 s33, s23, 40960
    buffer_load_dwordx4 v[16:19], v32, s[8:11], s33 offen offset:0
    s_waitcnt vmcnt(0)
    v_mfma_f32_16x16x32_bf16 v[76:79], v[16:19], v[96:99], 0
    v_mfma_f32_16x16x32_bf16 v[80:83], v[16:19], v[128:131], 0
    v_mfma_f32_16x16x32_bf16 v[84:87], v[16:19], v[156:159], 0
    v_mfma_f32_16x16x32_bf16 v[88:91], v[16:19], v[168:171], 0
    v_mfma_f32_16x16x32_bf16 v[92:95], v[16:19], v[180:183], 0
    s_nop 7
    buffer_load_dwordx4 v[16:19], v32, s[8:11], s33 offen offset:64
    s_waitcnt vmcnt(0)
    v_mfma_f32_16x16x32_bf16 v[76:79], v[16:19], v[100:103], v[76:79]
    v_mfma_f32_16x16x32_bf16 v[80:83], v[16:19], v[132:135], v[80:83]
    v_mfma_f32_16x16x32_bf16 v[84:87], v[16:19], v[160:163], v[84:87]
    v_mfma_f32_16x16x32_bf16 v[88:91], v[16:19], v[172:175], v[88:91]
    v_mfma_f32_16x16x32_bf16 v[92:95], v[16:19], v[184:187], v[92:95]
    s_nop 7
    buffer_load_dwordx4 v[16:19], v32, s[8:11], s33 offen offset:128
    s_waitcnt vmcnt(0)
    v_mfma_f32_16x16x32_bf16 v[76:79], v[16:19], v[104:107], v[76:79]
    v_mfma_f32_16x16x32_bf16 v[80:83], v[16:19], v[136:139], v[80:83]
    v_mfma_f32_16x16x32_bf16 v[84:87], v[16:19], v[164:167], v[84:87]
    v_mfma_f32_16x16x32_bf16 v[88:91], v[16:19], v[176:179], v[88:91]
    v_mfma_f32_16x16x32_bf16 v[92:95], v[16:19], v[188:191], v[92:95]
    s_nop 7
    buffer_load_dwordx4 v[16:19], v32, s[8:11], s33 offen offset:192
    s_waitcnt vmcnt(0)
    v_mfma_f32_16x16x32_bf16 v[76:79], v[16:19], v[108:111], v[76:79]
    ds_read_b128 v[24:27], v3 offset:15360
    s_waitcnt lgkmcnt(0)
    v_mfma_f32_16x16x32_bf16 v[80:83], v[16:19], v[24:27], v[80:83]
    ds_read_b128 v[28:31], v3 offset:5120
    s_waitcnt lgkmcnt(0)
    v_mfma_f32_16x16x32_bf16 v[84:87], v[16:19], v[28:31], v[84:87]
    ds_read_b128 v[20:23], v3 offset:0
    s_waitcnt lgkmcnt(0)
    v_mfma_f32_16x16x32_bf16 v[88:91], v[16:19], v[20:23], v[88:91]
    ds_read_b128 v[24:27], v3 offset:8192
    s_waitcnt lgkmcnt(0)
    v_mfma_f32_16x16x32_bf16 v[92:95], v[16:19], v[24:27], v[92:95]
    s_nop 7
    buffer_load_dwordx4 v[16:19], v32, s[8:11], s33 offen offset:256
    s_waitcnt vmcnt(0)
    v_mfma_f32_16x16x32_bf16 v[76:79], v[16:19], v[112:115], v[76:79]
    v_mfma_f32_16x16x32_bf16 v[80:83], v[16:19], v[140:143], v[80:83]
    ds_read_b128 v[28:31], v3 offset:6144
    s_waitcnt lgkmcnt(0)
    v_mfma_f32_16x16x32_bf16 v[84:87], v[16:19], v[28:31], v[84:87]
    ds_read_b128 v[20:23], v3 offset:1024
    s_waitcnt lgkmcnt(0)
    v_mfma_f32_16x16x32_bf16 v[88:91], v[16:19], v[20:23], v[88:91]
    ds_read_b128 v[24:27], v3 offset:9216
    s_waitcnt lgkmcnt(0)
    v_mfma_f32_16x16x32_bf16 v[92:95], v[16:19], v[24:27], v[92:95]
    s_nop 7
    buffer_load_dwordx4 v[16:19], v32, s[8:11], s33 offen offset:320
    s_waitcnt vmcnt(0)
    v_mfma_f32_16x16x32_bf16 v[76:79], v[16:19], v[116:119], v[76:79]
    v_mfma_f32_16x16x32_bf16 v[80:83], v[16:19], v[144:147], v[80:83]
    ds_read_b128 v[28:31], v3 offset:7168
    s_waitcnt lgkmcnt(0)
    v_mfma_f32_16x16x32_bf16 v[84:87], v[16:19], v[28:31], v[84:87]
    ds_read_b128 v[20:23], v3 offset:2048
    s_waitcnt lgkmcnt(0)
    v_mfma_f32_16x16x32_bf16 v[88:91], v[16:19], v[20:23], v[88:91]
    ds_read_b128 v[24:27], v3 offset:10240
    s_waitcnt lgkmcnt(0)
    v_mfma_f32_16x16x32_bf16 v[92:95], v[16:19], v[24:27], v[92:95]
    s_nop 7
    buffer_load_dwordx4 v[16:19], v32, s[8:11], s33 offen offset:384
    s_waitcnt vmcnt(0)
    v_mfma_f32_16x16x32_bf16 v[76:79], v[16:19], v[120:123], v[76:79]
    v_mfma_f32_16x16x32_bf16 v[80:83], v[16:19], v[148:151], v[80:83]
    ds_read_b128 v[28:31], v3 offset:13312
    s_waitcnt lgkmcnt(0)
    v_mfma_f32_16x16x32_bf16 v[84:87], v[16:19], v[28:31], v[84:87]
    ds_read_b128 v[20:23], v3 offset:3072
    s_waitcnt lgkmcnt(0)
    v_mfma_f32_16x16x32_bf16 v[88:91], v[16:19], v[20:23], v[88:91]
    ds_read_b128 v[24:27], v3 offset:11264
    s_waitcnt lgkmcnt(0)
    v_mfma_f32_16x16x32_bf16 v[92:95], v[16:19], v[24:27], v[92:95]
    s_nop 7
    buffer_load_dwordx4 v[16:19], v32, s[8:11], s33 offen offset:448
    s_waitcnt vmcnt(0)
    v_mfma_f32_16x16x32_bf16 v[76:79], v[16:19], v[124:127], v[76:79]
    v_mfma_f32_16x16x32_bf16 v[80:83], v[16:19], v[152:155], v[80:83]
    ds_read_b128 v[28:31], v3 offset:14336
    s_waitcnt lgkmcnt(0)
    v_mfma_f32_16x16x32_bf16 v[84:87], v[16:19], v[28:31], v[84:87]
    ds_read_b128 v[20:23], v3 offset:4096
    s_waitcnt lgkmcnt(0)
    v_mfma_f32_16x16x32_bf16 v[88:91], v[16:19], v[20:23], v[88:91]
    ds_read_b128 v[24:27], v3 offset:12288
    s_waitcnt lgkmcnt(0)
    v_mfma_f32_16x16x32_bf16 v[92:95], v[16:19], v[24:27], v[92:95]
    s_nop 7
    s_nop 7
    v_max3_f32 v32, v36, v37, v38
    v_max3_f32 v32, v32, v39, v76
    v_max3_f32 v32, v32, v77, v78
    v_max_f32 v32, v32, v79
    v_mov_b32 v33, v32
    v_mov_b32 v34, v32
    s_nop 1
    v_permlane32_swap_b32 v33, v34
    s_nop 1
    v_max_f32 v32, v33, v34
    v_mov_b32 v33, v32
    v_mov_b32 v34, v32
    s_nop 1
    v_permlane16_swap_b32 v33, v34
    s_nop 1
    v_max_f32 v32, v33, v34
    v_max_f32 v32, v32, v6
    v_sub_f32 v16, v6, v32
    v_exp_f32 v16, v16
    v_mov_b32 v6, v32
    v_mul_f32 v11, v11, v16
    v_max3_f32 v32, v40, v41, v42
    v_max3_f32 v32, v32, v43, v80
    v_max3_f32 v32, v32, v81, v82
    v_max_f32 v32, v32, v83
    v_mov_b32 v33, v32
    v_mov_b32 v34, v32
    s_nop 1
    v_permlane32_swap_b32 v33, v34
    s_nop 1
    v_max_f32 v32, v33, v34
    v_mov_b32 v33, v32
    v_mov_b32 v34, v32
    s_nop 1
    v_permlane16_swap_b32 v33, v34
    s_nop 1
    v_max_f32 v32, v33, v34
    v_max_f32 v32, v32, v7
    v_sub_f32 v17, v7, v32
    v_exp_f32 v17, v17
    v_mov_b32 v7, v32
    v_mul_f32 v12, v12, v17
    v_max3_f32 v32, v44, v45, v46
    v_max3_f32 v32, v32, v47, v84
    v_max3_f32 v32, v32, v85, v86
    v_max_f32 v32, v32, v87
    v_mov_b32 v33, v32
    v_mov_b32 v34, v32
    s_nop 1
    v_permlane32_swap_b32 v33, v34
    s_nop 1
    v_max_f32 v32, v33, v34
    v_mov_b32 v33, v32
    v_mov_b32 v34, v32
    s_nop 1
    v_permlane16_swap_b32 v33, v34
    s_nop 1
    v_max_f32 v32, v33, v34
    v_max_f32 v32, v32, v8
    v_sub_f32 v18, v8, v32
    v_exp_f32 v18, v18
    v_mov_b32 v8, v32
    v_mul_f32 v13, v13, v18
    v_max3_f32 v32, v48, v49, v50
    v_max3_f32 v32, v32, v51, v88
    v_max3_f32 v32, v32, v89, v90
    v_max_f32 v32, v32, v91
    v_mov_b32 v33, v32
    v_mov_b32 v34, v32
    s_nop 1
    v_permlane32_swap_b32 v33, v34
    s_nop 1
    v_max_f32 v32, v33, v34
    v_mov_b32 v33, v32
    v_mov_b32 v34, v32
    s_nop 1
    v_permlane16_swap_b32 v33, v34
    s_nop 1
    v_max_f32 v32, v33, v34
    v_max_f32 v32, v32, v9
    v_sub_f32 v19, v9, v32
    v_exp_f32 v19, v19
    v_mov_b32 v9, v32
    v_mul_f32 v14, v14, v19
    v_max3_f32 v32, v52, v53, v54
    v_max3_f32 v32, v32, v55, v92
    v_max3_f32 v32, v32, v93, v94
    v_max_f32 v32, v32, v95
    v_mov_b32 v33, v32
    v_mov_b32 v34, v32
    s_nop 1
    v_permlane32_swap_b32 v33, v34
    s_nop 1
    v_max_f32 v32, v33, v34
    v_mov_b32 v33, v32
    v_mov_b32 v34, v32
    s_nop 1
    v_permlane16_swap_b32 v33, v34
    s_nop 1
    v_max_f32 v32, v33, v34
    v_max_f32 v32, v32, v10
    v_sub_f32 v20, v10, v32
    v_exp_f32 v20, v20
    v_mov_b32 v10, v32
    v_mul_f32 v15, v15, v20
    v_sub_f32 v36, v36, v6
    v_exp_f32 v36, v36
    v_sub_f32 v37, v37, v6
    v_exp_f32 v37, v37
    v_sub_f32 v38, v38, v6
    v_exp_f32 v38, v38
    v_sub_f32 v39, v39, v6
    v_exp_f32 v39, v39
    v_add_f32 v5, v36, v37
    v_cvt_pk_bf16_f32 v36, v36, v37
    v_cvt_pk_bf16_f32 v37, v38, v39
    v_add_f32 v38, v38, v39
    v_add_f32 v38, v38, v5
    v_sub_f32 v40, v40, v7
    v_exp_f32 v40, v40
    v_sub_f32 v41, v41, v7
    v_exp_f32 v41, v41
    v_sub_f32 v42, v42, v7
    v_exp_f32 v42, v42
    v_sub_f32 v43, v43, v7
    v_exp_f32 v43, v43
    v_add_f32 v5, v40, v41
    v_cvt_pk_bf16_f32 v40, v40, v41
    v_cvt_pk_bf16_f32 v41, v42, v43
    v_add_f32 v42, v42, v43
    v_add_f32 v42, v42, v5
    v_sub_f32 v44, v44, v8
    v_exp_f32 v44, v44
    v_sub_f32 v45, v45, v8
    v_exp_f32 v45, v45
    v_sub_f32 v46, v46, v8
    v_exp_f32 v46, v46
    v_sub_f32 v47, v47, v8
    v_exp_f32 v47, v47
    v_add_f32 v5, v44, v45
    v_cvt_pk_bf16_f32 v44, v44, v45
    v_cvt_pk_bf16_f32 v45, v46, v47
    v_add_f32 v46, v46, v47
    v_add_f32 v46, v46, v5
    v_sub_f32 v48, v48, v9
    v_exp_f32 v48, v48
    v_sub_f32 v49, v49, v9
    v_exp_f32 v49, v49
    v_sub_f32 v50, v50, v9
    v_exp_f32 v50, v50
    v_sub_f32 v51, v51, v9
    v_exp_f32 v51, v51
    v_add_f32 v5, v48, v49
    v_cvt_pk_bf16_f32 v48, v48, v49
    v_cvt_pk_bf16_f32 v49, v50, v51
    v_add_f32 v50, v50, v51
    v_add_f32 v50, v50, v5
    v_sub_f32 v52, v52, v10
    v_exp_f32 v52, v52
    v_sub_f32 v53, v53, v10
    v_exp_f32 v53, v53
    v_sub_f32 v54, v54, v10
    v_exp_f32 v54, v54
    v_sub_f32 v55, v55, v10
    v_exp_f32 v55, v55
    v_add_f32 v5, v52, v53
    v_cvt_pk_bf16_f32 v52, v52, v53
    v_cvt_pk_bf16_f32 v53, v54, v55
    v_add_f32 v54, v54, v55
    v_add_f32 v54, v54, v5
    v_sub_f32 v76, v76, v6
    v_exp_f32 v76, v76
    v_sub_f32 v77, v77, v6
    v_exp_f32 v77, v77
    v_sub_f32 v78, v78, v6
    v_exp_f32 v78, v78
    v_sub_f32 v79, v79, v6
    v_exp_f32 v79, v79
    v_add_f32 v39, v38, v76
    v_cvt_pk_bf16_f32 v38, v76, v77
    v_add_f32 v76, v39, v77
    v_add_f32 v76, v76, v78
    v_cvt_pk_bf16_f32 v39, v78, v79
    v_add_f32 v76, v76, v79
    v_sub_f32 v80, v80, v7
    v_exp_f32 v80, v80
    v_sub_f32 v81, v81, v7
    v_exp_f32 v81, v81
    v_sub_f32 v82, v82, v7
    v_exp_f32 v82, v82
    v_sub_f32 v83, v83, v7
    v_exp_f32 v83, v83
    v_add_f32 v43, v42, v80
    v_cvt_pk_bf16_f32 v42, v80, v81
    v_add_f32 v80, v43, v81
    v_add_f32 v80, v80, v82
    v_cvt_pk_bf16_f32 v43, v82, v83
    v_add_f32 v80, v80, v83
    v_sub_f32 v84, v84, v8
    v_exp_f32 v84, v84
    v_sub_f32 v85, v85, v8
    v_exp_f32 v85, v85
    v_sub_f32 v86, v86, v8
    v_exp_f32 v86, v86
    v_sub_f32 v87, v87, v8
    v_exp_f32 v87, v87
    v_add_f32 v47, v46, v84
    v_cvt_pk_bf16_f32 v46, v84, v85
    v_add_f32 v84, v47, v85
    v_add_f32 v84, v84, v86
    v_cvt_pk_bf16_f32 v47, v86, v87
    v_add_f32 v84, v84, v87
    v_sub_f32 v88, v88, v9
    v_exp_f32 v88, v88
    v_sub_f32 v89, v89, v9
    v_exp_f32 v89, v89
    v_sub_f32 v90, v90, v9
    v_exp_f32 v90, v90
    v_sub_f32 v91, v91, v9
    v_exp_f32 v91, v91
    v_add_f32 v51, v50, v88
    v_cvt_pk_bf16_f32 v50, v88, v89
    v_add_f32 v88, v51, v89
    v_add_f32 v88, v88, v90
    v_cvt_pk_bf16_f32 v51, v90, v91
    v_add_f32 v88, v88, v91
    v_sub_f32 v92, v92, v10
    v_exp_f32 v92, v92
    v_sub_f32 v93, v93, v10
    v_exp_f32 v93, v93
    v_sub_f32 v94, v94, v10
    v_exp_f32 v94, v94
    v_sub_f32 v95, v95, v10
    v_exp_f32 v95, v95
    v_add_f32 v55, v54, v92
    v_cvt_pk_bf16_f32 v54, v92, v93
    v_add_f32 v92, v55, v93
    v_add_f32 v92, v92, v94
    v_cvt_pk_bf16_f32 v55, v94, v95
    v_add_f32 v92, v92, v95
    s_mov_b32 s32, 0
    s_branch L_rescale
L_backA:
    ds_read_b128 v[32:35], v0 offset:0
    ds_read_b128 v[16:19], v1 offset:0
    ds_read_b128 v[20:23], v0 offset:1024
    ds_read_b128 v[24:27], v0 offset:8192
    ds_read_b128 v[28:31], v1 offset:8192
    s_waitcnt lgkmcnt(0)
    s_nop 3
    s_branch L_retA
L_slowB:
    s_waitcnt vmcnt(0) lgkmcnt(0)
    s_nop 7
    v_mbcnt_lo_u32_b32 v32, -1, 0
    v_mbcnt_hi_u32_b32 v32, -1, v32
    v_and_b32 v33, 15, v32
    v_lshrrev_b32 v32, 4, v32
    v_lshlrev_b32 v35, 4, v32
    v_lshl_add_u32 v32, v33, 9, v35
    s_sub_u32 s33, s23, 49152
    buffer_load_dwordx4 v[16:19], v32, s[8:11], s33 offen offset:0
    s_waitcnt vmcnt(0)
    v_mfma_f32_16x16x32_bf16 v[56:59], v[16:19], v[96:99], 0
    v_mfma_f32_16x16x32_bf16 v[60:63], v[16:19], v[128:131], 0
    v_mfma_f32_16x16x32_bf16 v[64:67], v[16:19], v[156:159], 0
    v_mfma_f32_16x16x32_bf16 v[68:71], v[16:19], v[168:171], 0
    v_mfma_f32_16x16x32_bf16 v[72:75], v[16:19], v[180:183], 0
    s_nop 7
    buffer_load_dwordx4 v[16:19], v32, s[8:11], s33 offen offset:64
    s_waitcnt vmcnt(0)
    v_mfma_f32_16x16x32_bf16 v[56:59], v[16:19], v[100:103], v[56:59]
    v_mfma_f32_16x16x32_bf16 v[60:63], v[16:19], v[132:135], v[60:63]
    v_mfma_f32_16x16x32_bf16 v[64:67], v[16:19], v[160:163], v[64:67]
    v_mfma_f32_16x16x32_bf16 v[68:71], v[16:19], v[172:175], v[68:71]
    v_mfma_f32_16x16x32_bf16 v[72:75], v[16:19], v[184:187], v[72:75]
    s_nop 7
    buffer_load_dwordx4 v[16:19], v32, s[8:11], s33 offen offset:128
    s_waitcnt vmcnt(0)
    v_mfma_f32_16x16x32_bf16 v[56:59], v[16:19], v[104:107], v[56:59]
    v_mfma_f32_16x16x32_bf16 v[60:63], v[16:19], v[136:139], v[60:63]
    v_mfma_f32_16x16x32_bf16 v[64:67], v[16:19], v[164:167], v[64:67]
    v_mfma_f32_16x16x32_bf16 v[68:71], v[16:19], v[176:179], v[68:71]
    v_mfma_f32_16x16x32_bf16 v[72:75], v[16:19], v[188:191], v[72:75]
    s_nop 7
    buffer_load_dwordx4 v[16:19], v32, s[8:11], s33 offen offset:192
    s_waitcnt vmcnt(0)
    v_mfma_f32_16x16x32_bf16 v[56:59], v[16:19], v[108:111], v[56:59]
    ds_read_b128 v[24:27], v3 offset:15360
    s_waitcnt lgkmcnt(0)
    v_mfma_f32_16x16x32_bf16 v[60:63], v[16:19], v[24:27], v[60:63]
    ds_read_b128 v[28:31], v3 offset:5120
    s_waitcnt lgkmcnt(0)
    v_mfma_f32_16x16x32_bf16 v[64:67], v[16:19], v[28:31], v[64:67]
    ds_read_b128 v[20:23], v3 offset:0
    s_waitcnt lgkmcnt(0)
    v_mfma_f32_16x16x32_bf16 v[68:71], v[16:19], v[20:23], v[68:71]
    ds_read_b128 v[24:27], v3 offset:8192
    s_waitcnt lgkmcnt(0)
    v_mfma_f32_16x16x32_bf16 v[72:75], v[16:19], v[24:27], v[72:75]
    s_nop 7
    buffer_load_dwordx4 v[16:19], v32, s[8:11], s33 offen offset:256
    s_waitcnt vmcnt(0)
    v_mfma_f32_16x16x32_bf16 v[56:59], v[16:19], v[112:115], v[56:59]
    v_mfma_f32_16x16x32_bf16 v[60:63], v[16:19], v[140:143], v[60:63]
    ds_read_b128 v[28:31], v3 offset:6144
    s_waitcnt lgkmcnt(0)
    v_mfma_f32_16x16x32_bf16 v[64:67], v[16:19], v[28:31], v[64:67]
    ds_read_b128 v[20:23], v3 offset:1024
    s_waitcnt lgkmcnt(0)
    v_mfma_f32_16x16x32_bf16 v[68:71], v[16:19], v[20:23], v[68:71]
    ds_read_b128 v[24:27], v3 offset:9216
    s_waitcnt lgkmcnt(0)
    v_mfma_f32_16x16x32_bf16 v[72:75], v[16:19], v[24:27], v[72:75]
    s_nop 7
    buffer_load_dwordx4 v[16:19], v32, s[8:11], s33 offen offset:320
    s_waitcnt vmcnt(0)
    v_mfma_f32_16x16x32_bf16 v[56:59], v[16:19], v[116:119], v[56:59]
    v_mfma_f32_16x16x32_bf16 v[60:63], v[16:19], v[144:147], v[60:63]
    ds_read_b128 v[28:31], v3 offset:7168
    s_waitcnt lgkmcnt(0)
    v_mfma_f32_16x16x32_bf16 v[64:67], v[16:19], v[28:31], v[64:67]
    ds_read_b128 v[20:23], v3 offset:2048
    s_waitcnt lgkmcnt(0)
    v_mfma_f32_16x16x32_bf16 v[68:71], v[16:19], v[20:23], v[68:71]
    ds_read_b128 v[24:27], v3 offset:10240
    s_waitcnt lgkmcnt(0)
    v_mfma_f32_16x16x32_bf16 v[72:75], v[16:19], v[24:27], v[72:75]
    s_nop 7
    buffer_load_dwordx4 v[16:19], v32, s[8:11], s33 offen offset:384
    s_waitcnt vmcnt(0)
    v_mfma_f32_16x16x32_bf16 v[56:59], v[16:19], v[120:123], v[56:59]
    v_mfma_f32_16x16x32_bf16 v[60:63], v[16:19], v[148:151], v[60:63]
    ds_read_b128 v[28:31], v3 offset:13312
    s_waitcnt lgkmcnt(0)
    v_mfma_f32_16x16x32_bf16 v[64:67], v[16:19], v[28:31], v[64:67]
    ds_read_b128 v[20:23], v3 offset:3072
    s_waitcnt lgkmcnt(0)
    v_mfma_f32_16x16x32_bf16 v[68:71], v[16:19], v[20:23], v[68:71]
    ds_read_b128 v[24:27], v3 offset:11264
    s_waitcnt lgkmcnt(0)
    v_mfma_f32_16x16x32_bf16 v[72:75], v[16:19], v[24:27], v[72:75]
    s_nop 7
    buffer_load_dwordx4 v[16:19], v32, s[8:11], s33 offen offset:448
    s_waitcnt vmcnt(0)
    v_mfma_f32_16x16x32_bf16 v[56:59], v[16:19], v[124:127], v[56:59]
    v_mfma_f32_16x16x32_bf16 v[60:63], v[16:19], v[152:155], v[60:63]
    ds_read_b128 v[28:31], v3 offset:14336
    s_waitcnt lgkmcnt(0)
    v_mfma_f32_16x16x32_bf16 v[64:67], v[16:19], v[28:31], v[64:67]
    ds_read_b128 v[20:23], v3 offset:4096
    s_waitcnt lgkmcnt(0)
    v_mfma_f32_16x16x32_bf16 v[68:71], v[16:19], v[20:23], v[68:71]
    ds_read_b128 v[24:27], v3 offset:12288
    s_waitcnt lgkmcnt(0)
    v_mfma_f32_16x16x32_bf16 v[72:75], v[16:19], v[24:27], v[72:75]
    s_nop 7
    s_sub_u32 s33, s23, 40960
    buffer_load_dwordx4 v[16:19], v32, s[8:11], s33 offen offset:0
    s_waitcnt vmcnt(0)
    v_mfma_f32_16x16x32_bf16 v[76:79], v[16:19], v[96:99], 0
    v_mfma_f32_16x16x32_bf16 v[80:83], v[16:19], v[128:131], 0
    v_mfma_f32_16x16x32_bf16 v[84:87], v[16:19], v[156:159], 0
    v_mfma_f32_16x16x32_bf16 v[88:91], v[16:19], v[168:171], 0
    v_mfma_f32_16x16x32_bf16 v[92:95], v[16:19], v[180:183], 0
    s_nop 7
    buffer_load_dwordx4 v[16:19], v32, s[8:11], s33 offen offset:64
    s_waitcnt vmcnt(0)
    v_mfma_f32_16x16x32_bf16 v[76:79], v[16:19], v[100:103], v[76:79]
    v_mfma_f32_16x16x32_bf16 v[80:83], v[16:19], v[132:135], v[80:83]
    v_mfma_f32_16x16x32_bf16 v[84:87], v[16:19], v[160:163], v[84:87]
    v_mfma_f32_16x16x32_bf16 v[88:91], v[16:19], v[172:175], v[88:91]
    v_mfma_f32_16x16x32_bf16 v[92:95], v[16:19], v[184:187], v[92:95]
    s_nop 7
    buffer_load_dwordx4 v[16:19], v32, s[8:11], s33 offen offset:128
    s_waitcnt vmcnt(0)
    v_mfma_f32_16x16x32_bf16 v[76:79], v[16:19], v[104:107], v[76:79]
    v_mfma_f32_16x16x32_bf16 v[80:83], v[16:19], v[136:139], v[80:83]
    v_mfma_f32_16x16x32_bf16 v[84:87], v[16:19], v[164:167], v[84:87]
    v_mfma_f32_16x16x32_bf16 v[88:91], v[16:19], v[176:179], v[88:91]
    v_mfma_f32_16x16x32_bf16 v[92:95], v[16:19], v[188:191], v[92:95]
    s_nop 7
    buffer_load_dwordx4 v[16:19], v32, s[8:11], s33 offen offset:192
    s_waitcnt vmcnt(0)
    v_mfma_f32_16x16x32_bf16 v[76:79], v[16:19], v[108:111], v[76:79]
    ds_read_b128 v[24:27], v3 offset:15360
    s_waitcnt lgkmcnt(0)
    v_mfma_f32_16x16x32_bf16 v[80:83], v[16:19], v[24:27], v[80:83]
    ds_read_b128 v[28:31], v3 offset:5120
    s_waitcnt lgkmcnt(0)
    v_mfma_f32_16x16x32_bf16 v[84:87], v[16:19], v[28:31], v[84:87]
    ds_read_b128 v[20:23], v3 offset:0
    s_waitcnt lgkmcnt(0)
    v_mfma_f32_16x16x32_bf16 v[88:91], v[16:19], v[20:23], v[88:91]
    ds_read_b128 v[24:27], v3 offset:8192
    s_waitcnt lgkmcnt(0)
    v_mfma_f32_16x16x32_bf16 v[92:95], v[16:19], v[24:27], v[92:95]
    s_nop 7
    buffer_load_dwordx4 v[16:19], v32, s[8:11], s33 offen offset:256
    s_waitcnt vmcnt(0)
    v_mfma_f32_16x16x32_bf16 v[76:79], v[16:19], v[112:115], v[76:79]
    v_mfma_f32_16x16x32_bf16 v[80:83], v[16:19], v[140:143], v[80:83]
    ds_read_b128 v[28:31], v3 offset:6144
    s_waitcnt lgkmcnt(0)
    v_mfma_f32_16x16x32_bf16 v[84:87], v[16:19], v[28:31], v[84:87]
    ds_read_b128 v[20:23], v3 offset:1024
    s_waitcnt lgkmcnt(0)
    v_mfma_f32_16x16x32_bf16 v[88:91], v[16:19], v[20:23], v[88:91]
    ds_read_b128 v[24:27], v3 offset:9216
    s_waitcnt lgkmcnt(0)
    v_mfma_f32_16x16x32_bf16 v[92:95], v[16:19], v[24:27], v[92:95]
    s_nop 7
    buffer_load_dwordx4 v[16:19], v32, s[8:11], s33 offen offset:320
    s_waitcnt vmcnt(0)
    v_mfma_f32_16x16x32_bf16 v[76:79], v[16:19], v[116:119], v[76:79]
    v_mfma_f32_16x16x32_bf16 v[80:83], v[16:19], v[144:147], v[80:83]
    ds_read_b128 v[28:31], v3 offset:7168
    s_waitcnt lgkmcnt(0)
    v_mfma_f32_16x16x32_bf16 v[84:87], v[16:19], v[28:31], v[84:87]
    ds_read_b128 v[20:23], v3 offset:2048
    s_waitcnt lgkmcnt(0)
    v_mfma_f32_16x16x32_bf16 v[88:91], v[16:19], v[20:23], v[88:91]
    ds_read_b128 v[24:27], v3 offset:10240
    s_waitcnt lgkmcnt(0)
    v_mfma_f32_16x16x32_bf16 v[92:95], v[16:19], v[24:27], v[92:95]
    s_nop 7
    buffer_load_dwordx4 v[16:19], v32, s[8:11], s33 offen offset:384
    s_waitcnt vmcnt(0)
    v_mfma_f32_16x16x32_bf16 v[76:79], v[16:19], v[120:123], v[76:79]
    v_mfma_f32_16x16x32_bf16 v[80:83], v[16:19], v[148:151], v[80:83]
    ds_read_b128 v[28:31], v3 offset:13312
    s_waitcnt lgkmcnt(0)
    v_mfma_f32_16x16x32_bf16 v[84:87], v[16:19], v[28:31], v[84:87]
    ds_read_b128 v[20:23], v3 offset:3072
    s_waitcnt lgkmcnt(0)
    v_mfma_f32_16x16x32_bf16 v[88:91], v[16:19], v[20:23], v[88:91]
    ds_read_b128 v[24:27], v3 offset:11264
    s_waitcnt lgkmcnt(0)
    v_mfma_f32_16x16x32_bf16 v[92:95], v[16:19], v[24:27], v[92:95]
    s_nop 7
    buffer_load_dwordx4 v[16:19], v32, s[8:11], s33 offen offset:448
    s_waitcnt vmcnt(0)
    v_mfma_f32_16x16x32_bf16 v[76:79], v[16:19], v[124:127], v[76:79]
    v_mfma_f32_16x16x32_bf16 v[80:83], v[16:19], v[152:155], v[80:83]
    ds_read_b128 v[28:31], v3 offset:14336
    s_waitcnt lgkmcnt(0)
    v_mfma_f32_16x16x32_bf16 v[84:87], v[16:19], v[28:31], v[84:87]
    ds_read_b128 v[20:23], v3 offset:4096
    s_waitcnt lgkmcnt(0)
    v_mfma_f32_16x16x32_bf16 v[88:91], v[16:19], v[20:23], v[88:91]
    ds_read_b128 v[24:27], v3 offset:12288
    s_waitcnt lgkmcnt(0)
    v_mfma_f32_16x16x32_bf16 v[92:95], v[16:19], v[24:27], v[92:95]
    s_nop 7
    s_nop 7
    v_max3_f32 v32, v56, v57, v58
    v_max3_f32 v32, v32, v59, v76
    v_max3_f32 v32, v32, v77, v78
    v_max_f32 v32, v32, v79
    v_mov_b32 v33, v32
    v_mov_b32 v34, v32
    s_nop 1
    v_permlane32_swap_b32 v33, v34
    s_nop 1
    v_max_f32 v32, v33, v34
    v_mov_b32 v33, v32
    v_mov_b32 v34, v32
    s_nop 1
    v_permlane16_swap_b32 v33, v34
    s_nop 1
    v_max_f32 v32, v33, v34
    v_max_f32 v32, v32, v6
    v_sub_f32 v16, v6, v32
    v_exp_f32 v16, v16
    v_mov_b32 v6, v32
    v_mul_f32 v11, v11, v16
    v_max3_f32 v32, v60, v61, v62
    v_max3_f32 v32, v32, v63, v80
    v_max3_f32 v32, v32, v81, v82
    v_max_f32 v32, v32, v83
    v_mov_b32 v33, v32
    v_mov_b32 v34, v32
    s_nop 1
    v_permlane32_swap_b32 v33, v34
    s_nop 1
    v_max_f32 v32, v33, v34
    v_mov_b32 v33, v32
    v_mov_b32 v34, v32
    s_nop 1
    v_permlane16_swap_b32 v33, v34
    s_nop 1
    v_max_f32 v32, v33, v34
    v_max_f32 v32, v32, v7
    v_sub_f32 v17, v7, v32
    v_exp_f32 v17, v17
    v_mov_b32 v7, v32
    v_mul_f32 v12, v12, v17
    v_max3_f32 v32, v64, v65, v66
    v_max3_f32 v32, v32, v67, v84
    v_max3_f32 v32, v32, v85, v86
    v_max_f32 v32, v32, v87
    v_mov_b32 v33, v32
    v_mov_b32 v34, v32
    s_nop 1
    v_permlane32_swap_b32 v33, v34
    s_nop 1
    v_max_f32 v32, v33, v34
    v_mov_b32 v33, v32
    v_mov_b32 v34, v32
    s_nop 1
    v_permlane16_swap_b32 v33, v34
    s_nop 1
    v_max_f32 v32, v33, v34
    v_max_f32 v32, v32, v8
    v_sub_f32 v18, v8, v32
    v_exp_f32 v18, v18
    v_mov_b32 v8, v32
    v_mul_f32 v13, v13, v18
    v_max3_f32 v32, v68, v69, v70
    v_max3_f32 v32, v32, v71, v88
    v_max3_f32 v32, v32, v89, v90
    v_max_f32 v32, v32, v91
    v_mov_b32 v33, v32
    v_mov_b32 v34, v32
    s_nop 1
    v_permlane32_swap_b32 v33, v34
    s_nop 1
    v_max_f32 v32, v33, v34
    v_mov_b32 v33, v32
    v_mov_b32 v34, v32
    s_nop 1
    v_permlane16_swap_b32 v33, v34
    s_nop 1
    v_max_f32 v32, v33, v34
    v_max_f32 v32, v32, v9
    v_sub_f32 v19, v9, v32
    v_exp_f32 v19, v19
    v_mov_b32 v9, v32
    v_mul_f32 v14, v14, v19
    v_max3_f32 v32, v72, v73, v74
    v_max3_f32 v32, v32, v75, v92
    v_max3_f32 v32, v32, v93, v94
    v_max_f32 v32, v32, v95
    v_mov_b32 v33, v32
    v_mov_b32 v34, v32
    s_nop 1
    v_permlane32_swap_b32 v33, v34
    s_nop 1
    v_max_f32 v32, v33, v34
    v_mov_b32 v33, v32
    v_mov_b32 v34, v32
    s_nop 1
    v_permlane16_swap_b32 v33, v34
    s_nop 1
    v_max_f32 v32, v33, v34
    v_max_f32 v32, v32, v10
    v_sub_f32 v20, v10, v32
    v_exp_f32 v20, v20
    v_mov_b32 v10, v32
    v_mul_f32 v15, v15, v20
    v_sub_f32 v56, v56, v6
    v_exp_f32 v56, v56
    v_sub_f32 v57, v57, v6
    v_exp_f32 v57, v57
    v_sub_f32 v58, v58, v6
    v_exp_f32 v58, v58
    v_sub_f32 v59, v59, v6
    v_exp_f32 v59, v59
    v_add_f32 v5, v56, v57
    v_cvt_pk_bf16_f32 v56, v56, v57
    v_cvt_pk_bf16_f32 v57, v58, v59
    v_add_f32 v58, v58, v59
    v_add_f32 v58, v58, v5
    v_sub_f32 v60, v60, v7
    v_exp_f32 v60, v60
    v_sub_f32 v61, v61, v7
    v_exp_f32 v61, v61
    v_sub_f32 v62, v62, v7
    v_exp_f32 v62, v62
    v_sub_f32 v63, v63, v7
    v_exp_f32 v63, v63
    v_add_f32 v5, v60, v61
    v_cvt_pk_bf16_f32 v60, v60, v61
    v_cvt_pk_bf16_f32 v61, v62, v63
    v_add_f32 v62, v62, v63
    v_add_f32 v62, v62, v5
    v_sub_f32 v64, v64, v8
    v_exp_f32 v64, v64
    v_sub_f32 v65, v65, v8
    v_exp_f32 v65, v65
    v_sub_f32 v66, v66, v8
    v_exp_f32 v66, v66
    v_sub_f32 v67, v67, v8
    v_exp_f32 v67, v67
    v_add_f32 v5, v64, v65
    v_cvt_pk_bf16_f32 v64, v64, v65
    v_cvt_pk_bf16_f32 v65, v66, v67
    v_add_f32 v66, v66, v67
    v_add_f32 v66, v66, v5
    v_sub_f32 v68, v68, v9
    v_exp_f32 v68, v68
    v_sub_f32 v69, v69, v9
    v_exp_f32 v69, v69
    v_sub_f32 v70, v70, v9
    v_exp_f32 v70, v70
    v_sub_f32 v71, v71, v9
    v_exp_f32 v71, v71
    v_add_f32 v5, v68, v69
    v_cvt_pk_bf16_f32 v68, v68, v69
    v_cvt_pk_bf16_f32 v69, v70, v71
    v_add_f32 v70, v70, v71
    v_add_f32 v70, v70, v5
    v_sub_f32 v72, v72, v10
    v_exp_f32 v72, v72
    v_sub_f32 v73, v73, v10
    v_exp_f32 v73, v73
    v_sub_f32 v74, v74, v10
    v_exp_f32 v74, v74
    v_sub_f32 v75, v75, v10
    v_exp_f32 v75, v75
    v_add_f32 v5, v72, v73
    v_cvt_pk_bf16_f32 v72, v72, v73
    v_cvt_pk_bf16_f32 v73, v74, v75
    v_add_f32 v74, v74, v75
    v_add_f32 v74, v74, v5
    v_sub_f32 v76, v76, v6
    v_exp_f32 v76, v76
    v_sub_f32 v77, v77, v6
    v_exp_f32 v77, v77
    v_sub_f32 v78, v78, v6
    v_exp_f32 v78, v78
    v_sub_f32 v79, v79, v6
    v_exp_f32 v79, v79
    v_add_f32 v59, v58, v76
    v_cvt_pk_bf16_f32 v58, v76, v77
    v_add_f32 v76, v59, v77
    v_add_f32 v76, v76, v78
    v_cvt_pk_bf16_f32 v59, v78, v79
    v_add_f32 v76, v76, v79
    v_sub_f32 v80, v80, v7
    v_exp_f32 v80, v80
    v_sub_f32 v81, v81, v7
    v_exp_f32 v81, v81
    v_sub_f32 v82, v82, v7
    v_exp_f32 v82, v82
    v_sub_f32 v83, v83, v7
    v_exp_f32 v83, v83
    v_add_f32 v63, v62, v80
    v_cvt_pk_bf16_f32 v62, v80, v81
    v_add_f32 v80, v63, v81
    v_add_f32 v80, v80, v82
    v_cvt_pk_bf16_f32 v63, v82, v83
    v_add_f32 v80, v80, v83
    v_sub_f32 v84, v84, v8
    v_exp_f32 v84, v84
    v_sub_f32 v85, v85, v8
    v_exp_f32 v85, v85
    v_sub_f32 v86, v86, v8
    v_exp_f32 v86, v86
    v_sub_f32 v87, v87, v8
    v_exp_f32 v87, v87
    v_add_f32 v67, v66, v84
    v_cvt_pk_bf16_f32 v66, v84, v85
    v_add_f32 v84, v67, v85
    v_add_f32 v84, v84, v86
    v_cvt_pk_bf16_f32 v67, v86, v87
    v_add_f32 v84, v84, v87
    v_sub_f32 v88, v88, v9
    v_exp_f32 v88, v88
    v_sub_f32 v89, v89, v9
    v_exp_f32 v89, v89
    v_sub_f32 v90, v90, v9
    v_exp_f32 v90, v90
    v_sub_f32 v91, v91, v9
    v_exp_f32 v91, v91
    v_add_f32 v71, v70, v88
    v_cvt_pk_bf16_f32 v70, v88, v89
    v_add_f32 v88, v71, v89
    v_add_f32 v88, v88, v90
    v_cvt_pk_bf16_f32 v71, v90, v91
    v_add_f32 v88, v88, v91
    v_sub_f32 v92, v92, v10
    v_exp_f32 v92, v92
    v_sub_f32 v93, v93, v10
    v_exp_f32 v93, v93
    v_sub_f32 v94, v94, v10
    v_exp_f32 v94, v94
    v_sub_f32 v95, v95, v10
    v_exp_f32 v95, v95
    v_add_f32 v75, v74, v92
    v_cvt_pk_bf16_f32 v74, v92, v93
    v_add_f32 v92, v75, v93
    v_add_f32 v92, v92, v94
    v_cvt_pk_bf16_f32 v75, v94, v95
    v_add_f32 v92, v92, v95
    s_mov_b32 s32, 1
    s_branch L_rescale
L_backB:
    ds_read_b128 v[32:35], v0 offset:0
    ds_read_b128 v[16:19], v1 offset:0
    ds_read_b128 v[20:23], v0 offset:1024
    ds_read_b128 v[24:27], v0 offset:8192
    ds_read_b128 v[28:31], v1 offset:8192
    s_waitcnt lgkmcnt(0)
    s_nop 3
    s_branch L_retB
L_slowC:
    s_waitcnt vmcnt(0) lgkmcnt(0)
    s_nop 7
    v_mbcnt_lo_u32_b32 v32, -1, 0
    v_mbcnt_hi_u32_b32 v32, -1, v32
    v_and_b32 v33, 15, v32
    v_lshrrev_b32 v32, 4, v32
    v_lshlrev_b32 v35, 4, v32
    v_lshl_add_u32 v32, v33, 9, v35
    s_sub_u32 s33, s23, 49152
    buffer_load_dwordx4 v[16:19], v32, s[8:11], s33 offen offset:0
    s_waitcnt vmcnt(0)
    v_mfma_f32_16x16x32_bf16 v[36:39], v[16:19], v[96:99], 0
    v_mfma_f32_16x16x32_bf16 v[40:43], v[16:19], v[128:131], 0
    v_mfma_f32_16x16x32_bf16 v[44:47], v[16:19], v[156:159], 0
    v_mfma_f32_16x16x32_bf16 v[48:51], v[16:19], v[168:171], 0
    v_mfma_f32_16x16x32_bf16 v[52:55], v[16:19], v[180:183], 0
    s_nop 7
    buffer_load_dwordx4 v[16:19], v32, s[8:11], s33 offen offset:64
    s_waitcnt vmcnt(0)
    v_mfma_f32_16x16x32_bf16 v[36:39], v[16:19], v[100:103], v[36:39]
    v_mfma_f32_16x16x32_bf16 v[40:43], v[16:19], v[132:135], v[40:43]
    v_mfma_f32_16x16x32_bf16 v[44:47], v[16:19], v[160:163], v[44:47]
    v_mfma_f32_16x16x32_bf16 v[48:51], v[16:19], v[172:175], v[48:51]
    v_mfma_f32_16x16x32_bf16 v[52:55], v[16:19], v[184:187], v[52:55]
    s_nop 7
    buffer_load_dwordx4 v[16:19], v32, s[8:11], s33 offen offset:128
    s_waitcnt vmcnt(0)
    v_mfma_f32_16x16x32_bf16 v[36:39], v[16:19], v[104:107], v[36:39]
    v_mfma_f32_16x16x32_bf16 v[40:43], v[16:19], v[136:139], v[40:43]
    v_mfma_f32_16x16x32_bf16 v[44:47], v[16:19], v[164:167], v[44:47]
    v_mfma_f32_16x16x32_bf16 v[48:51], v[16:19], v[176:179], v[48:51]
    v_mfma_f32_16x16x32_bf16 v[52:55], v[16:19], v[188:191], v[52:55]
    s_nop 7
    buffer_load_dwordx4 v[16:19], v32, s[8:11], s33 offen offset:192
    s_waitcnt vmcnt(0)
    v_mfma_f32_16x16x32_bf16 v[36:39], v[16:19], v[108:111], v[36:39]
    ds_read_b128 v[24:27], v3 offset:15360
    s_waitcnt lgkmcnt(0)
    v_mfma_f32_16x16x32_bf16 v[40:43], v[16:19], v[24:27], v[40:43]
    ds_read_b128 v[28:31], v3 offset:5120
    s_waitcnt lgkmcnt(0)
    v_mfma_f32_16x16x32_bf16 v[44:47], v[16:19], v[28:31], v[44:47]
    ds_read_b128 v[20:23], v3 offset:0
    s_waitcnt lgkmcnt(0)
    v_mfma_f32_16x16x32_bf16 v[48:51], v[16:19], v[20:23], v[48:51]
    ds_read_b128 v[24:27], v3 offset:8192
    s_waitcnt lgkmcnt(0)
    v_mfma_f32_16x16x32_bf16 v[52:55], v[16:19], v[24:27], v[52:55]
    s_nop 7
    buffer_load_dwordx4 v[16:19], v32, s[8:11], s33 offen offset:256
    s_waitcnt vmcnt(0)
    v_mfma_f32_16x16x32_bf16 v[36:39], v[16:19], v[112:115], v[36:39]
    v_mfma_f32_16x16x32_bf16 v[40:43], v[16:19], v[140:143], v[40:43]
    ds_read_b128 v[28:31], v3 offset:6144
    s_waitcnt lgkmcnt(0)
    v_mfma_f32_16x16x32_bf16 v[44:47], v[16:19], v[28:31], v[44:47]
    ds_read_b128 v[20:23], v3 offset:1024
    s_waitcnt lgkmcnt(0)
    v_mfma_f32_16x16x32_bf16 v[48:51], v[16:19], v[20:23], v[48:51]
    ds_read_b128 v[24:27], v3 offset:9216
    s_waitcnt lgkmcnt(0)
    v_mfma_f32_16x16x32_bf16 v[52:55], v[16:19], v[24:27], v[52:55]
    s_nop 7
    buffer_load_dwordx4 v[16:19], v32, s[8:11], s33 offen offset:320
    s_waitcnt vmcnt(0)
    v_mfma_f32_16x16x32_bf16 v[36:39], v[16:19], v[116:119], v[36:39]
    v_mfma_f32_16x16x32_bf16 v[40:43], v[16:19], v[144:147], v[40:43]
    ds_read_b128 v[28:31], v3 offset:7168
    s_waitcnt lgkmcnt(0)
    v_mfma_f32_16x16x32_bf16 v[44:47], v[16:19], v[28:31], v[44:47]
    ds_read_b128 v[20:23], v3 offset:2048
    s_waitcnt lgkmcnt(0)
    v_mfma_f32_16x16x32_bf16 v[48:51], v[16:19], v[20:23], v[48:51]
    ds_read_b128 v[24:27], v3 offset:10240
    s_waitcnt lgkmcnt(0)
    v_mfma_f32_16x16x32_bf16 v[52:55], v[16:19], v[24:27], v[52:55]
    s_nop 7
    buffer_load_dwordx4 v[16:19], v32, s[8:11], s33 offen offset:384
    s_waitcnt vmcnt(0)
    v_mfma_f32_16x16x32_bf16 v[36:39], v[16:19], v[120:123], v[36:39]
    v_mfma_f32_16x16x32_bf16 v[40:43], v[16:19], v[148:151], v[40:43]
    ds_read_b128 v[28:31], v3 offset:13312
    s_waitcnt lgkmcnt(0)
    v_mfma_f32_16x16x32_bf16 v[44:47], v[16:19], v[28:31], v[44:47]
    ds_read_b128 v[20:23], v3 offset:3072
    s_waitcnt lgkmcnt(0)
    v_mfma_f32_16x16x32_bf16 v[48:51], v[16:19], v[20:23], v[48:51]
    ds_read_b128 v[24:27], v3 offset:11264
    s_waitcnt lgkmcnt(0)
    v_mfma_f32_16x16x32_bf16 v[52:55], v[16:19], v[24:27], v[52:55]
    s_nop 7
    buffer_load_dwordx4 v[16:19], v32, s[8:11], s33 offen offset:448
    s_waitcnt vmcnt(0)
    v_mfma_f32_16x16x32_bf16 v[36:39], v[16:19], v[124:127], v[36:39]
    v_mfma_f32_16x16x32_bf16 v[40:43], v[16:19], v[152:155], v[40:43]
    ds_read_b128 v[28:31], v3 offset:14336
    s_waitcnt lgkmcnt(0)
    v_mfma_f32_16x16x32_bf16 v[44:47], v[16:19], v[28:31], v[44:47]
    ds_read_b128 v[20:23], v3 offset:4096
    s_waitcnt lgkmcnt(0)
    v_mfma_f32_16x16x32_bf16 v[48:51], v[16:19], v[20:23], v[48:51]
    ds_read_b128 v[24:27], v3 offset:12288
    s_waitcnt lgkmcnt(0)
    v_mfma_f32_16x16x32_bf16 v[52:55], v[16:19], v[24:27], v[52:55]
    s_nop 7
    s_sub_u32 s33, s23, 40960
    buffer_load_dwordx4 v[16:19], v32, s[8:11], s33 offen offset:0
    s_waitcnt vmcnt(0)
    v_mfma_f32_16x16x32_bf16 v[76:79], v[16:19], v[96:99], 0
    v_mfma_f32_16x16x32_bf16 v[80:83], v[16:19], v[128:131], 0
    v_mfma_f32_16x16x32_bf16 v[84:87], v[16:19], v[156:159], 0
    v_mfma_f32_16x16x32_bf16 v[88:91], v[16:19], v[168:171], 0
    v_mfma_f32_16x16x32_bf16 v[92:95], v[16:19], v[180:183], 0
    s_nop 7
    buffer_load_dwordx4 v[16:19], v32, s[8:11], s33 offen offset:64
    s_waitcnt vmcnt(0)
    v_mfma_f32_16x16x32_bf16 v[76:79], v[16:19], v[100:103], v[76:79]
    v_mfma_f32_16x16x32_bf16 v[80:83], v[16:19], v[132:135], v[80:83]
    v_mfma_f32_16x16x32_bf16 v[84:87], v[16:19], v[160:163], v[84:87]
    v_mfma_f32_16x16x32_bf16 v[88:91], v[16:19], v[172:175], v[88:91]
    v_mfma_f32_16x16x32_bf16 v[92:95], v[16:19], v[184:187], v[92:95]
    s_nop 7
    buffer_load_dwordx4 v[16:19], v32, s[8:11], s33 offen offset:128
    s_waitcnt vmcnt(0)
    v_mfma_f32_16x16x32_bf16 v[76:79], v[16:19], v[104:107], v[76:79]
    v_mfma_f32_16x16x32_bf16 v[80:83], v[16:19], v[136:139], v[80:83]
    v_mfma_f32_16x16x32_bf16 v[84:87], v[16:19], v[164:167], v[84:87]
    v_mfma_f32_16x16x32_bf16 v[88:91], v[16:19], v[176:179], v[88:91]
    v_mfma_f32_16x16x32_bf16 v[92:95], v[16:19], v[188:191], v[92:95]
    s_nop 7
    buffer_load_dwordx4 v[16:19], v32, s[8:11], s33 offen offset:192
    s_waitcnt vmcnt(0)
    v_mfma_f32_16x16x32_bf16 v[76:79], v[16:19], v[108:111], v[76:79]
    ds_read_b128 v[24:27], v3 offset:15360
    s_waitcnt lgkmcnt(0)
    v_mfma_f32_16x16x32_bf16 v[80:83], v[16:19], v[24:27], v[80:83]
    ds_read_b128 v[28:31], v3 offset:5120
    s_waitcnt lgkmcnt(0)
    v_mfma_f32_16x16x32_bf16 v[84:87], v[16:19], v[28:31], v[84:87]
    ds_read_b128 v[20:23], v3 offset:0
    s_waitcnt lgkmcnt(0)
    v_mfma_f32_16x16x32_bf16 v[88:91], v[16:19], v[20:23], v[88:91]
    ds_read_b128 v[24:27], v3 offset:8192
    s_waitcnt lgkmcnt(0)
    v_mfma_f32_16x16x32_bf16 v[92:95], v[16:19], v[24:27], v[92:95]
    s_nop 7
    buffer_load_dwordx4 v[16:19], v32, s[8:11], s33 offen offset:256
    s_waitcnt vmcnt(0)
    v_mfma_f32_16x16x32_bf16 v[76:79], v[16:19], v[112:115], v[76:79]
    v_mfma_f32_16x16x32_bf16 v[80:83], v[16:19], v[140:143], v[80:83]
    ds_read_b128 v[28:31], v3 offset:6144
    s_waitcnt lgkmcnt(0)
    v_mfma_f32_16x16x32_bf16 v[84:87], v[16:19], v[28:31], v[84:87]
    ds_read_b128 v[20:23], v3 offset:1024
    s_waitcnt lgkmcnt(0)
    v_mfma_f32_16x16x32_bf16 v[88:91], v[16:19], v[20:23], v[88:91]
    ds_read_b128 v[24:27], v3 offset:9216
    s_waitcnt lgkmcnt(0)
    v_mfma_f32_16x16x32_bf16 v[92:95], v[16:19], v[24:27], v[92:95]
    s_nop 7
    buffer_load_dwordx4 v[16:19], v32, s[8:11], s33 offen offset:320
    s_waitcnt vmcnt(0)
    v_mfma_f32_16x16x32_bf16 v[76:79], v[16:19], v[116:119], v[76:79]
    v_mfma_f32_16x16x32_bf16 v[80:83], v[16:19], v[144:147], v[80:83]
    ds_read_b128 v[28:31], v3 offset:7168
    s_waitcnt lgkmcnt(0)
    v_mfma_f32_16x16x32_bf16 v[84:87], v[16:19], v[28:31], v[84:87]
    ds_read_b128 v[20:23], v3 offset:2048
    s_waitcnt lgkmcnt(0)
    v_mfma_f32_16x16x32_bf16 v[88:91], v[16:19], v[20:23], v[88:91]
    ds_read_b128 v[24:27], v3 offset:10240
    s_waitcnt lgkmcnt(0)
    v_mfma_f32_16x16x32_bf16 v[92:95], v[16:19], v[24:27], v[92:95]
    s_nop 7
    buffer_load_dwordx4 v[16:19], v32, s[8:11], s33 offen offset:384
    s_waitcnt vmcnt(0)
    v_mfma_f32_16x16x32_bf16 v[76:79], v[16:19], v[120:123], v[76:79]
    v_mfma_f32_16x16x32_bf16 v[80:83], v[16:19], v[148:151], v[80:83]
    ds_read_b128 v[28:31], v3 offset:13312
    s_waitcnt lgkmcnt(0)
    v_mfma_f32_16x16x32_bf16 v[84:87], v[16:19], v[28:31], v[84:87]
    ds_read_b128 v[20:23], v3 offset:3072
    s_waitcnt lgkmcnt(0)
    v_mfma_f32_16x16x32_bf16 v[88:91], v[16:19], v[20:23], v[88:91]
    ds_read_b128 v[24:27], v3 offset:11264
    s_waitcnt lgkmcnt(0)
    v_mfma_f32_16x16x32_bf16 v[92:95], v[16:19], v[24:27], v[92:95]
    s_nop 7
    buffer_load_dwordx4 v[16:19], v32, s[8:11], s33 offen offset:448
    s_waitcnt vmcnt(0)
    v_mfma_f32_16x16x32_bf16 v[76:79], v[16:19], v[124:127], v[76:79]
    v_mfma_f32_16x16x32_bf16 v[80:83], v[16:19], v[152:155], v[80:83]
    ds_read_b128 v[28:31], v3 offset:14336
    s_waitcnt lgkmcnt(0)
    v_mfma_f32_16x16x32_bf16 v[84:87], v[16:19], v[28:31], v[84:87]
    ds_read_b128 v[20:23], v3 offset:4096
    s_waitcnt lgkmcnt(0)
    v_mfma_f32_16x16x32_bf16 v[88:91], v[16:19], v[20:23], v[88:91]
    ds_read_b128 v[24:27], v3 offset:12288
    s_waitcnt lgkmcnt(0)
    v_mfma_f32_16x16x32_bf16 v[92:95], v[16:19], v[24:27], v[92:95]
    s_nop 7
    s_nop 7
    v_max3_f32 v32, v36, v37, v38
    v_max3_f32 v32, v32, v39, v76
    v_max3_f32 v32, v32, v77, v78
    v_max_f32 v32, v32, v79
    v_mov_b32 v33, v32
    v_mov_b32 v34, v32
    s_nop 1
    v_permlane32_swap_b32 v33, v34
    s_nop 1
    v_max_f32 v32, v33, v34
    v_mov_b32 v33, v32
    v_mov_b32 v34, v32
    s_nop 1
    v_permlane16_swap_b32 v33, v34
    s_nop 1
    v_max_f32 v32, v33, v34
    v_max_f32 v32, v32, v6
    v_sub_f32 v16, v6, v32
    v_exp_f32 v16, v16
    v_mov_b32 v6, v32
    v_mul_f32 v11, v11, v16
    v_max3_f32 v32, v40, v41, v42
    v_max3_f32 v32, v32, v43, v80
    v_max3_f32 v32, v32, v81, v82
    v_max_f32 v32, v32, v83
    v_mov_b32 v33, v32
    v_mov_b32 v34, v32
    s_nop 1
    v_permlane32_swap_b32 v33, v34
    s_nop 1
    v_max_f32 v32, v33, v34
    v_mov_b32 v33, v32
    v_mov_b32 v34, v32
    s_nop 1
    v_permlane16_swap_b32 v33, v34
    s_nop 1
    v_max_f32 v32, v33, v34
    v_max_f32 v32, v32, v7
    v_sub_f32 v17, v7, v32
    v_exp_f32 v17, v17
    v_mov_b32 v7, v32
    v_mul_f32 v12, v12, v17
    v_max3_f32 v32, v44, v45, v46
    v_max3_f32 v32, v32, v47, v84
    v_max3_f32 v32, v32, v85, v86
    v_max_f32 v32, v32, v87
    v_mov_b32 v33, v32
    v_mov_b32 v34, v32
    s_nop 1
    v_permlane32_swap_b32 v33, v34
    s_nop 1
    v_max_f32 v32, v33, v34
    v_mov_b32 v33, v32
    v_mov_b32 v34, v32
    s_nop 1
    v_permlane16_swap_b32 v33, v34
    s_nop 1
    v_max_f32 v32, v33, v34
    v_max_f32 v32, v32, v8
    v_sub_f32 v18, v8, v32
    v_exp_f32 v18, v18
    v_mov_b32 v8, v32
    v_mul_f32 v13, v13, v18
    v_max3_f32 v32, v48, v49, v50
    v_max3_f32 v32, v32, v51, v88
    v_max3_f32 v32, v32, v89, v90
    v_max_f32 v32, v32, v91
    v_mov_b32 v33, v32
    v_mov_b32 v34, v32
    s_nop 1
    v_permlane32_swap_b32 v33, v34
    s_nop 1
    v_max_f32 v32, v33, v34
    v_mov_b32 v33, v32
    v_mov_b32 v34, v32
    s_nop 1
    v_permlane16_swap_b32 v33, v34
    s_nop 1
    v_max_f32 v32, v33, v34
    v_max_f32 v32, v32, v9
    v_sub_f32 v19, v9, v32
    v_exp_f32 v19, v19
    v_mov_b32 v9, v32
    v_mul_f32 v14, v14, v19
    v_max3_f32 v32, v52, v53, v54
    v_max3_f32 v32, v32, v55, v92
    v_max3_f32 v32, v32, v93, v94
    v_max_f32 v32, v32, v95
    v_mov_b32 v33, v32
    v_mov_b32 v34, v32
    s_nop 1
    v_permlane32_swap_b32 v33, v34
    s_nop 1
    v_max_f32 v32, v33, v34
    v_mov_b32 v33, v32
    v_mov_b32 v34, v32
    s_nop 1
    v_permlane16_swap_b32 v33, v34
    s_nop 1
    v_max_f32 v32, v33, v34
    v_max_f32 v32, v32, v10
    v_sub_f32 v20, v10, v32
    v_exp_f32 v20, v20
    v_mov_b32 v10, v32
    v_mul_f32 v15, v15, v20
    v_sub_f32 v36, v36, v6
    v_exp_f32 v36, v36
    v_sub_f32 v37, v37, v6
    v_exp_f32 v37, v37
    v_sub_f32 v38, v38, v6
    v_exp_f32 v38, v38
    v_sub_f32 v39, v39, v6
    v_exp_f32 v39, v39
    v_add_f32 v5, v36, v37
    v_cvt_pk_bf16_f32 v36, v36, v37
    v_cvt_pk_bf16_f32 v37, v38, v39
    v_add_f32 v38, v38, v39
    v_add_f32 v38, v38, v5
    v_sub_f32 v40, v40, v7
    v_exp_f32 v40, v40
    v_sub_f32 v41, v41, v7
    v_exp_f32 v41, v41
    v_sub_f32 v42, v42, v7
    v_exp_f32 v42, v42
    v_sub_f32 v43, v43, v7
    v_exp_f32 v43, v43
    v_add_f32 v5, v40, v41
    v_cvt_pk_bf16_f32 v40, v40, v41
    v_cvt_pk_bf16_f32 v41, v42, v43
    v_add_f32 v42, v42, v43
    v_add_f32 v42, v42, v5
    v_sub_f32 v44, v44, v8
    v_exp_f32 v44, v44
    v_sub_f32 v45, v45, v8
    v_exp_f32 v45, v45
    v_sub_f32 v46, v46, v8
    v_exp_f32 v46, v46
    v_sub_f32 v47, v47, v8
    v_exp_f32 v47, v47
    v_add_f32 v5, v44, v45
    v_cvt_pk_bf16_f32 v44, v44, v45
    v_cvt_pk_bf16_f32 v45, v46, v47
    v_add_f32 v46, v46, v47
    v_add_f32 v46, v46, v5
    v_sub_f32 v48, v48, v9
    v_exp_f32 v48, v48
    v_sub_f32 v49, v49, v9
    v_exp_f32 v49, v49
    v_sub_f32 v50, v50, v9
    v_exp_f32 v50, v50
    v_sub_f32 v51, v51, v9
    v_exp_f32 v51, v51
    v_add_f32 v5, v48, v49
    v_cvt_pk_bf16_f32 v48, v48, v49
    v_cvt_pk_bf16_f32 v49, v50, v51
    v_add_f32 v50, v50, v51
    v_add_f32 v50, v50, v5
    v_sub_f32 v52, v52, v10
    v_exp_f32 v52, v52
    v_sub_f32 v53, v53, v10
    v_exp_f32 v53, v53
    v_sub_f32 v54, v54, v10
    v_exp_f32 v54, v54
    v_sub_f32 v55, v55, v10
    v_exp_f32 v55, v55
    v_add_f32 v5, v52, v53
    v_cvt_pk_bf16_f32 v52, v52, v53
    v_cvt_pk_bf16_f32 v53, v54, v55
    v_add_f32 v54, v54, v55
    v_add_f32 v54, v54, v5
    v_sub_f32 v76, v76, v6
    v_exp_f32 v76, v76
    v_sub_f32 v77, v77, v6
    v_exp_f32 v77, v77
    v_sub_f32 v78, v78, v6
    v_exp_f32 v78, v78
    v_sub_f32 v79, v79, v6
    v_exp_f32 v79, v79
    v_add_f32 v39, v38, v76
    v_cvt_pk_bf16_f32 v38, v76, v77
    v_add_f32 v76, v39, v77
    v_add_f32 v76, v76, v78
    v_cvt_pk_bf16_f32 v39, v78, v79
    v_add_f32 v76, v76, v79
    v_sub_f32 v80, v80, v7
    v_exp_f32 v80, v80
    v_sub_f32 v81, v81, v7
    v_exp_f32 v81, v81
    v_sub_f32 v82, v82, v7
    v_exp_f32 v82, v82
    v_sub_f32 v83, v83, v7
    v_exp_f32 v83, v83
    v_add_f32 v43, v42, v80
    v_cvt_pk_bf16_f32 v42, v80, v81
    v_add_f32 v80, v43, v81
    v_add_f32 v80, v80, v82
    v_cvt_pk_bf16_f32 v43, v82, v83
    v_add_f32 v80, v80, v83
    v_sub_f32 v84, v84, v8
    v_exp_f32 v84, v84
    v_sub_f32 v85, v85, v8
    v_exp_f32 v85, v85
    v_sub_f32 v86, v86, v8
    v_exp_f32 v86, v86
    v_sub_f32 v87, v87, v8
    v_exp_f32 v87, v87
    v_add_f32 v47, v46, v84
    v_cvt_pk_bf16_f32 v46, v84, v85
    v_add_f32 v84, v47, v85
    v_add_f32 v84, v84, v86
    v_cvt_pk_bf16_f32 v47, v86, v87
    v_add_f32 v84, v84, v87
    v_sub_f32 v88, v88, v9
    v_exp_f32 v88, v88
    v_sub_f32 v89, v89, v9
    v_exp_f32 v89, v89
    v_sub_f32 v90, v90, v9
    v_exp_f32 v90, v90
    v_sub_f32 v91, v91, v9
    v_exp_f32 v91, v91
    v_add_f32 v51, v50, v88
    v_cvt_pk_bf16_f32 v50, v88, v89
    v_add_f32 v88, v51, v89
    v_add_f32 v88, v88, v90
    v_cvt_pk_bf16_f32 v51, v90, v91
    v_add_f32 v88, v88, v91
    v_sub_f32 v92, v92, v10
    v_exp_f32 v92, v92
    v_sub_f32 v93, v93, v10
    v_exp_f32 v93, v93
    v_sub_f32 v94, v94, v10
    v_exp_f32 v94, v94
    v_sub_f32 v95, v95, v10
    v_exp_f32 v95, v95
    v_add_f32 v55, v54, v92
    v_cvt_pk_bf16_f32 v54, v92, v93
    v_add_f32 v92, v55, v93
    v_add_f32 v92, v92, v94
    v_cvt_pk_bf16_f32 v55, v94, v95
    v_add_f32 v92, v92, v95
    s_mov_b32 s32, 2
    s_branch L_rescale
L_backC:
    ds_read_b128 v[32:35], v0 offset:0
    ds_read_b128 v[16:19], v1 offset:0
    ds_read_b128 v[20:23], v0 offset:1024
    ds_read_b128 v[24:27], v0 offset:8192
    ds_read_b128 v[28:31], v1 offset:8192
    s_waitcnt lgkmcnt(0)
    s_nop 3
    s_branch L_retC
L_slowF:
    s_waitcnt vmcnt(0) lgkmcnt(0)
    s_nop 7
    v_mbcnt_lo_u32_b32 v32, -1, 0
    v_mbcnt_hi_u32_b32 v32, -1, v32
    v_and_b32 v33, 15, v32
    v_lshrrev_b32 v32, 4, v32
    v_lshlrev_b32 v35, 4, v32
    v_lshl_add_u32 v32, v33, 9, v35
    s_sub_u32 s33, s23, 49152
    buffer_load_dwordx4 v[16:19], v32, s[8:11], s33 offen offset:0
    s_waitcnt vmcnt(0)
    v_mfma_f32_16x16x32_bf16 v[56:59], v[16:19], v[96:99], 0
    v_mfma_f32_16x16x32_bf16 v[60:63], v[16:19], v[128:131], 0
    v_mfma_f32_16x16x32_bf16 v[64:67], v[16:19], v[156:159], 0
    v_mfma_f32_16x16x32_bf16 v[68:71], v[16:19], v[168:171], 0
    v_mfma_f32_16x16x32_bf16 v[72:75], v[16:19], v[180:183], 0
    s_nop 7
    buffer_load_dwordx4 v[16:19], v32, s[8:11], s33 offen offset:64
    s_waitcnt vmcnt(0)
    v_mfma_f32_16x16x32_bf16 v[56:59], v[16:19], v[100:103], v[56:59]
    v_mfma_f32_16x16x32_bf16 v[60:63], v[16:19], v[132:135], v[60:63]
    v_mfma_f32_16x16x32_bf16 v[64:67], v[16:19], v[160:163], v[64:67]
    v_mfma_f32_16x16x32_bf16 v[68:71], v[16:19], v[172:175], v[68:71]
    v_mfma_f32_16x16x32_bf16 v[72:75], v[16:19], v[184:187], v[72:75]
    s_nop 7
    buffer_load_dwordx4 v[16:19], v32, s[8:11], s33 offen offset:128
    s_waitcnt vmcnt(0)
    v_mfma_f32_16x16x32_bf16 v[56:59], v[16:19], v[104:107], v[56:59]
    v_mfma_f32_16x16x32_bf16 v[60:63], v[16:19], v[136:139], v[60:63]
    v_mfma_f32_16x16x32_bf16 v[64:67], v[16:19], v[164:167], v[64:67]
    v_mfma_f32_16x16x32_bf16 v[68:71], v[16:19], v[176:179], v[68:71]
    v_mfma_f32_16x16x32_bf16 v[72:75], v[16:19], v[188:191], v[72:75]
    s_nop 7
    buffer_load_dwordx4 v[16:19], v32, s[8:11], s33 offen offset:192
    s_waitcnt vmcnt(0)
    v_mfma_f32_16x16x32_bf16 v[56:59], v[16:19], v[108:111], v[56:59]
    ds_read_b128 v[24:27], v3 offset:15360
    s_waitcnt lgkmcnt(0)
    v_mfma_f32_16x16x32_bf16 v[60:63], v[16:19], v[24:27], v[60:63]
    ds_read_b128 v[28:31], v3 offset:5120
    s_waitcnt lgkmcnt(0)
    v_mfma_f32_16x16x32_bf16 v[64:67], v[16:19], v[28:31], v[64:67]
    ds_read_b128 v[20:23], v3 offset:0
    s_waitcnt lgkmcnt(0)
    v_mfma_f32_16x16x32_bf16 v[68:71], v[16:19], v[20:23], v[68:71]
    ds_read_b128 v[24:27], v3 offset:8192
    s_waitcnt lgkmcnt(0)
    v_mfma_f32_16x16x32_bf16 v[72:75], v[16:19], v[24:27], v[72:75]
    s_nop 7
    buffer_load_dwordx4 v[16:19], v32, s[8:11], s33 offen offset:256
    s_waitcnt vmcnt(0)
    v_mfma_f32_16x16x32_bf16 v[56:59], v[16:19], v[112:115], v[56:59]
    v_mfma_f32_16x16x32_bf16 v[60:63], v[16:19], v[140:143], v[60:63]
    ds_read_b128 v[28:31], v3 offset:6144
    s_waitcnt lgkmcnt(0)
    v_mfma_f32_16x16x32_bf16 v[64:67], v[16:19], v[28:31], v[64:67]
    ds_read_b128 v[20:23], v3 offset:1024
    s_waitcnt lgkmcnt(0)
    v_mfma_f32_16x16x32_bf16 v[68:71], v[16:19], v[20:23], v[68:71]
    ds_read_b128 v[24:27], v3 offset:9216
    s_waitcnt lgkmcnt(0)
    v_mfma_f32_16x16x32_bf16 v[72:75], v[16:19], v[24:27], v[72:75]
    s_nop 7
    buffer_load_dwordx4 v[16:19], v32, s[8:11], s33 offen offset:320
    s_waitcnt vmcnt(0)
    v_mfma_f32_16x16x32_bf16 v[56:59], v[16:19], v[116:119], v[56:59]
    v_mfma_f32_16x16x32_bf16 v[60:63], v[16:19], v[144:147], v[60:63]
    ds_read_b128 v[28:31], v3 offset:7168
    s_waitcnt lgkmcnt(0)
    v_mfma_f32_16x16x32_bf16 v[64:67], v[16:19], v[28:31], v[64:67]
    ds_read_b128 v[20:23], v3 offset:2048
    s_waitcnt lgkmcnt(0)
    v_mfma_f32_16x16x32_bf16 v[68:71], v[16:19], v[20:23], v[68:71]
    ds_read_b128 v[24:27], v3 offset:10240
    s_waitcnt lgkmcnt(0)
    v_mfma_f32_16x16x32_bf16 v[72:75], v[16:19], v[24:27], v[72:75]
    s_nop 7
    buffer_load_dwordx4 v[16:19], v32, s[8:11], s33 offen offset:384
    s_waitcnt vmcnt(0)
    v_mfma_f32_16x16x32_bf16 v[56:59], v[16:19], v[120:123], v[56:59]
    v_mfma_f32_16x16x32_bf16 v[60:63], v[16:19], v[148:151], v[60:63]
    ds_read_b128 v[28:31], v3 offset:13312
    s_waitcnt lgkmcnt(0)
    v_mfma_f32_16x16x32_bf16 v[64:67], v[16:19], v[28:31], v[64:67]
    ds_read_b128 v[20:23], v3 offset:3072
    s_waitcnt lgkmcnt(0)
    v_mfma_f32_16x16x32_bf16 v[68:71], v[16:19], v[20:23], v[68:71]
    ds_read_b128 v[24:27], v3 offset:11264
    s_waitcnt lgkmcnt(0)
    v_mfma_f32_16x16x32_bf16 v[72:75], v[16:19], v[24:27], v[72:75]
    s_nop 7
    buffer_load_dwordx4 v[16:19], v32, s[8:11], s33 offen offset:448
    s_waitcnt vmcnt(0)
    v_mfma_f32_16x16x32_bf16 v[56:59], v[16:19], v[124:127], v[56:59]
    v_mfma_f32_16x16x32_bf16 v[60:63], v[16:19], v[152:155], v[60:63]
    ds_read_b128 v[28:31], v3 offset:14336
    s_waitcnt lgkmcnt(0)
    v_mfma_f32_16x16x32_bf16 v[64:67], v[16:19], v[28:31], v[64:67]
    ds_read_b128 v[20:23], v3 offset:4096
    s_waitcnt lgkmcnt(0)
    v_mfma_f32_16x16x32_bf16 v[68:71], v[16:19], v[20:23], v[68:71]
    ds_read_b128 v[24:27], v3 offset:12288
    s_waitcnt lgkmcnt(0)
    v_mfma_f32_16x16x32_bf16 v[72:75], v[16:19], v[24:27], v[72:75]
    s_nop 7
    s_sub_u32 s33, s23, 40960
    buffer_load_dwordx4 v[16:19], v32, s[8:11], s33 offen offset:0
    s_waitcnt vmcnt(0)
    v_mfma_f32_16x16x32_bf16 v[76:79], v[16:19], v[96:99], 0
    v_mfma_f32_16x16x32_bf16 v[80:83], v[16:19], v[128:131], 0
    v_mfma_f32_16x16x32_bf16 v[84:87], v[16:19], v[156:159], 0
    v_mfma_f32_16x16x32_bf16 v[88:91], v[16:19], v[168:171], 0
    v_mfma_f32_16x16x32_bf16 v[92:95], v[16:19], v[180:183], 0
    s_nop 7
    buffer_load_dwordx4 v[16:19], v32, s[8:11], s33 offen offset:64
    s_waitcnt vmcnt(0)
    v_mfma_f32_16x16x32_bf16 v[76:79], v[16:19], v[100:103], v[76:79]
    v_mfma_f32_16x16x32_bf16 v[80:83], v[16:19], v[132:135], v[80:83]
    v_mfma_f32_16x16x32_bf16 v[84:87], v[16:19], v[160:163], v[84:87]
    v_mfma_f32_16x16x32_bf16 v[88:91], v[16:19], v[172:175], v[88:91]
    v_mfma_f32_16x16x32_bf16 v[92:95], v[16:19], v[184:187], v[92:95]
    s_nop 7
    buffer_load_dwordx4 v[16:19], v32, s[8:11], s33 offen offset:128
    s_waitcnt vmcnt(0)
    v_mfma_f32_16x16x32_bf16 v[76:79], v[16:19], v[104:107], v[76:79]
    v_mfma_f32_16x16x32_bf16 v[80:83], v[16:19], v[136:139], v[80:83]
    v_mfma_f32_16x16x32_bf16 v[84:87], v[16:19], v[164:167], v[84:87]
    v_mfma_f32_16x16x32_bf16 v[88:91], v[16:19], v[176:179], v[88:91]
    v_mfma_f32_16x16x32_bf16 v[92:95], v[16:19], v[188:191], v[92:95]
    s_nop 7
    buffer_load_dwordx4 v[16:19], v32, s[8:11], s33 offen offset:192
    s_waitcnt vmcnt(0)
    v_mfma_f32_16x16x32_bf16 v[76:79], v[16:19], v[108:111], v[76:79]
    ds_read_b128 v[24:27], v3 offset:15360
    s_waitcnt lgkmcnt(0)
    v_mfma_f32_16x16x32_bf16 v[80:83], v[16:19], v[24:27], v[80:83]
    ds_read_b128 v[28:31], v3 offset:5120
    s_waitcnt lgkmcnt(0)
    v_mfma_f32_16x16x32_bf16 v[84:87], v[16:19], v[28:31], v[84:87]
    ds_read_b128 v[20:23], v3 offset:0
    s_waitcnt lgkmcnt(0)
    v_mfma_f32_16x16x32_bf16 v[88:91], v[16:19], v[20:23], v[88:91]
    ds_read_b128 v[24:27], v3 offset:8192
    s_waitcnt lgkmcnt(0)
    v_mfma_f32_16x16x32_bf16 v[92:95], v[16:19], v[24:27], v[92:95]
    s_nop 7
    buffer_load_dwordx4 v[16:19], v32, s[8:11], s33 offen offset:256
    s_waitcnt vmcnt(0)
    v_mfma_f32_16x16x32_bf16 v[76:79], v[16:19], v[112:115], v[76:79]
    v_mfma_f32_16x16x32_bf16 v[80:83], v[16:19], v[140:143], v[80:83]
    ds_read_b128 v[28:31], v3 offset:6144
    s_waitcnt lgkmcnt(0)
    v_mfma_f32_16x16x32_bf16 v[84:87], v[16:19], v[28:31], v[84:87]
    ds_read_b128 v[20:23], v3 offset:1024
    s_waitcnt lgkmcnt(0)
    v_mfma_f32_16x16x32_bf16 v[88:91], v[16:19], v[20:23], v[88:91]
    ds_read_b128 v[24:27], v3 offset:9216
    s_waitcnt lgkmcnt(0)
    v_mfma_f32_16x16x32_bf16 v[92:95], v[16:19], v[24:27], v[92:95]
    s_nop 7
    buffer_load_dwordx4 v[16:19], v32, s[8:11], s33 offen offset:320
    s_waitcnt vmcnt(0)
    v_mfma_f32_16x16x32_bf16 v[76:79], v[16:19], v[116:119], v[76:79]
    v_mfma_f32_16x16x32_bf16 v[80:83], v[16:19], v[144:147], v[80:83]
    ds_read_b128 v[28:31], v3 offset:7168
    s_waitcnt lgkmcnt(0)
    v_mfma_f32_16x16x32_bf16 v[84:87], v[16:19], v[28:31], v[84:87]
    ds_read_b128 v[20:23], v3 offset:2048
    s_waitcnt lgkmcnt(0)
    v_mfma_f32_16x16x32_bf16 v[88:91], v[16:19], v[20:23], v[88:91]
    ds_read_b128 v[24:27], v3 offset:10240
    s_waitcnt lgkmcnt(0)
    v_mfma_f32_16x16x32_bf16 v[92:95], v[16:19], v[24:27], v[92:95]
    s_nop 7
    buffer_load_dwordx4 v[16:19], v32, s[8:11], s33 offen offset:384
    s_waitcnt vmcnt(0)
    v_mfma_f32_16x16x32_bf16 v[76:79], v[16:19], v[120:123], v[76:79]
    v_mfma_f32_16x16x32_bf16 v[80:83], v[16:19], v[148:151], v[80:83]
    ds_read_b128 v[28:31], v3 offset:13312
    s_waitcnt lgkmcnt(0)
    v_mfma_f32_16x16x32_bf16 v[84:87], v[16:19], v[28:31], v[84:87]
    ds_read_b128 v[20:23], v3 offset:3072
    s_waitcnt lgkmcnt(0)
    v_mfma_f32_16x16x32_bf16 v[88:91], v[16:19], v[20:23], v[88:91]
    ds_read_b128 v[24:27], v3 offset:11264
    s_waitcnt lgkmcnt(0)
    v_mfma_f32_16x16x32_bf16 v[92:95], v[16:19], v[24:27], v[92:95]
    s_nop 7
    buffer_load_dwordx4 v[16:19], v32, s[8:11], s33 offen offset:448
    s_waitcnt vmcnt(0)
    v_mfma_f32_16x16x32_bf16 v[76:79], v[16:19], v[124:127], v[76:79]
    v_mfma_f32_16x16x32_bf16 v[80:83], v[16:19], v[152:155], v[80:83]
    ds_read_b128 v[28:31], v3 offset:14336
    s_waitcnt lgkmcnt(0)
    v_mfma_f32_16x16x32_bf16 v[84:87], v[16:19], v[28:31], v[84:87]
    ds_read_b128 v[20:23], v3 offset:4096
    s_waitcnt lgkmcnt(0)
    v_mfma_f32_16x16x32_bf16 v[88:91], v[16:19], v[20:23], v[88:91]
    ds_read_b128 v[24:27], v3 offset:12288
    s_waitcnt lgkmcnt(0)
    v_mfma_f32_16x16x32_bf16 v[92:95], v[16:19], v[24:27], v[92:95]
    s_nop 7
    s_nop 7
    v_max3_f32 v32, v56, v57, v58
    v_max3_f32 v32, v32, v59, v76
    v_max3_f32 v32, v32, v77, v78
    v_max_f32 v32, v32, v79
    v_mov_b32 v33, v32
    v_mov_b32 v34, v32
    s_nop 1
    v_permlane32_swap_b32 v33, v34
    s_nop 1
    v_max_f32 v32, v33, v34
    v_mov_b32 v33, v32
    v_mov_b32 v34, v32
    s_nop 1
    v_permlane16_swap_b32 v33, v34
    s_nop 1
    v_max_f32 v32, v33, v34
    v_max_f32 v32, v32, v6
    v_sub_f32 v16, v6, v32
    v_exp_f32 v16, v16
    v_mov_b32 v6, v32
    v_mul_f32 v11, v11, v16
    v_max3_f32 v32, v60, v61, v62
    v_max3_f32 v32, v32, v63, v80
    v_max3_f32 v32, v32, v81, v82
    v_max_f32 v32, v32, v83
    v_mov_b32 v33, v32
    v_mov_b32 v34, v32
    s_nop 1
    v_permlane32_swap_b32 v33, v34
    s_nop 1
    v_max_f32 v32, v33, v34
    v_mov_b32 v33, v32
    v_mov_b32 v34, v32
    s_nop 1
    v_permlane16_swap_b32 v33, v34
    s_nop 1
    v_max_f32 v32, v33, v34
    v_max_f32 v32, v32, v7
    v_sub_f32 v17, v7, v32
    v_exp_f32 v17, v17
    v_mov_b32 v7, v32
    v_mul_f32 v12, v12, v17
    v_max3_f32 v32, v64, v65, v66
    v_max3_f32 v32, v32, v67, v84
    v_max3_f32 v32, v32, v85, v86
    v_max_f32 v32, v32, v87
    v_mov_b32 v33, v32
    v_mov_b32 v34, v32
    s_nop 1
    v_permlane32_swap_b32 v33, v34
    s_nop 1
    v_max_f32 v32, v33, v34
    v_mov_b32 v33, v32
    v_mov_b32 v34, v32
    s_nop 1
    v_permlane16_swap_b32 v33, v34
    s_nop 1
    v_max_f32 v32, v33, v34
    v_max_f32 v32, v32, v8
    v_sub_f32 v18, v8, v32
    v_exp_f32 v18, v18
    v_mov_b32 v8, v32
    v_mul_f32 v13, v13, v18
    v_max3_f32 v32, v68, v69, v70
    v_max3_f32 v32, v32, v71, v88
    v_max3_f32 v32, v32, v89, v90
    v_max_f32 v32, v32, v91
    v_mov_b32 v33, v32
    v_mov_b32 v34, v32
    s_nop 1
    v_permlane32_swap_b32 v33, v34
    s_nop 1
    v_max_f32 v32, v33, v34
    v_mov_b32 v33, v32
    v_mov_b32 v34, v32
    s_nop 1
    v_permlane16_swap_b32 v33, v34
    s_nop 1
    v_max_f32 v32, v33, v34
    v_max_f32 v32, v32, v9
    v_sub_f32 v19, v9, v32
    v_exp_f32 v19, v19
    v_mov_b32 v9, v32
    v_mul_f32 v14, v14, v19
    v_max3_f32 v32, v72, v73, v74
    v_max3_f32 v32, v32, v75, v92
    v_max3_f32 v32, v32, v93, v94
    v_max_f32 v32, v32, v95
    v_mov_b32 v33, v32
    v_mov_b32 v34, v32
    s_nop 1
    v_permlane32_swap_b32 v33, v34
    s_nop 1
    v_max_f32 v32, v33, v34
    v_mov_b32 v33, v32
    v_mov_b32 v34, v32
    s_nop 1
    v_permlane16_swap_b32 v33, v34
    s_nop 1
    v_max_f32 v32, v33, v34
    v_max_f32 v32, v32, v10
    v_sub_f32 v20, v10, v32
    v_exp_f32 v20, v20
    v_mov_b32 v10, v32
    v_mul_f32 v15, v15, v20
    v_sub_f32 v56, v56, v6
    v_exp_f32 v56, v56
    v_sub_f32 v57, v57, v6
    v_exp_f32 v57, v57
    v_sub_f32 v58, v58, v6
    v_exp_f32 v58, v58
    v_sub_f32 v59, v59, v6
    v_exp_f32 v59, v59
    v_add_f32 v5, v56, v57
    v_cvt_pk_bf16_f32 v56, v56, v57
    v_cvt_pk_bf16_f32 v57, v58, v59
    v_add_f32 v58, v58, v59
    v_add_f32 v58, v58, v5
    v_sub_f32 v60, v60, v7
    v_exp_f32 v60, v60
    v_sub_f32 v61, v61, v7
    v_exp_f32 v61, v61
    v_sub_f32 v62, v62, v7
    v_exp_f32 v62, v62
    v_sub_f32 v63, v63, v7
    v_exp_f32 v63, v63
    v_add_f32 v5, v60, v61
    v_cvt_pk_bf16_f32 v60, v60, v61
    v_cvt_pk_bf16_f32 v61, v62, v63
    v_add_f32 v62, v62, v63
    v_add_f32 v62, v62, v5
    v_sub_f32 v64, v64, v8
    v_exp_f32 v64, v64
    v_sub_f32 v65, v65, v8
    v_exp_f32 v65, v65
    v_sub_f32 v66, v66, v8
    v_exp_f32 v66, v66
    v_sub_f32 v67, v67, v8
    v_exp_f32 v67, v67
    v_add_f32 v5, v64, v65
    v_cvt_pk_bf16_f32 v64, v64, v65
    v_cvt_pk_bf16_f32 v65, v66, v67
    v_add_f32 v66, v66, v67
    v_add_f32 v66, v66, v5
    v_sub_f32 v68, v68, v9
    v_exp_f32 v68, v68
    v_sub_f32 v69, v69, v9
    v_exp_f32 v69, v69
    v_sub_f32 v70, v70, v9
    v_exp_f32 v70, v70
    v_sub_f32 v71, v71, v9
    v_exp_f32 v71, v71
    v_add_f32 v5, v68, v69
    v_cvt_pk_bf16_f32 v68, v68, v69
    v_cvt_pk_bf16_f32 v69, v70, v71
    v_add_f32 v70, v70, v71
    v_add_f32 v70, v70, v5
    v_sub_f32 v72, v72, v10
    v_exp_f32 v72, v72
    v_sub_f32 v73, v73, v10
    v_exp_f32 v73, v73
    v_sub_f32 v74, v74, v10
    v_exp_f32 v74, v74
    v_sub_f32 v75, v75, v10
    v_exp_f32 v75, v75
    v_add_f32 v5, v72, v73
    v_cvt_pk_bf16_f32 v72, v72, v73
    v_cvt_pk_bf16_f32 v73, v74, v75
    v_add_f32 v74, v74, v75
    v_add_f32 v74, v74, v5
    v_sub_f32 v76, v76, v6
    v_exp_f32 v76, v76
    v_sub_f32 v77, v77, v6
    v_exp_f32 v77, v77
    v_sub_f32 v78, v78, v6
    v_exp_f32 v78, v78
    v_sub_f32 v79, v79, v6
    v_exp_f32 v79, v79
    v_add_f32 v59, v58, v76
    v_cvt_pk_bf16_f32 v58, v76, v77
    v_add_f32 v76, v59, v77
    v_add_f32 v76, v76, v78
    v_cvt_pk_bf16_f32 v59, v78, v79
    v_add_f32 v76, v76, v79
    v_sub_f32 v80, v80, v7
    v_exp_f32 v80, v80
    v_sub_f32 v81, v81, v7
    v_exp_f32 v81, v81
    v_sub_f32 v82, v82, v7
    v_exp_f32 v82, v82
    v_sub_f32 v83, v83, v7
    v_exp_f32 v83, v83
    v_add_f32 v63, v62, v80
    v_cvt_pk_bf16_f32 v62, v80, v81
    v_add_f32 v80, v63, v81
    v_add_f32 v80, v80, v82
    v_cvt_pk_bf16_f32 v63, v82, v83
    v_add_f32 v80, v80, v83
    v_sub_f32 v84, v84, v8
    v_exp_f32 v84, v84
    v_sub_f32 v85, v85, v8
    v_exp_f32 v85, v85
    v_sub_f32 v86, v86, v8
    v_exp_f32 v86, v86
    v_sub_f32 v87, v87, v8
    v_exp_f32 v87, v87
    v_add_f32 v67, v66, v84
    v_cvt_pk_bf16_f32 v66, v84, v85
    v_add_f32 v84, v67, v85
    v_add_f32 v84, v84, v86
    v_cvt_pk_bf16_f32 v67, v86, v87
    v_add_f32 v84, v84, v87
    v_sub_f32 v88, v88, v9
    v_exp_f32 v88, v88
    v_sub_f32 v89, v89, v9
    v_exp_f32 v89, v89
    v_sub_f32 v90, v90, v9
    v_exp_f32 v90, v90
    v_sub_f32 v91, v91, v9
    v_exp_f32 v91, v91
    v_add_f32 v71, v70, v88
    v_cvt_pk_bf16_f32 v70, v88, v89
    v_add_f32 v88, v71, v89
    v_add_f32 v88, v88, v90
    v_cvt_pk_bf16_f32 v71, v90, v91
    v_add_f32 v88, v88, v91
    v_sub_f32 v92, v92, v10
    v_exp_f32 v92, v92
    v_sub_f32 v93, v93, v10
    v_exp_f32 v93, v93
    v_sub_f32 v94, v94, v10
    v_exp_f32 v94, v94
    v_sub_f32 v95, v95, v10
    v_exp_f32 v95, v95
    v_add_f32 v75, v74, v92
    v_cvt_pk_bf16_f32 v74, v92, v93
    v_add_f32 v92, v75, v93
    v_add_f32 v92, v92, v94
    v_cvt_pk_bf16_f32 v75, v94, v95
    v_add_f32 v92, v92, v95
    s_mov_b32 s32, 3
    s_branch L_rescale
L_backF:
    v_xor_b32 v5, 64, v2
    ds_read_b64_tr_b16 v[28:29], v5 offset:0
    v_xor_b32 v5, 64, v2
    ds_read_b64_tr_b16 v[30:31], v5 offset:8192
    v_xor_b32 v5, 96, v2
    ds_read_b64_tr_b16 v[24:25], v5 offset:0
    v_xor_b32 v5, 96, v2
    ds_read_b64_tr_b16 v[26:27], v5 offset:8192
    v_xor_b32 v5, 32, v2
    ds_read_b64_tr_b16 v[16:17], v5 offset:0
    v_xor_b32 v5, 32, v2
    ds_read_b64_tr_b16 v[18:19], v5 offset:8192
    ds_read_b64_tr_b16 v[20:21], v2 offset:0
    ds_read_b64_tr_b16 v[22:23], v2 offset:8192
    s_waitcnt lgkmcnt(0)
    s_nop 3
    s_branch L_retF
L_rescale:
    v_add_u32 v32, 0, v35
    ds_bpermute_b32 v28, v32, v16
    v_add_u32 v32, 4, v35
    ds_bpermute_b32 v29, v32, v16
    v_add_u32 v32, 8, v35
    ds_bpermute_b32 v30, v32, v16
    v_add_u32 v32, 12, v35
    ds_bpermute_b32 v31, v32, v16
    s_waitcnt lgkmcnt(0)
    v_accvgpr_read_b32 v24, a0
    v_accvgpr_read_b32 v25, a1
    v_accvgpr_read_b32 v26, a2
    v_accvgpr_read_b32 v27, a3
    v_mul_f32 v24, v24, v28
    v_mul_f32 v25, v25, v29
    v_mul_f32 v26, v26, v30
    v_mul_f32 v27, v27, v31
    v_accvgpr_write_b32 a0, v24
    v_accvgpr_write_b32 a1, v25
    v_accvgpr_write_b32 a2, v26
    v_accvgpr_write_b32 a3, v27
    v_accvgpr_read_b32 v24, a4
    v_accvgpr_read_b32 v25, a5
    v_accvgpr_read_b32 v26, a6
    v_accvgpr_read_b32 v27, a7
    v_mul_f32 v24, v24, v28
    v_mul_f32 v25, v25, v29
    v_mul_f32 v26, v26, v30
    v_mul_f32 v27, v27, v31
    v_accvgpr_write_b32 a4, v24
    v_accvgpr_write_b32 a5, v25
    v_accvgpr_write_b32 a6, v26
    v_accvgpr_write_b32 a7, v27
    v_accvgpr_read_b32 v24, a8
    v_accvgpr_read_b32 v25, a9
    v_accvgpr_read_b32 v26, a10
    v_accvgpr_read_b32 v27, a11
    v_mul_f32 v24, v24, v28
    v_mul_f32 v25, v25, v29
    v_mul_f32 v26, v26, v30
    v_mul_f32 v27, v27, v31
    v_accvgpr_write_b32 a8, v24
    v_accvgpr_write_b32 a9, v25
    v_accvgpr_write_b32 a10, v26
    v_accvgpr_write_b32 a11, v27
    v_accvgpr_read_b32 v24, a12
    v_accvgpr_read_b32 v25, a13
    v_accvgpr_read_b32 v26, a14
    v_accvgpr_read_b32 v27, a15
    v_mul_f32 v24, v24, v28
    v_mul_f32 v25, v25, v29
    v_mul_f32 v26, v26, v30
    v_mul_f32 v27, v27, v31
    v_accvgpr_write_b32 a12, v24
    v_accvgpr_write_b32 a13, v25
    v_accvgpr_write_b32 a14, v26
    v_accvgpr_write_b32 a15, v27
    v_accvgpr_read_b32 v24, a16
    v_accvgpr_read_b32 v25, a17
    v_accvgpr_read_b32 v26, a18
    v_accvgpr_read_b32 v27, a19
    v_mul_f32 v24, v24, v28
    v_mul_f32 v25, v25, v29
    v_mul_f32 v26, v26, v30
    v_mul_f32 v27, v27, v31
    v_accvgpr_write_b32 a16, v24
    v_accvgpr_write_b32 a17, v25
    v_accvgpr_write_b32 a18, v26
    v_accvgpr_write_b32 a19, v27
    v_accvgpr_read_b32 v24, a20
    v_accvgpr_read_b32 v25, a21
    v_accvgpr_read_b32 v26, a22
    v_accvgpr_read_b32 v27, a23
    v_mul_f32 v24, v24, v28
    v_mul_f32 v25, v25, v29
    v_mul_f32 v26, v26, v30
    v_mul_f32 v27, v27, v31
    v_accvgpr_write_b32 a20, v24
    v_accvgpr_write_b32 a21, v25
    v_accvgpr_write_b32 a22, v26
    v_accvgpr_write_b32 a23, v27
    v_accvgpr_read_b32 v24, a24
    v_accvgpr_read_b32 v25, a25
    v_accvgpr_read_b32 v26, a26
    v_accvgpr_read_b32 v27, a27
    v_mul_f32 v24, v24, v28
    v_mul_f32 v25, v25, v29
    v_mul_f32 v26, v26, v30
    v_mul_f32 v27, v27, v31
    v_accvgpr_write_b32 a24, v24
    v_accvgpr_write_b32 a25, v25
    v_accvgpr_write_b32 a26, v26
    v_accvgpr_write_b32 a27, v27
    v_accvgpr_read_b32 v24, a28
    v_accvgpr_read_b32 v25, a29
    v_accvgpr_read_b32 v26, a30
    v_accvgpr_read_b32 v27, a31
    v_mul_f32 v24, v24, v28
    v_mul_f32 v25, v25, v29
    v_mul_f32 v26, v26, v30
    v_mul_f32 v27, v27, v31
    v_accvgpr_write_b32 a28, v24
    v_accvgpr_write_b32 a29, v25
    v_accvgpr_write_b32 a30, v26
    v_accvgpr_write_b32 a31, v27
    v_accvgpr_read_b32 v24, a32
    v_accvgpr_read_b32 v25, a33
    v_accvgpr_read_b32 v26, a34
    v_accvgpr_read_b32 v27, a35
    v_mul_f32 v24, v24, v28
    v_mul_f32 v25, v25, v29
    v_mul_f32 v26, v26, v30
    v_mul_f32 v27, v27, v31
    v_accvgpr_write_b32 a32, v24
    v_accvgpr_write_b32 a33, v25
    v_accvgpr_write_b32 a34, v26
    v_accvgpr_write_b32 a35, v27
    v_accvgpr_read_b32 v24, a36
    v_accvgpr_read_b32 v25, a37
    v_accvgpr_read_b32 v26, a38
    v_accvgpr_read_b32 v27, a39
    v_mul_f32 v24, v24, v28
    v_mul_f32 v25, v25, v29
    v_mul_f32 v26, v26, v30
    v_mul_f32 v27, v27, v31
    v_accvgpr_write_b32 a36, v24
    v_accvgpr_write_b32 a37, v25
    v_accvgpr_write_b32 a38, v26
    v_accvgpr_write_b32 a39, v27
    v_accvgpr_read_b32 v24, a40
    v_accvgpr_read_b32 v25, a41
    v_accvgpr_read_b32 v26, a42
    v_accvgpr_read_b32 v27, a43
    v_mul_f32 v24, v24, v28
    v_mul_f32 v25, v25, v29
    v_mul_f32 v26, v26, v30
    v_mul_f32 v27, v27, v31
    v_accvgpr_write_b32 a40, v24
    v_accvgpr_write_b32 a41, v25
    v_accvgpr_write_b32 a42, v26
    v_accvgpr_write_b32 a43, v27
    v_accvgpr_read_b32 v24, a44
    v_accvgpr_read_b32 v25, a45
    v_accvgpr_read_b32 v26, a46
    v_accvgpr_read_b32 v27, a47
    v_mul_f32 v24, v24, v28
    v_mul_f32 v25, v25, v29
    v_mul_f32 v26, v26, v30
    v_mul_f32 v27, v27, v31
    v_accvgpr_write_b32 a44, v24
    v_accvgpr_write_b32 a45, v25
    v_accvgpr_write_b32 a46, v26
    v_accvgpr_write_b32 a47, v27
    v_accvgpr_read_b32 v24, a48
    v_accvgpr_read_b32 v25, a49
    v_accvgpr_read_b32 v26, a50
    v_accvgpr_read_b32 v27, a51
    v_mul_f32 v24, v24, v28
    v_mul_f32 v25, v25, v29
    v_mul_f32 v26, v26, v30
    v_mul_f32 v27, v27, v31
    v_accvgpr_write_b32 a48, v24
    v_accvgpr_write_b32 a49, v25
    v_accvgpr_write_b32 a50, v26
    v_accvgpr_write_b32 a51, v27
    v_accvgpr_read_b32 v24, a52
    v_accvgpr_read_b32 v25, a53
    v_accvgpr_read_b32 v26, a54
    v_accvgpr_read_b32 v27, a55
    v_mul_f32 v24, v24, v28
    v_mul_f32 v25, v25, v29
    v_mul_f32 v26, v26, v30
    v_mul_f32 v27, v27, v31
    v_accvgpr_write_b32 a52, v24
    v_accvgpr_write_b32 a53, v25
    v_accvgpr_write_b32 a54, v26
    v_accvgpr_write_b32 a55, v27
    v_accvgpr_read_b32 v24, a56
    v_accvgpr_read_b32 v25, a57
    v_accvgpr_read_b32 v26, a58
    v_accvgpr_read_b32 v27, a59
    v_mul_f32 v24, v24, v28
    v_mul_f32 v25, v25, v29
    v_mul_f32 v26, v26, v30
    v_mul_f32 v27, v27, v31
    v_accvgpr_write_b32 a56, v24
    v_accvgpr_write_b32 a57, v25
    v_accvgpr_write_b32 a58, v26
    v_accvgpr_write_b32 a59, v27
    v_accvgpr_read_b32 v24, a60
    v_accvgpr_read_b32 v25, a61
    v_accvgpr_read_b32 v26, a62
    v_accvgpr_read_b32 v27, a63
    v_mul_f32 v24, v24, v28
    v_mul_f32 v25, v25, v29
    v_mul_f32 v26, v26, v30
    v_mul_f32 v27, v27, v31
    v_accvgpr_write_b32 a60, v24
    v_accvgpr_write_b32 a61, v25
    v_accvgpr_write_b32 a62, v26
    v_accvgpr_write_b32 a63, v27
    v_add_u32 v32, 0, v35
    ds_bpermute_b32 v28, v32, v17
    v_add_u32 v32, 4, v35
    ds_bpermute_b32 v29, v32, v17
    v_add_u32 v32, 8, v35
    ds_bpermute_b32 v30, v32, v17
    v_add_u32 v32, 12, v35
    ds_bpermute_b32 v31, v32, v17
    s_waitcnt lgkmcnt(0)
    v_accvgpr_read_b32 v24, a64
    v_accvgpr_read_b32 v25, a65
    v_accvgpr_read_b32 v26, a66
    v_accvgpr_read_b32 v27, a67
    v_mul_f32 v24, v24, v28
    v_mul_f32 v25, v25, v29
    v_mul_f32 v26, v26, v30
    v_mul_f32 v27, v27, v31
    v_accvgpr_write_b32 a64, v24
    v_accvgpr_write_b32 a65, v25
    v_accvgpr_write_b32 a66, v26
    v_accvgpr_write_b32 a67, v27
    v_accvgpr_read_b32 v24, a68
    v_accvgpr_read_b32 v25, a69
    v_accvgpr_read_b32 v26, a70
    v_accvgpr_read_b32 v27, a71
    v_mul_f32 v24, v24, v28
    v_mul_f32 v25, v25, v29
    v_mul_f32 v26, v26, v30
    v_mul_f32 v27, v27, v31
    v_accvgpr_write_b32 a68, v24
    v_accvgpr_write_b32 a69, v25
    v_accvgpr_write_b32 a70, v26
    v_accvgpr_write_b32 a71, v27
    v_accvgpr_read_b32 v24, a72
    v_accvgpr_read_b32 v25, a73
    v_accvgpr_read_b32 v26, a74
    v_accvgpr_read_b32 v27, a75
    v_mul_f32 v24, v24, v28
    v_mul_f32 v25, v25, v29
    v_mul_f32 v26, v26, v30
    v_mul_f32 v27, v27, v31
    v_accvgpr_write_b32 a72, v24
    v_accvgpr_write_b32 a73, v25
    v_accvgpr_write_b32 a74, v26
    v_accvgpr_write_b32 a75, v27
    v_accvgpr_read_b32 v24, a76
    v_accvgpr_read_b32 v25, a77
    v_accvgpr_read_b32 v26, a78
    v_accvgpr_read_b32 v27, a79
    v_mul_f32 v24, v24, v28
    v_mul_f32 v25, v25, v29
    v_mul_f32 v26, v26, v30
    v_mul_f32 v27, v27, v31
    v_accvgpr_write_b32 a76, v24
    v_accvgpr_write_b32 a77, v25
    v_accvgpr_write_b32 a78, v26
    v_accvgpr_write_b32 a79, v27
    v_accvgpr_read_b32 v24, a80
    v_accvgpr_read_b32 v25, a81
    v_accvgpr_read_b32 v26, a82
    v_accvgpr_read_b32 v27, a83
    v_mul_f32 v24, v24, v28
    v_mul_f32 v25, v25, v29
    v_mul_f32 v26, v26, v30
    v_mul_f32 v27, v27, v31
    v_accvgpr_write_b32 a80, v24
    v_accvgpr_write_b32 a81, v25
    v_accvgpr_write_b32 a82, v26
    v_accvgpr_write_b32 a83, v27
    v_accvgpr_read_b32 v24, a84
    v_accvgpr_read_b32 v25, a85
    v_accvgpr_read_b32 v26, a86
    v_accvgpr_read_b32 v27, a87
    v_mul_f32 v24, v24, v28
    v_mul_f32 v25, v25, v29
    v_mul_f32 v26, v26, v30
    v_mul_f32 v27, v27, v31
    v_accvgpr_write_b32 a84, v24
    v_accvgpr_write_b32 a85, v25
    v_accvgpr_write_b32 a86, v26
    v_accvgpr_write_b32 a87, v27
    v_accvgpr_read_b32 v24, a88
    v_accvgpr_read_b32 v25, a89
    v_accvgpr_read_b32 v26, a90
    v_accvgpr_read_b32 v27, a91
    v_mul_f32 v24, v24, v28
    v_mul_f32 v25, v25, v29
    v_mul_f32 v26, v26, v30
    v_mul_f32 v27, v27, v31
    v_accvgpr_write_b32 a88, v24
    v_accvgpr_write_b32 a89, v25
    v_accvgpr_write_b32 a90, v26
    v_accvgpr_write_b32 a91, v27
    v_accvgpr_read_b32 v24, a92
    v_accvgpr_read_b32 v25, a93
    v_accvgpr_read_b32 v26, a94
    v_accvgpr_read_b32 v27, a95
    v_mul_f32 v24, v24, v28
    v_mul_f32 v25, v25, v29
    v_mul_f32 v26, v26, v30
    v_mul_f32 v27, v27, v31
    v_accvgpr_write_b32 a92, v24
    v_accvgpr_write_b32 a93, v25
    v_accvgpr_write_b32 a94, v26
    v_accvgpr_write_b32 a95, v27
    v_accvgpr_read_b32 v24, a96
    v_accvgpr_read_b32 v25, a97
    v_accvgpr_read_b32 v26, a98
    v_accvgpr_read_b32 v27, a99
    v_mul_f32 v24, v24, v28
    v_mul_f32 v25, v25, v29
    v_mul_f32 v26, v26, v30
    v_mul_f32 v27, v27, v31
    v_accvgpr_write_b32 a96, v24
    v_accvgpr_write_b32 a97, v25
    v_accvgpr_write_b32 a98, v26
    v_accvgpr_write_b32 a99, v27
    v_accvgpr_read_b32 v24, a100
    v_accvgpr_read_b32 v25, a101
    v_accvgpr_read_b32 v26, a102
    v_accvgpr_read_b32 v27, a103
    v_mul_f32 v24, v24, v28
    v_mul_f32 v25, v25, v29
    v_mul_f32 v26, v26, v30
    v_mul_f32 v27, v27, v31
    v_accvgpr_write_b32 a100, v24
    v_accvgpr_write_b32 a101, v25
    v_accvgpr_write_b32 a102, v26
    v_accvgpr_write_b32 a103, v27
    v_accvgpr_read_b32 v24, a104
    v_accvgpr_read_b32 v25, a105
    v_accvgpr_read_b32 v26, a106
    v_accvgpr_read_b32 v27, a107
    v_mul_f32 v24, v24, v28
    v_mul_f32 v25, v25, v29
    v_mul_f32 v26, v26, v30
    v_mul_f32 v27, v27, v31
    v_accvgpr_write_b32 a104, v24
    v_accvgpr_write_b32 a105, v25
    v_accvgpr_write_b32 a106, v26
    v_accvgpr_write_b32 a107, v27
    v_accvgpr_read_b32 v24, a108
    v_accvgpr_read_b32 v25, a109
    v_accvgpr_read_b32 v26, a110
    v_accvgpr_read_b32 v27, a111
    v_mul_f32 v24, v24, v28
    v_mul_f32 v25, v25, v29
    v_mul_f32 v26, v26, v30
    v_mul_f32 v27, v27, v31
    v_accvgpr_write_b32 a108, v24
    v_accvgpr_write_b32 a109, v25
    v_accvgpr_write_b32 a110, v26
    v_accvgpr_write_b32 a111, v27
    v_accvgpr_read_b32 v24, a112
    v_accvgpr_read_b32 v25, a113
    v_accvgpr_read_b32 v26, a114
    v_accvgpr_read_b32 v27, a115
    v_mul_f32 v24, v24, v28
    v_mul_f32 v25, v25, v29
    v_mul_f32 v26, v26, v30
    v_mul_f32 v27, v27, v31
    v_accvgpr_write_b32 a112, v24
    v_accvgpr_write_b32 a113, v25
    v_accvgpr_write_b32 a114, v26
    v_accvgpr_write_b32 a115, v27
    v_accvgpr_read_b32 v24, a116
    v_accvgpr_read_b32 v25, a117
    v_accvgpr_read_b32 v26, a118
    v_accvgpr_read_b32 v27, a119
    v_mul_f32 v24, v24, v28
    v_mul_f32 v25, v25, v29
    v_mul_f32 v26, v26, v30
    v_mul_f32 v27, v27, v31
    v_accvgpr_write_b32 a116, v24
    v_accvgpr_write_b32 a117, v25
    v_accvgpr_write_b32 a118, v26
    v_accvgpr_write_b32 a119, v27
    v_accvgpr_read_b32 v24, a120
    v_accvgpr_read_b32 v25, a121
    v_accvgpr_read_b32 v26, a122
    v_accvgpr_read_b32 v27, a123
    v_mul_f32 v24, v24, v28
    v_mul_f32 v25, v25, v29
    v_mul_f32 v26, v26, v30
    v_mul_f32 v27, v27, v31
    v_accvgpr_write_b32 a120, v24
    v_accvgpr_write_b32 a121, v25
    v_accvgpr_write_b32 a122, v26
    v_accvgpr_write_b32 a123, v27
    v_accvgpr_read_b32 v24, a124
    v_accvgpr_read_b32 v25, a125
    v_accvgpr_read_b32 v26, a126
    v_accvgpr_read_b32 v27, a127
    v_mul_f32 v24, v24, v28
    v_mul_f32 v25, v25, v29
    v_mul_f32 v26, v26, v30
    v_mul_f32 v27, v27, v31
    v_accvgpr_write_b32 a124, v24
    v_accvgpr_write_b32 a125, v25
    v_accvgpr_write_b32 a126, v26
    v_accvgpr_write_b32 a127, v27
    v_add_u32 v32, 0, v35
    ds_bpermute_b32 v28, v32, v18
    v_add_u32 v32, 4, v35
    ds_bpermute_b32 v29, v32, v18
    v_add_u32 v32, 8, v35
    ds_bpermute_b32 v30, v32, v18
    v_add_u32 v32, 12, v35
    ds_bpermute_b32 v31, v32, v18
    s_waitcnt lgkmcnt(0)
    v_accvgpr_read_b32 v24, a128
    v_accvgpr_read_b32 v25, a129
    v_accvgpr_read_b32 v26, a130
    v_accvgpr_read_b32 v27, a131
    v_mul_f32 v24, v24, v28
    v_mul_f32 v25, v25, v29
    v_mul_f32 v26, v26, v30
    v_mul_f32 v27, v27, v31
    v_accvgpr_write_b32 a128, v24
    v_accvgpr_write_b32 a129, v25
    v_accvgpr_write_b32 a130, v26
    v_accvgpr_write_b32 a131, v27
    v_accvgpr_read_b32 v24, a132
    v_accvgpr_read_b32 v25, a133
    v_accvgpr_read_b32 v26, a134
    v_accvgpr_read_b32 v27, a135
    v_mul_f32 v24, v24, v28
    v_mul_f32 v25, v25, v29
    v_mul_f32 v26, v26, v30
    v_mul_f32 v27, v27, v31
    v_accvgpr_write_b32 a132, v24
    v_accvgpr_write_b32 a133, v25
    v_accvgpr_write_b32 a134, v26
    v_accvgpr_write_b32 a135, v27
    v_accvgpr_read_b32 v24, a136
    v_accvgpr_read_b32 v25, a137
    v_accvgpr_read_b32 v26, a138
    v_accvgpr_read_b32 v27, a139
    v_mul_f32 v24, v24, v28
    v_mul_f32 v25, v25, v29
    v_mul_f32 v26, v26, v30
    v_mul_f32 v27, v27, v31
    v_accvgpr_write_b32 a136, v24
    v_accvgpr_write_b32 a137, v25
    v_accvgpr_write_b32 a138, v26
    v_accvgpr_write_b32 a139, v27
    v_accvgpr_read_b32 v24, a140
    v_accvgpr_read_b32 v25, a141
    v_accvgpr_read_b32 v26, a142
    v_accvgpr_read_b32 v27, a143
    v_mul_f32 v24, v24, v28
    v_mul_f32 v25, v25, v29
    v_mul_f32 v26, v26, v30
    v_mul_f32 v27, v27, v31
    v_accvgpr_write_b32 a140, v24
    v_accvgpr_write_b32 a141, v25
    v_accvgpr_write_b32 a142, v26
    v_accvgpr_write_b32 a143, v27
    v_accvgpr_read_b32 v24, a144
    v_accvgpr_read_b32 v25, a145
    v_accvgpr_read_b32 v26, a146
    v_accvgpr_read_b32 v27, a147
    v_mul_f32 v24, v24, v28
    v_mul_f32 v25, v25, v29
    v_mul_f32 v26, v26, v30
    v_mul_f32 v27, v27, v31
    v_accvgpr_write_b32 a144, v24
    v_accvgpr_write_b32 a145, v25
    v_accvgpr_write_b32 a146, v26
    v_accvgpr_write_b32 a147, v27
    v_accvgpr_read_b32 v24, a148
    v_accvgpr_read_b32 v25, a149
    v_accvgpr_read_b32 v26, a150
    v_accvgpr_read_b32 v27, a151
    v_mul_f32 v24, v24, v28
    v_mul_f32 v25, v25, v29
    v_mul_f32 v26, v26, v30
    v_mul_f32 v27, v27, v31
    v_accvgpr_write_b32 a148, v24
    v_accvgpr_write_b32 a149, v25
    v_accvgpr_write_b32 a150, v26
    v_accvgpr_write_b32 a151, v27
    v_accvgpr_read_b32 v24, a152
    v_accvgpr_read_b32 v25, a153
    v_accvgpr_read_b32 v26, a154
    v_accvgpr_read_b32 v27, a155
    v_mul_f32 v24, v24, v28
    v_mul_f32 v25, v25, v29
    v_mul_f32 v26, v26, v30
    v_mul_f32 v27, v27, v31
    v_accvgpr_write_b32 a152, v24
    v_accvgpr_write_b32 a153, v25
    v_accvgpr_write_b32 a154, v26
    v_accvgpr_write_b32 a155, v27
    v_accvgpr_read_b32 v24, a156
    v_accvgpr_read_b32 v25, a157
    v_accvgpr_read_b32 v26, a158
    v_accvgpr_read_b32 v27, a159
    v_mul_f32 v24, v24, v28
    v_mul_f32 v25, v25, v29
    v_mul_f32 v26, v26, v30
    v_mul_f32 v27, v27, v31
    v_accvgpr_write_b32 a156, v24
    v_accvgpr_write_b32 a157, v25
    v_accvgpr_write_b32 a158, v26
    v_accvgpr_write_b32 a159, v27
    v_accvgpr_read_b32 v24, a160
    v_accvgpr_read_b32 v25, a161
    v_accvgpr_read_b32 v26, a162
    v_accvgpr_read_b32 v27, a163
    v_mul_f32 v24, v24, v28
    v_mul_f32 v25, v25, v29
    v_mul_f32 v26, v26, v30
    v_mul_f32 v27, v27, v31
    v_accvgpr_write_b32 a160, v24
    v_accvgpr_write_b32 a161, v25
    v_accvgpr_write_b32 a162, v26
    v_accvgpr_write_b32 a163, v27
    v_accvgpr_read_b32 v24, a164
    v_accvgpr_read_b32 v25, a165
    v_accvgpr_read_b32 v26, a166
    v_accvgpr_read_b32 v27, a167
    v_mul_f32 v24, v24, v28
    v_mul_f32 v25, v25, v29
    v_mul_f32 v26, v26, v30
    v_mul_f32 v27, v27, v31
    v_accvgpr_write_b32 a164, v24
    v_accvgpr_write_b32 a165, v25
    v_accvgpr_write_b32 a166, v26
    v_accvgpr_write_b32 a167, v27
    v_accvgpr_read_b32 v24, a168
    v_accvgpr_read_b32 v25, a169
    v_accvgpr_read_b32 v26, a170
    v_accvgpr_read_b32 v27, a171
    v_mul_f32 v24, v24, v28
    v_mul_f32 v25, v25, v29
    v_mul_f32 v26, v26, v30
    v_mul_f32 v27, v27, v31
    v_accvgpr_write_b32 a168, v24
    v_accvgpr_write_b32 a169, v25
    v_accvgpr_write_b32 a170, v26
    v_accvgpr_write_b32 a171, v27
    v_accvgpr_read_b32 v24, a172
    v_accvgpr_read_b32 v25, a173
    v_accvgpr_read_b32 v26, a174
    v_accvgpr_read_b32 v27, a175
    v_mul_f32 v24, v24, v28
    v_mul_f32 v25, v25, v29
    v_mul_f32 v26, v26, v30
    v_mul_f32 v27, v27, v31
    v_accvgpr_write_b32 a172, v24
    v_accvgpr_write_b32 a173, v25
    v_accvgpr_write_b32 a174, v26
    v_accvgpr_write_b32 a175, v27
    v_accvgpr_read_b32 v24, a176
    v_accvgpr_read_b32 v25, a177
    v_accvgpr_read_b32 v26, a178
    v_accvgpr_read_b32 v27, a179
    v_mul_f32 v24, v24, v28
    v_mul_f32 v25, v25, v29
    v_mul_f32 v26, v26, v30
    v_mul_f32 v27, v27, v31
    v_accvgpr_write_b32 a176, v24
    v_accvgpr_write_b32 a177, v25
    v_accvgpr_write_b32 a178, v26
    v_accvgpr_write_b32 a179, v27
    v_accvgpr_read_b32 v24, a180
    v_accvgpr_read_b32 v25, a181
    v_accvgpr_read_b32 v26, a182
    v_accvgpr_read_b32 v27, a183
    v_mul_f32 v24, v24, v28
    v_mul_f32 v25, v25, v29
    v_mul_f32 v26, v26, v30
    v_mul_f32 v27, v27, v31
    v_accvgpr_write_b32 a180, v24
    v_accvgpr_write_b32 a181, v25
    v_accvgpr_write_b32 a182, v26
    v_accvgpr_write_b32 a183, v27
    v_accvgpr_read_b32 v24, a184
    v_accvgpr_read_b32 v25, a185
    v_accvgpr_read_b32 v26, a186
    v_accvgpr_read_b32 v27, a187
    v_mul_f32 v24, v24, v28
    v_mul_f32 v25, v25, v29
    v_mul_f32 v26, v26, v30
    v_mul_f32 v27, v27, v31
    v_accvgpr_write_b32 a184, v24
    v_accvgpr_write_b32 a185, v25
    v_accvgpr_write_b32 a186, v26
    v_accvgpr_write_b32 a187, v27
    v_accvgpr_read_b32 v24, a188
    v_accvgpr_read_b32 v25, a189
    v_accvgpr_read_b32 v26, a190
    v_accvgpr_read_b32 v27, a191
    v_mul_f32 v24, v24, v28
    v_mul_f32 v25, v25, v29
    v_mul_f32 v26, v26, v30
    v_mul_f32 v27, v27, v31
    v_accvgpr_write_b32 a188, v24
    v_accvgpr_write_b32 a189, v25
    v_accvgpr_write_b32 a190, v26
    v_accvgpr_write_b32 a191, v27
    v_add_u32 v32, 0, v35
    ds_bpermute_b32 v28, v32, v19
    v_add_u32 v32, 4, v35
    ds_bpermute_b32 v29, v32, v19
    v_add_u32 v32, 8, v35
    ds_bpermute_b32 v30, v32, v19
    v_add_u32 v32, 12, v35
    ds_bpermute_b32 v31, v32, v19
    s_waitcnt lgkmcnt(0)
    v_accvgpr_read_b32 v24, a192
    v_accvgpr_read_b32 v25, a193
    v_accvgpr_read_b32 v26, a194
    v_accvgpr_read_b32 v27, a195
    v_mul_f32 v24, v24, v28
    v_mul_f32 v25, v25, v29
    v_mul_f32 v26, v26, v30
    v_mul_f32 v27, v27, v31
    v_accvgpr_write_b32 a192, v24
    v_accvgpr_write_b32 a193, v25
    v_accvgpr_write_b32 a194, v26
    v_accvgpr_write_b32 a195, v27
    v_accvgpr_read_b32 v24, a196
    v_accvgpr_read_b32 v25, a197
    v_accvgpr_read_b32 v26, a198
    v_accvgpr_read_b32 v27, a199
    v_mul_f32 v24, v24, v28
    v_mul_f32 v25, v25, v29
    v_mul_f32 v26, v26, v30
    v_mul_f32 v27, v27, v31
    v_accvgpr_write_b32 a196, v24
    v_accvgpr_write_b32 a197, v25
    v_accvgpr_write_b32 a198, v26
    v_accvgpr_write_b32 a199, v27
    v_accvgpr_read_b32 v24, a200
    v_accvgpr_read_b32 v25, a201
    v_accvgpr_read_b32 v26, a202
    v_accvgpr_read_b32 v27, a203
    v_mul_f32 v24, v24, v28
    v_mul_f32 v25, v25, v29
    v_mul_f32 v26, v26, v30
    v_mul_f32 v27, v27, v31
    v_accvgpr_write_b32 a200, v24
    v_accvgpr_write_b32 a201, v25
    v_accvgpr_write_b32 a202, v26
    v_accvgpr_write_b32 a203, v27
    v_accvgpr_read_b32 v24, a204
    v_accvgpr_read_b32 v25, a205
    v_accvgpr_read_b32 v26, a206
    v_accvgpr_read_b32 v27, a207
    v_mul_f32 v24, v24, v28
    v_mul_f32 v25, v25, v29
    v_mul_f32 v26, v26, v30
    v_mul_f32 v27, v27, v31
    v_accvgpr_write_b32 a204, v24
    v_accvgpr_write_b32 a205, v25
    v_accvgpr_write_b32 a206, v26
    v_accvgpr_write_b32 a207, v27
    v_accvgpr_read_b32 v24, a208
    v_accvgpr_read_b32 v25, a209
    v_accvgpr_read_b32 v26, a210
    v_accvgpr_read_b32 v27, a211
    v_mul_f32 v24, v24, v28
    v_mul_f32 v25, v25, v29
    v_mul_f32 v26, v26, v30
    v_mul_f32 v27, v27, v31
    v_accvgpr_write_b32 a208, v24
    v_accvgpr_write_b32 a209, v25
    v_accvgpr_write_b32 a210, v26
    v_accvgpr_write_b32 a211, v27
    v_accvgpr_read_b32 v24, a212
    v_accvgpr_read_b32 v25, a213
    v_accvgpr_read_b32 v26, a214
    v_accvgpr_read_b32 v27, a215
    v_mul_f32 v24, v24, v28
    v_mul_f32 v25, v25, v29
    v_mul_f32 v26, v26, v30
    v_mul_f32 v27, v27, v31
    v_accvgpr_write_b32 a212, v24
    v_accvgpr_write_b32 a213, v25
    v_accvgpr_write_b32 a214, v26
    v_accvgpr_write_b32 a215, v27
    v_accvgpr_read_b32 v24, a216
    v_accvgpr_read_b32 v25, a217
    v_accvgpr_read_b32 v26, a218
    v_accvgpr_read_b32 v27, a219
    v_mul_f32 v24, v24, v28
    v_mul_f32 v25, v25, v29
    v_mul_f32 v26, v26, v30
    v_mul_f32 v27, v27, v31
    v_accvgpr_write_b32 a216, v24
    v_accvgpr_write_b32 a217, v25
    v_accvgpr_write_b32 a218, v26
    v_accvgpr_write_b32 a219, v27
    v_accvgpr_read_b32 v24, a220
    v_accvgpr_read_b32 v25, a221
    v_accvgpr_read_b32 v26, a222
    v_accvgpr_read_b32 v27, a223
    v_mul_f32 v24, v24, v28
    v_mul_f32 v25, v25, v29
    v_mul_f32 v26, v26, v30
    v_mul_f32 v27, v27, v31
    v_accvgpr_write_b32 a220, v24
    v_accvgpr_write_b32 a221, v25
    v_accvgpr_write_b32 a222, v26
    v_accvgpr_write_b32 a223, v27
    v_accvgpr_read_b32 v24, a224
    v_accvgpr_read_b32 v25, a225
    v_accvgpr_read_b32 v26, a226
    v_accvgpr_read_b32 v27, a227
    v_mul_f32 v24, v24, v28
    v_mul_f32 v25, v25, v29
    v_mul_f32 v26, v26, v30
    v_mul_f32 v27, v27, v31
    v_accvgpr_write_b32 a224, v24
    v_accvgpr_write_b32 a225, v25
    v_accvgpr_write_b32 a226, v26
    v_accvgpr_write_b32 a227, v27
    v_accvgpr_read_b32 v24, a228
    v_accvgpr_read_b32 v25, a229
    v_accvgpr_read_b32 v26, a230
    v_accvgpr_read_b32 v27, a231
    v_mul_f32 v24, v24, v28
    v_mul_f32 v25, v25, v29
    v_mul_f32 v26, v26, v30
    v_mul_f32 v27, v27, v31
    v_accvgpr_write_b32 a228, v24
    v_accvgpr_write_b32 a229, v25
    v_accvgpr_write_b32 a230, v26
    v_accvgpr_write_b32 a231, v27
    v_accvgpr_read_b32 v24, a232
    v_accvgpr_read_b32 v25, a233
    v_accvgpr_read_b32 v26, a234
    v_accvgpr_read_b32 v27, a235
    v_mul_f32 v24, v24, v28
    v_mul_f32 v25, v25, v29
    v_mul_f32 v26, v26, v30
    v_mul_f32 v27, v27, v31
    v_accvgpr_write_b32 a232, v24
    v_accvgpr_write_b32 a233, v25
    v_accvgpr_write_b32 a234, v26
    v_accvgpr_write_b32 a235, v27
    v_accvgpr_read_b32 v24, a236
    v_accvgpr_read_b32 v25, a237
    v_accvgpr_read_b32 v26, a238
    v_accvgpr_read_b32 v27, a239
    v_mul_f32 v24, v24, v28
    v_mul_f32 v25, v25, v29
    v_mul_f32 v26, v26, v30
    v_mul_f32 v27, v27, v31
    v_accvgpr_write_b32 a236, v24
    v_accvgpr_write_b32 a237, v25
    v_accvgpr_write_b32 a238, v26
    v_accvgpr_write_b32 a239, v27
    v_accvgpr_read_b32 v24, a240
    v_accvgpr_read_b32 v25, a241
    v_accvgpr_read_b32 v26, a242
    v_accvgpr_read_b32 v27, a243
    v_mul_f32 v24, v24, v28
    v_mul_f32 v25, v25, v29
    v_mul_f32 v26, v26, v30
    v_mul_f32 v27, v27, v31
    v_accvgpr_write_b32 a240, v24
    v_accvgpr_write_b32 a241, v25
    v_accvgpr_write_b32 a242, v26
    v_accvgpr_write_b32 a243, v27
    v_accvgpr_read_b32 v24, a244
    v_accvgpr_read_b32 v25, a245
    v_accvgpr_read_b32 v26, a246
    v_accvgpr_read_b32 v27, a247
    v_mul_f32 v24, v24, v28
    v_mul_f32 v25, v25, v29
    v_mul_f32 v26, v26, v30
    v_mul_f32 v27, v27, v31
    v_accvgpr_write_b32 a244, v24
    v_accvgpr_write_b32 a245, v25
    v_accvgpr_write_b32 a246, v26
    v_accvgpr_write_b32 a247, v27
    v_accvgpr_read_b32 v24, a248
    v_accvgpr_read_b32 v25, a249
    v_accvgpr_read_b32 v26, a250
    v_accvgpr_read_b32 v27, a251
    v_mul_f32 v24, v24, v28
    v_mul_f32 v25, v25, v29
    v_mul_f32 v26, v26, v30
    v_mul_f32 v27, v27, v31
    v_accvgpr_write_b32 a248, v24
    v_accvgpr_write_b32 a249, v25
    v_accvgpr_write_b32 a250, v26
    v_accvgpr_write_b32 a251, v27
    v_accvgpr_read_b32 v24, a252
    v_accvgpr_read_b32 v25, a253
    v_accvgpr_read_b32 v26, a254
    v_accvgpr_read_b32 v27, a255
    v_mul_f32 v24, v24, v28
    v_mul_f32 v25, v25, v29
    v_mul_f32 v26, v26, v30
    v_mul_f32 v27, v27, v31
    v_accvgpr_write_b32 a252, v24
    v_accvgpr_write_b32 a253, v25
    v_accvgpr_write_b32 a254, v26
    v_accvgpr_write_b32 a255, v27
    v_add_u32 v32, 0, v35
    ds_bpermute_b32 v28, v32, v20
    v_add_u32 v32, 4, v35
    ds_bpermute_b32 v29, v32, v20
    v_add_u32 v32, 8, v35
    ds_bpermute_b32 v30, v32, v20
    v_add_u32 v32, 12, v35
    ds_bpermute_b32 v31, v32, v20
    s_waitcnt lgkmcnt(0)
    v_mul_f32 v192, v192, v28
    v_mul_f32 v193, v193, v29
    v_mul_f32 v194, v194, v30
    v_mul_f32 v195, v195, v31
    v_mul_f32 v196, v196, v28
    v_mul_f32 v197, v197, v29
    v_mul_f32 v198, v198, v30
    v_mul_f32 v199, v199, v31
    v_mul_f32 v200, v200, v28
    v_mul_f32 v201, v201, v29
    v_mul_f32 v202, v202, v30
    v_mul_f32 v203, v203, v31
    v_mul_f32 v204, v204, v28
    v_mul_f32 v205, v205, v29
    v_mul_f32 v206, v206, v30
    v_mul_f32 v207, v207, v31
    v_mul_f32 v208, v208, v28
    v_mul_f32 v209, v209, v29
    v_mul_f32 v210, v210, v30
    v_mul_f32 v211, v211, v31
    v_mul_f32 v212, v212, v28
    v_mul_f32 v213, v213, v29
    v_mul_f32 v214, v214, v30
    v_mul_f32 v215, v215, v31
    v_mul_f32 v216, v216, v28
    v_mul_f32 v217, v217, v29
    v_mul_f32 v218, v218, v30
    v_mul_f32 v219, v219, v31
    v_mul_f32 v220, v220, v28
    v_mul_f32 v221, v221, v29
    v_mul_f32 v222, v222, v30
    v_mul_f32 v223, v223, v31
    v_mul_f32 v224, v224, v28
    v_mul_f32 v225, v225, v29
    v_mul_f32 v226, v226, v30
    v_mul_f32 v227, v227, v31
    v_mul_f32 v228, v228, v28
    v_mul_f32 v229, v229, v29
    v_mul_f32 v230, v230, v30
    v_mul_f32 v231, v231, v31
    v_mul_f32 v232, v232, v28
    v_mul_f32 v233, v233, v29
    v_mul_f32 v234, v234, v30
    v_mul_f32 v235, v235, v31
    v_mul_f32 v236, v236, v28
    v_mul_f32 v237, v237, v29
    v_mul_f32 v238, v238, v30
    v_mul_f32 v239, v239, v31
    v_mul_f32 v240, v240, v28
    v_mul_f32 v241, v241, v29
    v_mul_f32 v242, v242, v30
    v_mul_f32 v243, v243, v31
    v_mul_f32 v244, v244, v28
    v_mul_f32 v245, v245, v29
    v_mul_f32 v246, v246, v30
    v_mul_f32 v247, v247, v31
    v_mul_f32 v248, v248, v28
    v_mul_f32 v249, v249, v29
    v_mul_f32 v250, v250, v30
    v_mul_f32 v251, v251, v31
    v_mul_f32 v252, v252, v28
    v_mul_f32 v253, v253, v29
    v_mul_f32 v254, v254, v30
    v_mul_f32 v255, v255, v31
    s_cmp_eq_u32 s32, 0
    s_cbranch_scc1 L_backA
    s_cmp_eq_u32 s32, 1
    s_cbranch_scc1 L_backB
    s_cmp_eq_u32 s32, 2
    s_cbranch_scc1 L_backC
    s_branch L_backF
.section .rodata,"a"
.p2align 6
.amdhsa_kernel standalone__mha_softmax__near_ridge_kernel
  .amdhsa_next_free_vgpr 512
  .amdhsa_next_free_sgpr 100
  .amdhsa_accum_offset 256
  .amdhsa_group_segment_fixed_size 0
  .amdhsa_kernarg_size 48
  .amdhsa_user_sgpr_count 2
  .amdhsa_user_sgpr_kernarg_segment_ptr 1
  .amdhsa_system_sgpr_workgroup_id_x 1
.end_amdhsa_kernel
```
